```python
import torch

def _softmax(x, axis=-1):
    return torch.softmax(x, dim=axis)

def _gelu(x):
    return torch.nn.functional.gelu(x, approximate='tanh')

def _silu(x):
    return torch.nn.functional.silu(x)

def _sigmoid(x):
    return torch.sigmoid(x)

def _layernorm(x, axis=-1, eps=1e-05):
    m = x.mean(dim=axis, keepdim=True)
    v = x.var(dim=axis, keepdim=True, unbiased=False)
    return (x - m) / torch.sqrt(v + eps)

def _scatter_add(tgt, idx, src, axis=0):
    return tgt.clone().index_add_(axis, idx, src)

def _segment_sum(src, seg, n):
    out = torch.zeros((n,) + src.shape[1:], dtype=src.dtype)
    return out.index_add_(0, seg, src)

def _pad(x, pw):
    flat = tuple((v for pair in reversed(pw) for v in pair))
    return torch.nn.functional.pad(x, flat)
kernel_name = 'adaLN_cond__spectral_gfnet__glu_gated_reglu__prompt'

def setup_inputs():

    _w = lambda a: (lambda t: t.to(torch.bfloat16) if t.is_floating_point() else t)(torch.as_tensor(a))

    def _A_setup():
        B, S, D = (1, 2048, 640)
        Df = D // 2 + 1
        return {'x': _w((lambda *s: torch.randn(*s, dtype=torch.bfloat16) * 0.05)(B, S, D)), 'w_r': _w((lambda *s: torch.randn(*s, dtype=torch.bfloat16) * 1.6)(S, Df) * 0.02), 'w_i': _w((lambda *s: torch.randn(*s, dtype=torch.bfloat16) * 1.6)(S, Df) * 0.02)}
    _A_in = _A_setup()

    def _B_setup():
        B, S, D, F = (1, 2048, 640, 1536)
        return {'x': _w((lambda *s: torch.randn(*s, dtype=torch.bfloat16) * 0.05)(B, S, D)), 'W_gate': _w((lambda *s: torch.randn(*s, dtype=torch.bfloat16) * 0.4)(D, F) * (2.0 / D) ** 0.5), 'W_up': _w((lambda *s: torch.randn(*s, dtype=torch.bfloat16) * 0.4)(D, F) * (2.0 / D) ** 0.5), 'W_down': _w((lambda *s: torch.randn(*s, dtype=torch.bfloat16) * 0.4)(F, D) * (1.0 / F) ** 0.5)}
    _B_in = _B_setup()
    return {'A_x': _A_in['x'], 'A_w_r': _A_in['w_r'], 'A_w_i': _A_in['w_i'], 'B_x': _B_in['x'], 'B_W_gate': _B_in['W_gate'], 'B_W_up': _B_in['W_up'], 'B_W_down': _B_in['W_down'], 'c': _w((lambda *s: torch.randn(*s, dtype=torch.bfloat16) * 0.2)(1, 640) * 8.0), 'w_mod': _w((lambda *s: torch.randn(*s, dtype=torch.bfloat16) * 0.2)(640, 6 * 640) * 640 ** (-0.5) * 8.0)}

def reference(A_x, A_w_r, A_w_i, B_x, B_W_gate, B_W_up, B_W_down, c, w_mod):

    def _A_ref(x, w_r, w_i):
        B, S, D = x.shape
        X = (lambda x, axes=(-2, -1): torch.fft.rfft2(x.float(), dim=axes))(x, axes=(-2, -1))
        W = w_r + 1j * w_i
        X = X * W
        y = (lambda x, s, axes=(-2, -1): torch.fft.irfft2(x, s=s, dim=axes).to(torch.bfloat16))(X, (S, D), axes=(-2, -1))
        return y

    def _B_ref(x, W_gate, W_up, W_down):
        gate = torch.einsum('bsd,df->bsf', x, W_gate)
        up = torch.einsum('bsd,df->bsf', x, W_up)
        gate = gate * (lambda x, dt: x.to(dt))(gate > 0, gate.dtype)
        h = gate * up
        return torch.einsum('bsf,fd->bsd', h, W_down)
    x = A_x
    mod = (_silu(c) @ w_mod).reshape(c.shape[0], 6, 1, -1)
    sa, ca, ga, sb, cb, gb = (mod[:, 0].clone(), mod[:, 1].clone(), mod[:, 2].clone(), mod[:, 3].clone(), mod[:, 4].clone(), mod[:, 5].clone())
    h = _layernorm(x, axis=-1) * (1 + ca) + sa
    x = x + ga * _A_ref(h, A_w_r, A_w_i)
    h = _layernorm(x, axis=-1) * (1 + cb) + sb
    x = x + gb * _B_ref(h, B_W_gate, B_W_up, B_W_down)
    return x
```

```asm
; @launch grid=(256,1,1) block=(512,1,1) lds=163840
.amdgcn_target "amdgcn-amd-amdhsa--gfx950"
.text
.globl adaLN_cond__spectral_gfnet__glu_gated_reglu__prompt_kernel
.p2align 8
.type adaLN_cond__spectral_gfnet__glu_gated_reglu__prompt_kernel,@function
adaLN_cond__spectral_gfnet__glu_gated_reglu__prompt_kernel:
  s_load_dwordx4 s[8:11], s[0:1], 0
  s_load_dwordx2 s[12:13], s[0:1], 16
  s_load_dwordx8 s[16:23], s[0:1], 32
  s_load_dwordx8 s[24:31], s[0:1], 64
  s_lshr_b32 s4, s2, 3
  s_sub_u32 s4, s4, 23
  s_cmp_lt_u32 s4, 3
  s_cbranch_scc0 K0_nc
  s_getpc_b64 s[44:45]
K0_pc:
  s_lshl_b32 s4, s4, 14
  v_lshl_add_u32 v7, v0, 5, s4
  v_min_u32 v7, CODE_END-K0_pc-4, v7
  v_mov_b32 v9, s45
  v_add_co_u32 v8, vcc, s44, v7
  s_nop 1
  v_addc_co_u32 v9, vcc, 0, v9, vcc
  global_load_dword v254, v[8:9], off
K0_nc:
  v_lshrrev_b32 v1, 6, v0
  s_nop 0
  v_readfirstlane_b32 s15, v1
  s_cmp_ge_u32 s2, 256
  s_cbranch_scc1 K4_end
  s_cmp_ge_u32 s2, 160
  s_cbranch_scc1 K0_notln
  s_cmp_ge_u32 s15, 4
  s_cbranch_scc1 P1_start
  s_and_b32 s3, s2, 7
  s_lshr_b32 s4, s2, 3
  s_mul_i32 s5, s4, 52
  s_lshr_b32 s5, s5, 8
  s_mul_i32 s6, s5, 5
  s_sub_u32 s6, s4, s6
  s_lshl_b32 s5, s5, 3
  s_add_u32 s5, s5, s3
  s_mul_i32 s7, s5, 1280
  v_lshrrev_b32 v1, 2, v0
  v_and_b32 v2, 3, v0
  v_mul_u32_u24 v3, 40960, v1
  v_lshlrev_b32 v4, 4, v2
  v_add_u32 v5, v3, v4
  v_sub_u32 v6, v3, v4
  v_add_u32 v6, 48, v6
  s_lshl_b32 s44, s6, 6
  s_add_u32 s50, s7, s44
  s_sub_u32 s55, s7, s44
  s_add_u32 s55, s55, 256
  s_add_u32 s44, s44, 64
  s_cmp_ge_u32 s44, 320
  s_cselect_b32 s45, 320, 0
  s_sub_u32 s44, s44, s45
  s_add_u32 s51, s7, s44
  s_sub_u32 s56, s7, s44
  s_add_u32 s56, s56, 256
  s_add_u32 s44, s44, 64
  s_cmp_ge_u32 s44, 320
  s_cselect_b32 s45, 320, 0
  s_sub_u32 s44, s44, s45
  s_add_u32 s52, s7, s44
  s_sub_u32 s57, s7, s44
  s_add_u32 s57, s57, 256
  s_add_u32 s44, s44, 64
  s_cmp_ge_u32 s44, 320
  s_cselect_b32 s45, 320, 0
  s_sub_u32 s44, s44, s45
  s_add_u32 s53, s7, s44
  s_sub_u32 s58, s7, s44
  s_add_u32 s58, s58, 256
  s_add_u32 s44, s44, 64
  s_cmp_ge_u32 s44, 320
  s_cselect_b32 s45, 320, 0
  s_sub_u32 s44, s44, s45
  s_add_u32 s54, s7, s44
  s_sub_u32 s59, s7, s44
  s_add_u32 s59, s59, 256
  s_waitcnt lgkmcnt(0)
  s_mov_b32 s32, s8
  s_mov_b32 s33, s9
  s_mov_b32 s34, 2621440
  s_mov_b32 s35, 0x20000
  buffer_load_dwordx4 v[32:35], v5, s[32:35], s50 offen
  buffer_load_dwordx4 v[44:47], v6, s[32:35], s55 offen offset:320
  buffer_load_dwordx4 v[36:39], v5, s[32:35], s50 offen offset:640
  buffer_load_dwordx4 v[40:43], v6, s[32:35], s55 offen offset:960
  buffer_load_dwordx4 v[48:51], v5, s[32:35], s51 offen
  buffer_load_dwordx4 v[60:63], v6, s[32:35], s56 offen offset:320
  buffer_load_dwordx4 v[52:55], v5, s[32:35], s51 offen offset:640
  buffer_load_dwordx4 v[56:59], v6, s[32:35], s56 offen offset:960
  buffer_load_dwordx4 v[64:67], v5, s[32:35], s52 offen
  buffer_load_dwordx4 v[76:79], v6, s[32:35], s57 offen offset:320
  buffer_load_dwordx4 v[68:71], v5, s[32:35], s52 offen offset:640
  buffer_load_dwordx4 v[72:75], v6, s[32:35], s57 offen offset:960
  buffer_load_dwordx4 v[80:83], v5, s[32:35], s53 offen
  buffer_load_dwordx4 v[92:95], v6, s[32:35], s58 offen offset:320
  buffer_load_dwordx4 v[84:87], v5, s[32:35], s53 offen offset:640
  buffer_load_dwordx4 v[88:91], v6, s[32:35], s58 offen offset:960
  buffer_load_dwordx4 v[96:99], v5, s[32:35], s54 offen
  buffer_load_dwordx4 v[108:111], v6, s[32:35], s59 offen offset:320
  buffer_load_dwordx4 v[100:103], v5, s[32:35], s54 offen offset:640
  buffer_load_dwordx4 v[104:107], v6, s[32:35], s59 offen offset:960
  s_lshr_b32 s44, s4, 2
  s_lshl_b32 s44, s44, 3
  s_add_u32 s44, s44, s3
  s_sub_u32 s45, 64, s44
  s_cmp_eq_u32 s44, 0
  s_cselect_b32 s45, 32, s45
  s_bitcmp1_b32 s4, 1
  s_cselect_b32 s44, s45, s44
  s_mul_i32 s44, s44, 642
  s_bitcmp1_b32 s4, 0
  s_cselect_b32 s40, s12, s10
  s_cselect_b32 s41, s13, s11
  s_cmp_ge_u32 s4, 16
  s_cselect_b32 s42, 0, 1314816
  s_mov_b32 s43, 0x20000
  v_lshrrev_b32 v7, 3, v0
  v_and_b32 v8, 7, v0
  v_mul_u32_u24 v7, 41088, v7
  v_min_u32 v8, 5, v8
  v_lshl_add_u32 v7, v8, 7, v7
  buffer_load_ushort v128, v7, s[40:43], s44 offen
  s_mov_b32 s36, s30
  s_mov_b32 s37, s31
  s_mov_b32 s38, 24416256
  s_mov_b32 s39, 0x20000
  v_lshrrev_b32 v7, 6, v0
  v_and_b32 v8, 15, v0
  v_lshl_add_u32 v9, v7, 4, v8
  v_bfe_u32 v10, v0, 4, 2
  v_subrev_u32 v11, 32, v9
  v_cmp_lt_u32 vcc, 32, v9
  v_mov_b32 v12, 0
  v_mov_b32 v13, 0x3e800000
  v_cndmask_b32 v11, v9, v11, vcc
  v_cndmask_b32 v12, v12, v13, vcc
  v_cvt_f32_u32 v11, v11
  v_cvt_f32_u32 v13, v10
  v_mul_f32 v11, 0x3c800000, v11
  v_mul_f32 v13, 4.0, v13
  v_fmac_f32 v12, v13, v11
  v_cos_f32 v24, v12
  v_fmamk_f32 v25, v11, 0x3f800000, v12
  v_cos_f32 v25, v25
  v_fmamk_f32 v26, v11, 0x40000000, v12
  v_cos_f32 v26, v26
  v_fmamk_f32 v27, v11, 0x40400000, v12
  v_cos_f32 v27, v27
  v_fmamk_f32 v28, v11, 0x41800000, v12
  v_cos_f32 v28, v28
  v_fmamk_f32 v29, v11, 0x41880000, v12
  v_cos_f32 v29, v29
  v_fmamk_f32 v30, v11, 0x41900000, v12
  v_cos_f32 v30, v30
  v_fmamk_f32 v31, v11, 0x41980000, v12
  v_cos_f32 v31, v31
  v_cvt_pk_bf16_f32 v16, v24, v25
  v_cvt_pk_bf16_f32 v17, v26, v27
  v_cvt_pk_bf16_f32 v18, v28, v29
  v_cvt_pk_bf16_f32 v19, v30, v31
  v_fmamk_f32 v24, v11, 0x42000000, v12
  v_cos_f32 v24, v24
  v_fmamk_f32 v25, v11, 0x42040000, v12
  v_cos_f32 v25, v25
  v_fmamk_f32 v26, v11, 0x42080000, v12
  v_cos_f32 v26, v26
  v_fmamk_f32 v27, v11, 0x420c0000, v12
  v_cos_f32 v27, v27
  v_fmamk_f32 v28, v11, 0x42400000, v12
  v_cos_f32 v28, v28
  v_fmamk_f32 v29, v11, 0x42440000, v12
  v_cos_f32 v29, v29
  v_fmamk_f32 v30, v11, 0x42480000, v12
  v_cos_f32 v30, v30
  v_fmamk_f32 v31, v11, 0x424c0000, v12
  v_cos_f32 v31, v31
  v_cvt_pk_bf16_f32 v20, v24, v25
  v_cvt_pk_bf16_f32 v21, v26, v27
  v_cvt_pk_bf16_f32 v22, v28, v29
  v_cvt_pk_bf16_f32 v23, v30, v31
  v_mul_u32_u24 v14, 288, v1
  v_lshl_add_u32 v14, v2, 3, v14
  v_bfe_u32 v15, v0, 2, 4
  v_mul_u32_u24 v15, 288, v15
  v_lshl_add_u32 v15, v2, 3, v15
  v_lshl_add_u32 v9, v7, 2, v10
  v_mul_u32_u24 v9, 163840, v9
  v_lshl_add_u32 v9, v8, 4, v9
  s_lshl_b32 s44, s6, 8
  s_add_u32 s44, s44, s7
  s_add_u32 s44, s44, 745472
  s_add_u32 s45, s44, 40960
  s_add_u32 s46, s44, 81920
  s_add_u32 s47, s44, 122880
  s_mov_b32 s48, 0x3f803f80
  s_mov_b32 s49, 0xffff0000
  v_mov_b32 v24, 0
  v_mov_b32 v25, 0
  v_mov_b32 v26, 0
  v_mov_b32 v27, 0
  s_waitcnt vmcnt(20)
  v_dot2c_f32_bf16 v24, s48, v32
  v_dot2c_f32_bf16 v26, v32, v32
  v_dot2c_f32_bf16 v25, s48, v33
  v_dot2c_f32_bf16 v27, v33, v33
  v_dot2c_f32_bf16 v24, s48, v34
  v_dot2c_f32_bf16 v26, v34, v34
  v_dot2c_f32_bf16 v25, s48, v35
  v_dot2c_f32_bf16 v27, v35, v35
  s_waitcnt vmcnt(19)
  v_dot2c_f32_bf16 v24, s48, v44
  v_dot2c_f32_bf16 v26, v44, v44
  v_dot2c_f32_bf16 v25, s48, v45
  v_dot2c_f32_bf16 v27, v45, v45
  v_dot2c_f32_bf16 v24, s48, v46
  v_dot2c_f32_bf16 v26, v46, v46
  v_dot2c_f32_bf16 v25, s48, v47
  v_dot2c_f32_bf16 v27, v47, v47
  s_waitcnt vmcnt(18)
  v_dot2c_f32_bf16 v24, s48, v36
  v_dot2c_f32_bf16 v26, v36, v36
  v_dot2c_f32_bf16 v25, s48, v37
  v_dot2c_f32_bf16 v27, v37, v37
  v_dot2c_f32_bf16 v24, s48, v38
  v_dot2c_f32_bf16 v26, v38, v38
  v_dot2c_f32_bf16 v25, s48, v39
  v_dot2c_f32_bf16 v27, v39, v39
  s_waitcnt vmcnt(17)
  v_dot2c_f32_bf16 v24, s48, v40
  v_dot2c_f32_bf16 v26, v40, v40
  v_dot2c_f32_bf16 v25, s48, v41
  v_dot2c_f32_bf16 v27, v41, v41
  v_dot2c_f32_bf16 v24, s48, v42
  v_dot2c_f32_bf16 v26, v42, v42
  v_dot2c_f32_bf16 v25, s48, v43
  v_dot2c_f32_bf16 v27, v43, v43
  s_waitcnt vmcnt(16)
  v_dot2c_f32_bf16 v24, s48, v48
  v_dot2c_f32_bf16 v26, v48, v48
  v_dot2c_f32_bf16 v25, s48, v49
  v_dot2c_f32_bf16 v27, v49, v49
  v_dot2c_f32_bf16 v24, s48, v50
  v_dot2c_f32_bf16 v26, v50, v50
  v_dot2c_f32_bf16 v25, s48, v51
  v_dot2c_f32_bf16 v27, v51, v51
  s_waitcnt vmcnt(15)
  v_dot2c_f32_bf16 v24, s48, v60
  v_dot2c_f32_bf16 v26, v60, v60
  v_dot2c_f32_bf16 v25, s48, v61
  v_dot2c_f32_bf16 v27, v61, v61
  v_dot2c_f32_bf16 v24, s48, v62
  v_dot2c_f32_bf16 v26, v62, v62
  v_dot2c_f32_bf16 v25, s48, v63
  v_dot2c_f32_bf16 v27, v63, v63
  s_waitcnt vmcnt(14)
  v_dot2c_f32_bf16 v24, s48, v52
  v_dot2c_f32_bf16 v26, v52, v52
  v_dot2c_f32_bf16 v25, s48, v53
  v_dot2c_f32_bf16 v27, v53, v53
  v_dot2c_f32_bf16 v24, s48, v54
  v_dot2c_f32_bf16 v26, v54, v54
  v_dot2c_f32_bf16 v25, s48, v55
  v_dot2c_f32_bf16 v27, v55, v55
  s_waitcnt vmcnt(13)
  v_dot2c_f32_bf16 v24, s48, v56
  v_dot2c_f32_bf16 v26, v56, v56
  v_dot2c_f32_bf16 v25, s48, v57
  v_dot2c_f32_bf16 v27, v57, v57
  v_dot2c_f32_bf16 v24, s48, v58
  v_dot2c_f32_bf16 v26, v58, v58
  v_dot2c_f32_bf16 v25, s48, v59
  v_dot2c_f32_bf16 v27, v59, v59
  s_waitcnt vmcnt(12)
  v_dot2c_f32_bf16 v24, s48, v64
  v_dot2c_f32_bf16 v26, v64, v64
  v_dot2c_f32_bf16 v25, s48, v65
  v_dot2c_f32_bf16 v27, v65, v65
  v_dot2c_f32_bf16 v24, s48, v66
  v_dot2c_f32_bf16 v26, v66, v66
  v_dot2c_f32_bf16 v25, s48, v67
  v_dot2c_f32_bf16 v27, v67, v67
  s_waitcnt vmcnt(11)
  v_dot2c_f32_bf16 v24, s48, v76
  v_dot2c_f32_bf16 v26, v76, v76
  v_dot2c_f32_bf16 v25, s48, v77
  v_dot2c_f32_bf16 v27, v77, v77
  v_dot2c_f32_bf16 v24, s48, v78
  v_dot2c_f32_bf16 v26, v78, v78
  v_dot2c_f32_bf16 v25, s48, v79
  v_dot2c_f32_bf16 v27, v79, v79
  s_waitcnt vmcnt(10)
  v_dot2c_f32_bf16 v24, s48, v68
  v_dot2c_f32_bf16 v26, v68, v68
  v_dot2c_f32_bf16 v25, s48, v69
  v_dot2c_f32_bf16 v27, v69, v69
  v_dot2c_f32_bf16 v24, s48, v70
  v_dot2c_f32_bf16 v26, v70, v70
  v_dot2c_f32_bf16 v25, s48, v71
  v_dot2c_f32_bf16 v27, v71, v71
  s_waitcnt vmcnt(9)
  v_dot2c_f32_bf16 v24, s48, v72
  v_dot2c_f32_bf16 v26, v72, v72
  v_dot2c_f32_bf16 v25, s48, v73
  v_dot2c_f32_bf16 v27, v73, v73
  v_dot2c_f32_bf16 v24, s48, v74
  v_dot2c_f32_bf16 v26, v74, v74
  v_dot2c_f32_bf16 v25, s48, v75
  v_dot2c_f32_bf16 v27, v75, v75
  s_waitcnt vmcnt(8)
  v_dot2c_f32_bf16 v24, s48, v80
  v_dot2c_f32_bf16 v26, v80, v80
  v_dot2c_f32_bf16 v25, s48, v81
  v_dot2c_f32_bf16 v27, v81, v81
  v_dot2c_f32_bf16 v24, s48, v82
  v_dot2c_f32_bf16 v26, v82, v82
  v_dot2c_f32_bf16 v25, s48, v83
  v_dot2c_f32_bf16 v27, v83, v83
  s_waitcnt vmcnt(7)
  v_dot2c_f32_bf16 v24, s48, v92
  v_dot2c_f32_bf16 v26, v92, v92
  v_dot2c_f32_bf16 v25, s48, v93
  v_dot2c_f32_bf16 v27, v93, v93
  v_dot2c_f32_bf16 v24, s48, v94
  v_dot2c_f32_bf16 v26, v94, v94
  v_dot2c_f32_bf16 v25, s48, v95
  v_dot2c_f32_bf16 v27, v95, v95
  s_waitcnt vmcnt(6)
  v_dot2c_f32_bf16 v24, s48, v84
  v_dot2c_f32_bf16 v26, v84, v84
  v_dot2c_f32_bf16 v25, s48, v85
  v_dot2c_f32_bf16 v27, v85, v85
  v_dot2c_f32_bf16 v24, s48, v86
  v_dot2c_f32_bf16 v26, v86, v86
  v_dot2c_f32_bf16 v25, s48, v87
  v_dot2c_f32_bf16 v27, v87, v87
  s_waitcnt vmcnt(5)
  v_dot2c_f32_bf16 v24, s48, v88
  v_dot2c_f32_bf16 v26, v88, v88
  v_dot2c_f32_bf16 v25, s48, v89
  v_dot2c_f32_bf16 v27, v89, v89
  v_dot2c_f32_bf16 v24, s48, v90
  v_dot2c_f32_bf16 v26, v90, v90
  v_dot2c_f32_bf16 v25, s48, v91
  v_dot2c_f32_bf16 v27, v91, v91
  s_waitcnt vmcnt(4)
  v_dot2c_f32_bf16 v24, s48, v96
  v_dot2c_f32_bf16 v26, v96, v96
  v_dot2c_f32_bf16 v25, s48, v97
  v_dot2c_f32_bf16 v27, v97, v97
  v_dot2c_f32_bf16 v24, s48, v98
  v_dot2c_f32_bf16 v26, v98, v98
  v_dot2c_f32_bf16 v25, s48, v99
  v_dot2c_f32_bf16 v27, v99, v99
  s_waitcnt vmcnt(3)
  v_dot2c_f32_bf16 v24, s48, v108
  v_dot2c_f32_bf16 v26, v108, v108
  v_dot2c_f32_bf16 v25, s48, v109
  v_dot2c_f32_bf16 v27, v109, v109
  v_dot2c_f32_bf16 v24, s48, v110
  v_dot2c_f32_bf16 v26, v110, v110
  v_dot2c_f32_bf16 v25, s48, v111
  v_dot2c_f32_bf16 v27, v111, v111
  s_waitcnt vmcnt(2)
  v_dot2c_f32_bf16 v24, s48, v100
  v_dot2c_f32_bf16 v26, v100, v100
  v_dot2c_f32_bf16 v25, s48, v101
  v_dot2c_f32_bf16 v27, v101, v101
  v_dot2c_f32_bf16 v24, s48, v102
  v_dot2c_f32_bf16 v26, v102, v102
  v_dot2c_f32_bf16 v25, s48, v103
  v_dot2c_f32_bf16 v27, v103, v103
  s_waitcnt vmcnt(1)
  v_dot2c_f32_bf16 v24, s48, v104
  v_dot2c_f32_bf16 v26, v104, v104
  v_dot2c_f32_bf16 v25, s48, v105
  v_dot2c_f32_bf16 v27, v105, v105
  v_dot2c_f32_bf16 v24, s48, v106
  v_dot2c_f32_bf16 v26, v106, v106
  v_dot2c_f32_bf16 v25, s48, v107
  v_dot2c_f32_bf16 v27, v107, v107
  s_nop 1
  v_add_f32 v24, v24, v25
  v_add_f32 v26, v26, v27
  s_nop 0
  v_add_f32_dpp v24, v24, v24 quad_perm:[1,0,3,2] row_mask:0xf bank_mask:0xf
  v_add_f32_dpp v26, v26, v26 quad_perm:[1,0,3,2] row_mask:0xf bank_mask:0xf
  s_nop 0
  v_add_f32_dpp v24, v24, v24 quad_perm:[2,3,0,1] row_mask:0xf bank_mask:0xf
  v_add_f32_dpp v26, v26, v26 quad_perm:[2,3,0,1] row_mask:0xf bank_mask:0xf
  v_mul_f32 v24, 0x3acccccd, v24
  v_mul_f32 v26, 0x3acccccd, v26
  v_fma_f32 v26, -v24, v24, v26
  v_max_f32 v26, 0, v26
  v_add_f32 v26, 0x3727c5ac, v26
  v_rsq_f32 v26, v26
  s_nop 0
  v_mul_f32 v28, v24, v26
  v_mov_b32 v27, v26
  v_sub_f32 v28, 0, v28
  v_mov_b32 v29, v28
  v_lshlrev_b32 v48, 16, v32
  v_and_b32 v49, s49, v32
  v_lshlrev_b32 v50, 16, v33
  v_and_b32 v51, s49, v33
  v_lshlrev_b32 v52, 16, v34
  v_and_b32 v53, s49, v34
  v_lshlrev_b32 v54, 16, v35
  v_and_b32 v55, s49, v35
  v_pk_fma_f32 v[48:49], v[48:49], v[26:27], v[28:29]
  v_pk_fma_f32 v[50:51], v[50:51], v[26:27], v[28:29]
  v_pk_fma_f32 v[52:53], v[52:53], v[26:27], v[28:29]
  v_pk_fma_f32 v[54:55], v[54:55], v[26:27], v[28:29]
  v_lshlrev_b32 v56, 16, v36
  v_and_b32 v57, s49, v36
  v_lshlrev_b32 v58, 16, v37
  v_and_b32 v59, s49, v37
  v_lshlrev_b32 v60, 16, v38
  v_and_b32 v61, s49, v38
  v_lshlrev_b32 v62, 16, v39
  v_and_b32 v63, s49, v39
  v_pk_fma_f32 v[56:57], v[56:57], v[26:27], v[28:29]
  v_pk_fma_f32 v[58:59], v[58:59], v[26:27], v[28:29]
  v_pk_fma_f32 v[60:61], v[60:61], v[26:27], v[28:29]
  v_pk_fma_f32 v[62:63], v[62:63], v[26:27], v[28:29]
  v_lshlrev_b32 v64, 16, v40
  v_and_b32 v65, s49, v40
  v_lshlrev_b32 v66, 16, v41
  v_and_b32 v67, s49, v41
  v_lshlrev_b32 v68, 16, v42
  v_and_b32 v69, s49, v42
  v_lshlrev_b32 v70, 16, v43
  v_and_b32 v71, s49, v43
  v_pk_fma_f32 v[64:65], v[64:65], v[26:27], v[28:29]
  v_pk_fma_f32 v[66:67], v[66:67], v[26:27], v[28:29]
  v_pk_fma_f32 v[68:69], v[68:69], v[26:27], v[28:29]
  v_pk_fma_f32 v[70:71], v[70:71], v[26:27], v[28:29]
  v_lshlrev_b32 v72, 16, v44
  v_and_b32 v73, s49, v44
  v_lshlrev_b32 v74, 16, v45
  v_and_b32 v75, s49, v45
  v_lshlrev_b32 v76, 16, v46
  v_and_b32 v77, s49, v46
  v_lshlrev_b32 v78, 16, v47
  v_and_b32 v79, s49, v47
  v_pk_fma_f32 v[72:73], v[72:73], v[26:27], v[28:29]
  v_pk_fma_f32 v[74:75], v[74:75], v[26:27], v[28:29]
  v_pk_fma_f32 v[76:77], v[76:77], v[26:27], v[28:29]
  v_pk_fma_f32 v[78:79], v[78:79], v[26:27], v[28:29]
  v_cvt_pk_bf16_f32 v80, v48, v50
  v_cvt_pk_bf16_f32 v81, v52, v54
  ds_write_b64 v14, v[80:81] offset:0
  v_cvt_pk_bf16_f32 v82, v56, v58
  v_cvt_pk_bf16_f32 v83, v60, v62
  ds_write_b64 v14, v[82:83] offset:32
  v_cvt_pk_bf16_f32 v84, v71, v69
  v_cvt_pk_bf16_f32 v85, v67, v65
  ds_write_b64 v14, v[84:85] offset:64
  v_cvt_pk_bf16_f32 v86, v79, v77
  v_cvt_pk_bf16_f32 v87, v75, v73
  ds_write_b64 v14, v[86:87] offset:96
  v_cvt_pk_bf16_f32 v88, v49, v51
  v_cvt_pk_bf16_f32 v89, v53, v55
  ds_write_b64 v14, v[88:89] offset:128
  v_cvt_pk_bf16_f32 v90, v57, v59
  v_cvt_pk_bf16_f32 v91, v61, v63
  ds_write_b64 v14, v[90:91] offset:160
  v_cvt_pk_bf16_f32 v92, v70, v68
  v_cvt_pk_bf16_f32 v93, v66, v64
  ds_write_b64 v14, v[92:93] offset:192
  v_cvt_pk_bf16_f32 v94, v78, v76
  v_cvt_pk_bf16_f32 v95, v74, v72
  ds_write_b64 v14, v[94:95] offset:224
  s_waitcnt lgkmcnt(0)
  s_barrier
  ds_read_b64_tr_b16 v[32:33], v15 offset:0
  ds_read_b64_tr_b16 v[34:35], v15 offset:4608
  ds_read_b64_tr_b16 v[36:37], v15 offset:9216
  ds_read_b64_tr_b16 v[38:39], v15 offset:13824
  ds_read_b64_tr_b16 v[40:41], v15 offset:32
  ds_read_b64_tr_b16 v[42:43], v15 offset:4640
  ds_read_b64_tr_b16 v[44:45], v15 offset:9248
  ds_read_b64_tr_b16 v[46:47], v15 offset:13856
  ds_read_b64_tr_b16 v[48:49], v15 offset:64
  ds_read_b64_tr_b16 v[50:51], v15 offset:4672
  ds_read_b64_tr_b16 v[52:53], v15 offset:9280
  ds_read_b64_tr_b16 v[54:55], v15 offset:13888
  ds_read_b64_tr_b16 v[56:57], v15 offset:96
  ds_read_b64_tr_b16 v[58:59], v15 offset:4704
  ds_read_b64_tr_b16 v[60:61], v15 offset:9312
  ds_read_b64_tr_b16 v[62:63], v15 offset:13920
  ds_read_b64_tr_b16 v[64:65], v15 offset:128
  ds_read_b64_tr_b16 v[66:67], v15 offset:4736
  ds_read_b64_tr_b16 v[68:69], v15 offset:9344
  ds_read_b64_tr_b16 v[70:71], v15 offset:13952
  ds_read_b64_tr_b16 v[72:73], v15 offset:160
  ds_read_b64_tr_b16 v[74:75], v15 offset:4768
  ds_read_b64_tr_b16 v[76:77], v15 offset:9376
  ds_read_b64_tr_b16 v[78:79], v15 offset:13984
  ds_read_b64_tr_b16 v[80:81], v15 offset:192
  ds_read_b64_tr_b16 v[82:83], v15 offset:4800
  ds_read_b64_tr_b16 v[84:85], v15 offset:9408
  ds_read_b64_tr_b16 v[86:87], v15 offset:14016
  ds_read_b64_tr_b16 v[88:89], v15 offset:224
  ds_read_b64_tr_b16 v[90:91], v15 offset:4832
  ds_read_b64_tr_b16 v[92:93], v15 offset:9440
  ds_read_b64_tr_b16 v[94:95], v15 offset:14048
  s_waitcnt lgkmcnt(15)
  v_mfma_f32_16x16x32_bf16 v[96:99], v[16:19], v[32:35], 0
  v_mfma_f32_16x16x32_bf16 v[96:99], v[20:23], v[36:39], v[96:99]
  v_mfma_f32_16x16x32_bf16 v[100:103], v[16:19], v[40:43], 0
  v_mfma_f32_16x16x32_bf16 v[100:103], v[20:23], v[44:47], v[100:103]
  v_mfma_f32_16x16x32_bf16 v[104:107], v[16:19], v[48:51], 0
  v_mfma_f32_16x16x32_bf16 v[104:107], v[20:23], v[52:55], v[104:107]
  v_mfma_f32_16x16x32_bf16 v[108:111], v[16:19], v[56:59], 0
  v_mfma_f32_16x16x32_bf16 v[108:111], v[20:23], v[60:63], v[108:111]
  s_waitcnt lgkmcnt(14)
  v_mfma_f32_16x16x32_bf16 v[112:115], v[16:19], v[64:67], 0
  s_waitcnt lgkmcnt(12)
  v_mfma_f32_16x16x32_bf16 v[112:115], v[20:23], v[68:71], v[112:115]
  s_waitcnt lgkmcnt(10)
  v_mfma_f32_16x16x32_bf16 v[116:119], v[16:19], v[72:75], 0
  s_waitcnt lgkmcnt(8)
  v_mfma_f32_16x16x32_bf16 v[116:119], v[20:23], v[76:79], v[116:119]
  s_waitcnt lgkmcnt(6)
  v_mfma_f32_16x16x32_bf16 v[120:123], v[16:19], v[80:83], 0
  s_waitcnt lgkmcnt(4)
  v_mfma_f32_16x16x32_bf16 v[120:123], v[20:23], v[84:87], v[120:123]
  s_waitcnt lgkmcnt(2)
  v_mfma_f32_16x16x32_bf16 v[124:127], v[16:19], v[88:91], 0
  s_waitcnt lgkmcnt(0)
  v_mfma_f32_16x16x32_bf16 v[124:127], v[20:23], v[92:95], v[124:127]
  v_cvt_pk_bf16_f32 v32, v96, v100
  v_cvt_pk_bf16_f32 v33, v104, v108
  v_cvt_pk_bf16_f32 v34, v112, v116
  s_nop 4
  v_cvt_pk_bf16_f32 v35, v120, v124
  buffer_store_dwordx4 v[32:35], v9, s[36:39], s44 offen sc1
  v_cvt_pk_bf16_f32 v36, v97, v101
  v_cvt_pk_bf16_f32 v37, v105, v109
  v_cvt_pk_bf16_f32 v38, v113, v117
  v_cvt_pk_bf16_f32 v39, v121, v125
  buffer_store_dwordx4 v[36:39], v9, s[36:39], s45 offen sc1
  v_cvt_pk_bf16_f32 v40, v98, v102
  v_cvt_pk_bf16_f32 v41, v106, v110
  v_cvt_pk_bf16_f32 v42, v114, v118
  v_cvt_pk_bf16_f32 v43, v122, v126
  buffer_store_dwordx4 v[40:43], v9, s[36:39], s46 offen sc1
  v_cvt_pk_bf16_f32 v44, v99, v103
  v_cvt_pk_bf16_f32 v45, v107, v111
  v_cvt_pk_bf16_f32 v46, v115, v119
  v_cvt_pk_bf16_f32 v47, v123, v127
  buffer_store_dwordx4 v[44:47], v9, s[36:39], s47 offen sc1
  s_mov_b64 exec, -1
  s_branch P0_end
K0_notln:
  s_sub_u32 s4, s2, 248
  s_cmp_lt_u32 s4, 8
  s_cbranch_scc0 K0_ni
  s_cmp_ge_u32 s15, 1
  s_cbranch_scc1 P0_bar
  s_lshl_b32 s5, s4, 2
  s_mul_i32 s4, s4, 8192
  s_add_u32 s4, s4, 21733376
  v_mov_b32 v4, 0
  v_mov_b32 v5, 0
  v_mov_b32 v6, 0
  v_mov_b32 v7, 0
  v_and_b32 v2, 63, v0
  v_lshlrev_b32 v2, 4, v2
  v_mov_b32 v8, 1
  s_waitcnt lgkmcnt(0)
  s_mov_b32 s36, s30
  s_mov_b32 s37, s31
  s_mov_b32 s38, 21794816
  s_mov_b32 s39, 0x20000
  s_mov_b32 s40, s28
  s_mov_b32 s41, s29
  s_mov_b32 s42, 256
  s_mov_b32 s43, 0x20000
  buffer_store_dwordx4 v[4:7], v2, s[36:39], s4 offen offset:0 sc1
  buffer_store_dwordx4 v[4:7], v2, s[36:39], s4 offen offset:1024 sc1
  buffer_store_dwordx4 v[4:7], v2, s[36:39], s4 offen offset:2048 sc1
  buffer_store_dwordx4 v[4:7], v2, s[36:39], s4 offen offset:3072 sc1
  s_add_u32 s4, s4, 4096
  buffer_store_dwordx4 v[4:7], v2, s[36:39], s4 offen offset:0 sc1
  buffer_store_dwordx4 v[4:7], v2, s[36:39], s4 offen offset:1024 sc1
  buffer_store_dwordx4 v[4:7], v2, s[36:39], s4 offen offset:2048 sc1
  buffer_store_dwordx4 v[4:7], v2, s[36:39], s4 offen offset:3072 sc1
  buffer_load_dword v9, v4, s[40:43], 0 offen offset:128 sc0 sc1
  s_waitcnt vmcnt(0)
  s_mov_b64 exec, 1
  buffer_store_dword v8, v4, s[40:43], s5 offen sc0 sc1
  s_mov_b64 exec, -1
  s_branch P0_bar
K0_ni:
  s_sub_u32 s3, s2, 160
  s_cmp_lt_u32 s2, 180
  s_cbranch_scc1 K0_mod
  s_sub_u32 s3, s2, 188
  s_sub_u32 s4, s2, 208
  s_cmp_lt_u32 s4, 40
  s_cbranch_scc0 K0_pf
K0_mod:
  s_cmp_ge_u32 s15, 4
  s_cbranch_scc0 MOD_m
  v_and_b32 v2, 255, v0
  v_lshlrev_b32 v1, 1, v2
  v_lshlrev_b32 v5, 3, v2
  v_add_u32 v5, 131072, v5
  s_waitcnt lgkmcnt(0)
  s_mov_b32 s32, s22
  s_mov_b32 s33, s23
  s_mov_b32 s34, 1280
  s_mov_b32 s35, 0x20000
  buffer_load_ushort v8, v1, s[32:35], 0 offen offset:0
  buffer_load_ushort v9, v1, s[32:35], 0 offen offset:512
  buffer_load_ushort v10, v1, s[32:35], 0 offen offset:1024
  s_waitcnt vmcnt(2)
  v_lshlrev_b32 v8, 16, v8
  v_mul_f32 v11, 0xbfb8aa3b, v8
  v_exp_f32 v11, v11
  s_nop 0
  v_add_f32 v11, 1.0, v11
  v_rcp_f32 v11, v11
  s_nop 0
  v_mul_f32 v11, v8, v11
  v_cvt_pk_bf16_f32 v12, v11, 0
  v_lshlrev_b32 v13, 16, v12
  ds_write_b64 v5, v[12:13] offset:0
  s_waitcnt vmcnt(1)
  v_lshlrev_b32 v9, 16, v9
  v_mul_f32 v11, 0xbfb8aa3b, v9
  v_exp_f32 v11, v11
  s_nop 0
  v_add_f32 v11, 1.0, v11
  v_rcp_f32 v11, v11
  s_nop 0
  v_mul_f32 v11, v9, v11
  v_cvt_pk_bf16_f32 v14, v11, 0
  v_lshlrev_b32 v15, 16, v14
  ds_write_b64 v5, v[14:15] offset:2048
  s_waitcnt vmcnt(0)
  v_lshlrev_b32 v10, 16, v10
  v_mul_f32 v11, 0xbfb8aa3b, v10
  v_exp_f32 v11, v11
  s_nop 0
  v_add_f32 v11, 1.0, v11
  v_rcp_f32 v11, v11
  s_nop 0
  v_mul_f32 v11, v10, v11
  v_cvt_pk_bf16_f32 v16, v11, 0
  v_lshlrev_b32 v17, 16, v16
  ds_write_b64 v5, v[16:17] offset:4096
  s_waitcnt lgkmcnt(0)
  s_branch P0_bar
MOD_m:
  v_lshrrev_b32 v2, 3, v0
  v_and_b32 v3, 7, v0
  v_mul_u32_u24 v4, 153600, v2
  v_lshl_add_u32 v4, v3, 4, v4
  s_lshl_b32 s4, s3, 7
  v_mul_u32_u24 v6, 160, v2
  v_add_u32 v6, 131072, v6
  v_mov_b32 v7, 143360
  v_mov_b32 v1, 0
  ds_write_b32 v7, v1
  ds_write_b32 v7, v1 offset:4
  ds_write_b32 v7, v1 offset:8
  v_and_b32 v136, 7, v0
  v_lshlrev_b32 v136, 2, v136
  v_mov_b32 v128, 0
  v_mov_b32 v129, 0
  v_mov_b32 v130, 0
  v_mov_b32 v131, 0
  v_mov_b32 v132, 0
  v_mov_b32 v133, 0
  v_mov_b32 v134, 0
  v_mov_b32 v135, 0
  s_waitcnt lgkmcnt(0)
  s_mov_b32 s32, s24
  s_mov_b32 s33, s25
  s_mov_b32 s34, 4915200
  s_mov_b32 s35, 0x20000
  buffer_load_dwordx4 v[48:51], v4, s[32:35], s4 offen nt
  s_add_u32 s4, s4, 7680
  buffer_load_dwordx4 v[52:55], v4, s[32:35], s4 offen nt
  s_add_u32 s4, s4, 7680
  buffer_load_dwordx4 v[56:59], v4, s[32:35], s4 offen nt
  s_add_u32 s4, s4, 7680
  buffer_load_dwordx4 v[60:63], v4, s[32:35], s4 offen nt
  s_add_u32 s4, s4, 7680
  buffer_load_dwordx4 v[64:67], v4, s[32:35], s4 offen nt
  s_add_u32 s4, s4, 7680
  buffer_load_dwordx4 v[68:71], v4, s[32:35], s4 offen nt
  s_add_u32 s4, s4, 7680
  buffer_load_dwordx4 v[72:75], v4, s[32:35], s4 offen nt
  s_add_u32 s4, s4, 7680
  buffer_load_dwordx4 v[76:79], v4, s[32:35], s4 offen nt
  s_add_u32 s4, s4, 7680
  buffer_load_dwordx4 v[80:83], v4, s[32:35], s4 offen nt
  s_add_u32 s4, s4, 7680
  buffer_load_dwordx4 v[84:87], v4, s[32:35], s4 offen nt
  s_add_u32 s4, s4, 7680
  buffer_load_dwordx4 v[88:91], v4, s[32:35], s4 offen nt
  s_add_u32 s4, s4, 7680
  buffer_load_dwordx4 v[92:95], v4, s[32:35], s4 offen nt
  s_add_u32 s4, s4, 7680
  s_mov_b32 s36, s30
  s_mov_b32 s37, s31
  s_mov_b32 s38, 24416256
  s_mov_b32 s39, 0x20000
  s_mov_b32 s40, s28
  s_mov_b32 s41, s29
  s_mov_b32 s42, 256
  s_mov_b32 s43, 0x20000
  s_barrier
  ds_read_b128 v[8:11], v6 offset:0
  ds_read_b128 v[12:15], v6 offset:16
  ds_read_b128 v[16:19], v6 offset:32
  ds_read_b128 v[20:23], v6 offset:48
  ds_read_b128 v[24:27], v6 offset:64
  ds_read_b128 v[28:31], v6 offset:80
  ds_read_b128 v[32:35], v6 offset:96
  ds_read_b128 v[36:39], v6 offset:112
  ds_read_b128 v[40:43], v6 offset:128
  ds_read_b128 v[44:47], v6 offset:144
  buffer_load_dwordx4 v[96:99], v4, s[32:35], s4 offen nt
  s_add_u32 s4, s4, 7680
  s_waitcnt vmcnt(12) lgkmcnt(9)
  v_dot2c_f32_bf16 v128, v48, v8
  v_dot2c_f32_bf16 v129, v48, v9
  v_dot2c_f32_bf16 v130, v49, v8
  v_dot2c_f32_bf16 v131, v49, v9
  v_dot2c_f32_bf16 v132, v50, v8
  v_dot2c_f32_bf16 v133, v50, v9
  v_dot2c_f32_bf16 v134, v51, v8
  v_dot2c_f32_bf16 v135, v51, v9
  buffer_load_dwordx4 v[100:103], v4, s[32:35], s4 offen nt
  s_add_u32 s4, s4, 7680
  s_waitcnt vmcnt(12)
  v_dot2c_f32_bf16 v128, v52, v10
  v_dot2c_f32_bf16 v129, v52, v11
  v_dot2c_f32_bf16 v130, v53, v10
  v_dot2c_f32_bf16 v131, v53, v11
  v_dot2c_f32_bf16 v132, v54, v10
  v_dot2c_f32_bf16 v133, v54, v11
  v_dot2c_f32_bf16 v134, v55, v10
  v_dot2c_f32_bf16 v135, v55, v11
  buffer_load_dwordx4 v[104:107], v4, s[32:35], s4 offen nt
  s_add_u32 s4, s4, 7680
  s_waitcnt vmcnt(12) lgkmcnt(8)
  v_dot2c_f32_bf16 v128, v56, v12
  v_dot2c_f32_bf16 v129, v56, v13
  v_dot2c_f32_bf16 v130, v57, v12
  v_dot2c_f32_bf16 v131, v57, v13
  v_dot2c_f32_bf16 v132, v58, v12
  v_dot2c_f32_bf16 v133, v58, v13
  v_dot2c_f32_bf16 v134, v59, v12
  v_dot2c_f32_bf16 v135, v59, v13
  buffer_load_dwordx4 v[108:111], v4, s[32:35], s4 offen nt
  s_add_u32 s4, s4, 7680
  s_waitcnt vmcnt(12)
  v_dot2c_f32_bf16 v128, v60, v14
  v_dot2c_f32_bf16 v129, v60, v15
  v_dot2c_f32_bf16 v130, v61, v14
  v_dot2c_f32_bf16 v131, v61, v15
  v_dot2c_f32_bf16 v132, v62, v14
  v_dot2c_f32_bf16 v133, v62, v15
  v_dot2c_f32_bf16 v134, v63, v14
  v_dot2c_f32_bf16 v135, v63, v15
  buffer_load_dwordx4 v[112:115], v4, s[32:35], s4 offen nt
  s_add_u32 s4, s4, 7680
  s_waitcnt vmcnt(12) lgkmcnt(7)
  v_dot2c_f32_bf16 v128, v64, v16
  v_dot2c_f32_bf16 v129, v64, v17
  v_dot2c_f32_bf16 v130, v65, v16
  v_dot2c_f32_bf16 v131, v65, v17
  v_dot2c_f32_bf16 v132, v66, v16
  v_dot2c_f32_bf16 v133, v66, v17
  v_dot2c_f32_bf16 v134, v67, v16
  v_dot2c_f32_bf16 v135, v67, v17
  buffer_load_dwordx4 v[116:119], v4, s[32:35], s4 offen nt
  s_add_u32 s4, s4, 7680
  s_waitcnt vmcnt(12)
  v_dot2c_f32_bf16 v128, v68, v18
  v_dot2c_f32_bf16 v129, v68, v19
  v_dot2c_f32_bf16 v130, v69, v18
  v_dot2c_f32_bf16 v131, v69, v19
  v_dot2c_f32_bf16 v132, v70, v18
  v_dot2c_f32_bf16 v133, v70, v19
  v_dot2c_f32_bf16 v134, v71, v18
  v_dot2c_f32_bf16 v135, v71, v19
  buffer_load_dwordx4 v[120:123], v4, s[32:35], s4 offen nt
  s_add_u32 s4, s4, 7680
  s_waitcnt vmcnt(12) lgkmcnt(6)
  v_dot2c_f32_bf16 v128, v72, v20
  v_dot2c_f32_bf16 v129, v72, v21
  v_dot2c_f32_bf16 v130, v73, v20
  v_dot2c_f32_bf16 v131, v73, v21
  v_dot2c_f32_bf16 v132, v74, v20
  v_dot2c_f32_bf16 v133, v74, v21
  v_dot2c_f32_bf16 v134, v75, v20
  v_dot2c_f32_bf16 v135, v75, v21
  buffer_load_dwordx4 v[124:127], v4, s[32:35], s4 offen nt
  s_add_u32 s4, s4, 7680
  s_waitcnt vmcnt(12)
  v_dot2c_f32_bf16 v128, v76, v22
  v_dot2c_f32_bf16 v129, v76, v23
  v_dot2c_f32_bf16 v130, v77, v22
  v_dot2c_f32_bf16 v131, v77, v23
  v_dot2c_f32_bf16 v132, v78, v22
  v_dot2c_f32_bf16 v133, v78, v23
  v_dot2c_f32_bf16 v134, v79, v22
  v_dot2c_f32_bf16 v135, v79, v23
  buffer_load_dword v137, v136, s[40:43], 0 offen sc0 sc1
  s_waitcnt vmcnt(12) lgkmcnt(5)
  v_dot2c_f32_bf16 v128, v80, v24
  v_dot2c_f32_bf16 v129, v80, v25
  v_dot2c_f32_bf16 v130, v81, v24
  v_dot2c_f32_bf16 v131, v81, v25
  v_dot2c_f32_bf16 v132, v82, v24
  v_dot2c_f32_bf16 v133, v82, v25
  v_dot2c_f32_bf16 v134, v83, v24
  v_dot2c_f32_bf16 v135, v83, v25
  s_waitcnt vmcnt(11)
  v_dot2c_f32_bf16 v128, v84, v26
  v_dot2c_f32_bf16 v129, v84, v27
  v_dot2c_f32_bf16 v130, v85, v26
  v_dot2c_f32_bf16 v131, v85, v27
  v_dot2c_f32_bf16 v132, v86, v26
  v_dot2c_f32_bf16 v133, v86, v27
  v_dot2c_f32_bf16 v134, v87, v26
  v_dot2c_f32_bf16 v135, v87, v27
  s_waitcnt vmcnt(10) lgkmcnt(4)
  v_dot2c_f32_bf16 v128, v88, v28
  v_dot2c_f32_bf16 v129, v88, v29
  v_dot2c_f32_bf16 v130, v89, v28
  v_dot2c_f32_bf16 v131, v89, v29
  v_dot2c_f32_bf16 v132, v90, v28
  v_dot2c_f32_bf16 v133, v90, v29
  v_dot2c_f32_bf16 v134, v91, v28
  v_dot2c_f32_bf16 v135, v91, v29
  s_waitcnt vmcnt(9)
  v_dot2c_f32_bf16 v128, v92, v30
  v_dot2c_f32_bf16 v129, v92, v31
  v_dot2c_f32_bf16 v130, v93, v30
  v_dot2c_f32_bf16 v131, v93, v31
  v_dot2c_f32_bf16 v132, v94, v30
  v_dot2c_f32_bf16 v133, v94, v31
  v_dot2c_f32_bf16 v134, v95, v30
  v_dot2c_f32_bf16 v135, v95, v31
  s_waitcnt vmcnt(8) lgkmcnt(3)
  v_dot2c_f32_bf16 v128, v96, v32
  v_dot2c_f32_bf16 v129, v96, v33
  v_dot2c_f32_bf16 v130, v97, v32
  v_dot2c_f32_bf16 v131, v97, v33
  v_dot2c_f32_bf16 v132, v98, v32
  v_dot2c_f32_bf16 v133, v98, v33
  v_dot2c_f32_bf16 v134, v99, v32
  v_dot2c_f32_bf16 v135, v99, v33
  s_waitcnt vmcnt(7)
  v_dot2c_f32_bf16 v128, v100, v34
  v_dot2c_f32_bf16 v129, v100, v35
  v_dot2c_f32_bf16 v130, v101, v34
  v_dot2c_f32_bf16 v131, v101, v35
  v_dot2c_f32_bf16 v132, v102, v34
  v_dot2c_f32_bf16 v133, v102, v35
  v_dot2c_f32_bf16 v134, v103, v34
  v_dot2c_f32_bf16 v135, v103, v35
  s_waitcnt vmcnt(6) lgkmcnt(2)
  v_dot2c_f32_bf16 v128, v104, v36
  v_dot2c_f32_bf16 v129, v104, v37
  v_dot2c_f32_bf16 v130, v105, v36
  v_dot2c_f32_bf16 v131, v105, v37
  v_dot2c_f32_bf16 v132, v106, v36
  v_dot2c_f32_bf16 v133, v106, v37
  v_dot2c_f32_bf16 v134, v107, v36
  v_dot2c_f32_bf16 v135, v107, v37
  s_waitcnt vmcnt(5)
  v_dot2c_f32_bf16 v128, v108, v38
  v_dot2c_f32_bf16 v129, v108, v39
  v_dot2c_f32_bf16 v130, v109, v38
  v_dot2c_f32_bf16 v131, v109, v39
  v_dot2c_f32_bf16 v132, v110, v38
  v_dot2c_f32_bf16 v133, v110, v39
  v_dot2c_f32_bf16 v134, v111, v38
  v_dot2c_f32_bf16 v135, v111, v39
  s_waitcnt vmcnt(4) lgkmcnt(1)
  v_dot2c_f32_bf16 v128, v112, v40
  v_dot2c_f32_bf16 v129, v112, v41
  v_dot2c_f32_bf16 v130, v113, v40
  v_dot2c_f32_bf16 v131, v113, v41
  v_dot2c_f32_bf16 v132, v114, v40
  v_dot2c_f32_bf16 v133, v114, v41
  v_dot2c_f32_bf16 v134, v115, v40
  v_dot2c_f32_bf16 v135, v115, v41
  s_waitcnt vmcnt(3)
  v_dot2c_f32_bf16 v128, v116, v42
  v_dot2c_f32_bf16 v129, v116, v43
  v_dot2c_f32_bf16 v130, v117, v42
  v_dot2c_f32_bf16 v131, v117, v43
  v_dot2c_f32_bf16 v132, v118, v42
  v_dot2c_f32_bf16 v133, v118, v43
  v_dot2c_f32_bf16 v134, v119, v42
  v_dot2c_f32_bf16 v135, v119, v43
  s_waitcnt vmcnt(2) lgkmcnt(0)
  v_dot2c_f32_bf16 v128, v120, v44
  v_dot2c_f32_bf16 v129, v120, v45
  v_dot2c_f32_bf16 v130, v121, v44
  v_dot2c_f32_bf16 v131, v121, v45
  v_dot2c_f32_bf16 v132, v122, v44
  v_dot2c_f32_bf16 v133, v122, v45
  v_dot2c_f32_bf16 v134, v123, v44
  v_dot2c_f32_bf16 v135, v123, v45
  s_waitcnt vmcnt(1)
  v_dot2c_f32_bf16 v128, v124, v46
  v_dot2c_f32_bf16 v129, v124, v47
  v_dot2c_f32_bf16 v130, v125, v46
  v_dot2c_f32_bf16 v131, v125, v47
  v_dot2c_f32_bf16 v132, v126, v46
  v_dot2c_f32_bf16 v133, v126, v47
  v_dot2c_f32_bf16 v134, v127, v46
  v_dot2c_f32_bf16 v135, v127, v47
  v_permlane32_swap_b32 v128, v132
  v_permlane32_swap_b32 v129, v133
  v_permlane32_swap_b32 v130, v134
  v_permlane32_swap_b32 v131, v135
  v_add_f32 v128, v128, v132
  v_add_f32 v129, v129, v133
  v_add_f32 v130, v130, v134
  v_add_f32 v131, v131, v135
  s_nop 0
  v_permlane16_swap_b32 v128, v130
  v_permlane16_swap_b32 v129, v131
  v_add_f32 v128, v128, v130
  v_add_f32 v129, v129, v131
  s_nop 0
  v_add_f32_dpp v128, v128, v128 row_ror:8 row_mask:0xf bank_mask:0xf
  v_add_f32_dpp v129, v129, v129 row_ror:8 row_mask:0xf bank_mask:0xf
  v_and_b32 v8, 8, v0
  v_cmp_eq_u32 vcc, 0, v8
  v_lshlrev_b32 v9, 2, v0
  s_nop 0
  v_cndmask_b32 v32, v129, v128, vcc
  v_add_u32 v9, 131072, v9
  s_cmp_eq_u32 s15, 0
  s_cbranch_scc1 MOD_w0
  ds_write_b32 v9, v32 offset:8192
  v_mov_b32 v1, 1
  s_mov_b64 exec, 1
  ds_add_u32 v7, v1
  s_mov_b64 exec, -1
  s_branch P0_end
MOD_w0:
  s_mul_i32 s5, s3, 205
  s_lshr_b32 s5, s5, 11
  s_mul_i32 s6, s5, 10
  s_sub_u32 s6, s3, s6
  s_lshl_b32 s6, s6, 6
  s_cmp_eq_u32 s5, 1
  s_cselect_b32 s7, 1.0, 0
  s_cmp_eq_u32 s5, 4
  s_cselect_b32 s7, 1.0, s7
  s_mul_i32 s44, s5, 1280
  s_lshl_b32 s45, s44, 1
  v_bfe_u32 v14, v0, 5, 1
  v_bfe_u32 v15, v0, 4, 1
  v_bfe_u32 v16, v0, 3, 1
  v_lshl_add_u32 v16, v15, 1, v16
  v_lshl_add_u32 v16, v14, 2, v16
  v_lshl_add_u32 v16, v3, 3, v16
  v_add_u32 v16, s6, v16
  v_lshlrev_b32 v17, 2, v16
  v_sub_u32 v18, 1279, v17
  v_cmp_lt_u32 vcc, 159, v16
  v_subrev_u32 v19, 1279, v17
  s_nop 0
  v_cndmask_b32 v20, v17, v18, vcc
  v_cmp_lt_u32 vcc, 319, v16
  v_sub_u32 v18, 2558, v17
  s_nop 0
  v_cndmask_b32 v20, v20, v19, vcc
  v_cmp_lt_u32 vcc, 479, v16
  v_lshlrev_b32 v21, 1, v16
  s_nop 0
  v_cndmask_b32 v20, v20, v18, vcc
  v_lshlrev_b32 v22, 1, v20
  v_lshlrev_b32 v23, 2, v20
  v_lshlrev_b32 v24, 15, v20
  v_and_b32 v24, 0x8000, v24
  s_mov_b32 s14, 0x200000
MOD_sp:
  ds_read_b32 v1, v7
  s_sub_u32 s14, s14, 1
  s_waitcnt lgkmcnt(0)
  v_readfirstlane_b32 s46, v1
  s_cmp_eq_u32 s14, 0
  s_cbranch_scc1 MOD_sg
  s_cmp_eq_u32 s46, 3
  s_cbranch_scc0 MOD_sp
MOD_sg:
  ds_read_b32 v33, v9 offset:8448
  ds_read_b32 v34, v9 offset:8704
  ds_read_b32 v35, v9 offset:8960
  s_waitcnt lgkmcnt(1)
  v_add_f32 v32, v32, v34
  s_waitcnt lgkmcnt(0)
  v_add_f32 v33, v33, v35
  v_add_f32 v32, v32, v33
  v_cvt_pk_bf16_f32 v10, v32, 0
  v_lshlrev_b32 v10, 16, v10
  v_add_f32 v10, s7, v10
  v_cvt_pk_bf16_f32 v10, v10, 0
  v_lshlrev_b32 v11, 16, v10
  v_xor_b32 v12, v24, v10
  v_mul_f32 v13, 0x35cccccd, v11
  s_cmp_ge_u32 s5, 2
  s_cbranch_scc1 MOD_late
  s_add_u32 s46, s44, 24576
  buffer_store_short v10, v22, s[36:39], s46 offen sc1
  s_add_u32 s46, s44, 32768
  buffer_store_short v12, v22, s[36:39], s46 offen sc1
  s_branch MOD_done
MOD_late:
  s_add_u32 s46, s44, 0
  buffer_store_short v10, v21, s[36:39], s46 offen sc1
  s_add_u32 s46, s45, 8192
  buffer_store_dword v11, v17, s[36:39], s46 offen sc1
  s_add_u32 s46, s45, 40960
  buffer_store_dword v13, v23, s[36:39], s46 offen sc1
  v_mov_b32 v40, 1
  v_mov_b32 v41, 0
  v_mov_b32 v42, 1
  v_lshlrev_b32 v43, 2, v0
  s_mov_b32 s4, 21792768
  s_mov_b32 s5, 21792896
  s_waitcnt vmcnt(3)
  v_cmp_ne_u32 vcc, 1, v137
  s_nop 4
  s_cbranch_vccz MOD_rk
  s_mov_b32 s14, 0x10000
  s_nop 4
SP_nm:
  buffer_load_dword v137, v136, s[40:43], 0 offen offset:0 sc0 sc1
  s_sub_u32 s14, s14, 1
  s_waitcnt vmcnt(0)
  v_cmp_ne_u32 vcc, 1, v137
  s_cmp_eq_u32 s14, 0
  s_cbranch_scc1 SG_nm
  s_nop 3
  s_cbranch_vccnz SP_nm
SG_nm:
  s_nop 1
MOD_rk:
  s_waitcnt vmcnt(0)
  s_mov_b64 exec, 1
  buffer_atomic_add v40, v41, s[36:39], s4 offen sc0 sc1
  s_waitcnt vmcnt(0)
  v_readfirstlane_b32 s4, v40
  s_mov_b64 exec, 255
  s_cmp_eq_u32 s4, 39
  s_cbranch_scc0 GA_s
  buffer_store_dword v42, v43, s[36:39], s5 offen sc0 sc1
GA_s:
  s_mov_b64 exec, -1
  s_mov_b64 exec, 1
  ds_add_u32 v7, v42
  s_mov_b64 exec, -1
MOD_done:
  s_mov_b64 exec, -1
  s_branch P0_end
K0_pf:
  s_sub_u32 s4, s2, 184
  s_cmp_ge_u32 s4, 20
  s_cbranch_scc1 K0_p2
  s_cmp_lt_u32 s15, 3
  s_cbranch_scc1 K0_p2
  v_subrev_u32 v2, 192, v0
  v_mul_u32_u24 v3, 205, v2
  v_lshrrev_b32 v3, 11, v3
  v_mul_u32_u24 v3, 10, v3
  v_add_u32 v2, v2, v3
  v_mul_u32_u24 v2, 7680, v2
  s_lshl_b32 s4, s4, 7
  s_add_u32 s4, s4, 76800
  s_waitcnt lgkmcnt(0)
  s_mov_b32 s40, s24
  s_mov_b32 s41, s25
  s_mov_b32 s42, 4915200
  s_mov_b32 s43, 0x20000
  buffer_load_dword v255, v2, s[40:43], s4 offen
K0_p2:
  v_and_b32 v0, 63, v0
  s_sub_u32 s7, s2, 180
  s_sub_u32 s6, s2, 192
  s_mul_i32 s6, s6, 3
  s_cmp_ge_u32 s2, 198
  s_cselect_b32 s7, s6, s7
  s_bfe_u32 s48, s15, 0x10001
  v_lshlrev_b32 v5, 4, v0
  v_lshrrev_b32 v16, 4, v0
  v_and_b32 v17, 15, v0
  s_lshl_b32 s52, s48, 3
  v_lshl_add_u32 v18, v16, 1, s52
  v_xor_b32 v18, v18, v17
  v_lshlrev_b32 v18, 4, v18
  v_mul_u32_u24 v19, 1280, v16
  v_add_u32 v18, v18, v19
  s_lshl_b32 s52, s7, 3
  s_add_u32 s52, s52, s15
  s_mul_i32 s52, s52, 5120
  s_mul_i32 m0, s15, 5120
  s_waitcnt lgkmcnt(0)
  s_mov_b32 s40, s20
  s_mov_b32 s41, s21
  s_mov_b32 s42, 1966080
  s_mov_b32 s43, 0x20000
  s_mov_b32 s36, s30
  s_mov_b32 s37, s31
  s_mov_b32 s38, 24416256
  s_mov_b32 s39, 0x20000
  buffer_load_dwordx4 v18, s[40:43], s52 offen nt lds
  s_add_u32 m0, m0, 1024
  s_add_u32 s52, s52, 256
  buffer_load_dwordx4 v18, s[40:43], s52 offen nt lds
  s_add_u32 m0, m0, 1024
  s_add_u32 s52, s52, 256
  buffer_load_dwordx4 v18, s[40:43], s52 offen nt lds
  s_add_u32 m0, m0, 1024
  s_add_u32 s52, s52, 256
  buffer_load_dwordx4 v18, s[40:43], s52 offen nt lds
  s_add_u32 m0, m0, 1024
  s_add_u32 s52, s52, 256
  buffer_load_dwordx4 v18, s[40:43], s52 offen nt lds
  s_add_u32 m0, m0, 1024
  s_add_u32 s52, s52, 256
  s_add_u32 m0, m0, 35840
  s_add_u32 s52, s52, 39680
  s_cmp_ge_u32 s2, 198
  s_cbranch_scc0 WD_d1
  buffer_load_dwordx4 v18, s[40:43], s52 offen nt lds
  s_add_u32 m0, m0, 1024
  s_add_u32 s52, s52, 256
  buffer_load_dwordx4 v18, s[40:43], s52 offen nt lds
  s_add_u32 m0, m0, 1024
  s_add_u32 s52, s52, 256
  buffer_load_dwordx4 v18, s[40:43], s52 offen nt lds
  s_add_u32 m0, m0, 1024
  s_add_u32 s52, s52, 256
  buffer_load_dwordx4 v18, s[40:43], s52 offen nt lds
  s_add_u32 m0, m0, 1024
  s_add_u32 s52, s52, 256
  buffer_load_dwordx4 v18, s[40:43], s52 offen nt lds
  s_add_u32 m0, m0, 1024
  s_add_u32 s52, s52, 256
  s_add_u32 m0, m0, 35840
  s_add_u32 s52, s52, 39680
  buffer_load_dwordx4 v18, s[40:43], s52 offen nt lds
  s_add_u32 m0, m0, 1024
  s_add_u32 s52, s52, 256
  buffer_load_dwordx4 v18, s[40:43], s52 offen nt lds
  s_add_u32 m0, m0, 1024
  s_add_u32 s52, s52, 256
  buffer_load_dwordx4 v18, s[40:43], s52 offen nt lds
  s_add_u32 m0, m0, 1024
  s_add_u32 s52, s52, 256
  buffer_load_dwordx4 v18, s[40:43], s52 offen nt lds
  s_add_u32 m0, m0, 1024
  s_add_u32 s52, s52, 256
  buffer_load_dwordx4 v18, s[40:43], s52 offen nt lds
  s_add_u32 m0, m0, 1024
  s_add_u32 s52, s52, 256
  s_add_u32 m0, m0, 35840
  s_add_u32 s52, s52, 39680
WD_d1:
  v_bfe_u32 v18, v0, 2, 2
  v_and_b32 v19, 3, v0
  v_and_b32 v61, 1, v16
  v_lshl_add_u32 v61, v61, 2, v18
  v_xor_b32 v61, s15, v61
  v_lshlrev_b32 v61, 5, v61
  v_mul_u32_u24 v16, 10240, v16
  v_lshl_add_u32 v16, v18, 8, v16
  v_lshl_add_u32 v16, v19, 3, v16
  v_add_u32 v61, v61, v16
  s_add_u32 s54, s15, 0
  s_mul_i32 s52, s54, 52
  s_lshr_b32 s52, s52, 8
  s_mul_i32 s53, s52, 235
  s_add_u32 s53, s53, s54
  s_mul_i32 s52, s7, 5
  s_add_u32 s53, s53, s52
  s_lshl_b32 s53, s53, 10
  s_add_u32 s56, s53, 13475840
  s_add_u32 s54, s15, 8
  s_mul_i32 s52, s54, 52
  s_lshr_b32 s52, s52, 8
  s_mul_i32 s53, s52, 235
  s_add_u32 s53, s53, s54
  s_mul_i32 s52, s7, 5
  s_add_u32 s53, s53, s52
  s_lshl_b32 s53, s53, 10
  s_add_u32 s57, s53, 13475840
  s_add_u32 s54, s15, 16
  s_mul_i32 s52, s54, 52
  s_lshr_b32 s52, s52, 8
  s_mul_i32 s53, s52, 235
  s_add_u32 s53, s53, s54
  s_mul_i32 s52, s7, 5
  s_add_u32 s53, s53, s52
  s_lshl_b32 s53, s53, 10
  s_add_u32 s58, s53, 13475840
  s_add_u32 s54, s15, 24
  s_mul_i32 s52, s54, 52
  s_lshr_b32 s52, s52, 8
  s_mul_i32 s53, s52, 235
  s_add_u32 s53, s53, s54
  s_mul_i32 s52, s7, 5
  s_add_u32 s53, s53, s52
  s_lshl_b32 s53, s53, 10
  s_add_u32 s59, s53, 13475840
  s_add_u32 s54, s15, 32
  s_mul_i32 s52, s54, 52
  s_lshr_b32 s52, s52, 8
  s_mul_i32 s53, s52, 235
  s_add_u32 s53, s53, s54
  s_mul_i32 s52, s7, 5
  s_add_u32 s53, s53, s52
  s_lshl_b32 s53, s53, 10
  s_add_u32 s60, s53, 13475840
  s_waitcnt vmcnt(0)
  s_barrier
  ds_read_b64_tr_b16 v[140:141], v61 offset:0
  ds_read_b64_tr_b16 v[142:143], v61 offset:5120
  ds_read_b64_tr_b16 v[144:145], v61 offset:1024
  ds_read_b64_tr_b16 v[146:147], v61 offset:6144
  ds_read_b64_tr_b16 v[148:149], v61 offset:2048
  ds_read_b64_tr_b16 v[150:151], v61 offset:7168
  ds_read_b64_tr_b16 v[152:153], v61 offset:3072
  ds_read_b64_tr_b16 v[154:155], v61 offset:8192
  ds_read_b64_tr_b16 v[156:157], v61 offset:4096
  ds_read_b64_tr_b16 v[158:159], v61 offset:9216
  s_waitcnt lgkmcnt(8)
  buffer_store_dwordx4 v[140:143], v5, s[36:39], s56 offen sc1
  s_waitcnt lgkmcnt(6)
  buffer_store_dwordx4 v[144:147], v5, s[36:39], s57 offen sc1
  s_waitcnt lgkmcnt(4)
  buffer_store_dwordx4 v[148:151], v5, s[36:39], s58 offen sc1
  s_waitcnt lgkmcnt(2)
  buffer_store_dwordx4 v[152:155], v5, s[36:39], s59 offen sc1
  s_waitcnt lgkmcnt(0)
  buffer_store_dwordx4 v[156:159], v5, s[36:39], s60 offen sc1
  v_add_u32 v61, 40960, v61
  v_add_u32 v5, 5120, v5
  s_cmp_ge_u32 s2, 198
  s_cbranch_scc0 K0_p3
  ds_read_b64_tr_b16 v[160:161], v61 offset:0
  ds_read_b64_tr_b16 v[162:163], v61 offset:5120
  ds_read_b64_tr_b16 v[164:165], v61 offset:1024
  ds_read_b64_tr_b16 v[166:167], v61 offset:6144
  ds_read_b64_tr_b16 v[168:169], v61 offset:2048
  ds_read_b64_tr_b16 v[170:171], v61 offset:7168
  ds_read_b64_tr_b16 v[172:173], v61 offset:3072
  ds_read_b64_tr_b16 v[174:175], v61 offset:8192
  ds_read_b64_tr_b16 v[176:177], v61 offset:4096
  ds_read_b64_tr_b16 v[178:179], v61 offset:9216
  s_waitcnt lgkmcnt(8)
  buffer_store_dwordx4 v[160:163], v5, s[36:39], s56 offen sc1
  s_waitcnt lgkmcnt(6)
  buffer_store_dwordx4 v[164:167], v5, s[36:39], s57 offen sc1
  s_waitcnt lgkmcnt(4)
  buffer_store_dwordx4 v[168:171], v5, s[36:39], s58 offen sc1
  s_waitcnt lgkmcnt(2)
  buffer_store_dwordx4 v[172:175], v5, s[36:39], s59 offen sc1
  s_waitcnt lgkmcnt(0)
  buffer_store_dwordx4 v[176:179], v5, s[36:39], s60 offen sc1
  v_add_u32 v61, 40960, v61
  v_add_u32 v5, 5120, v5
  ds_read_b64_tr_b16 v[180:181], v61 offset:0
  ds_read_b64_tr_b16 v[182:183], v61 offset:5120
  ds_read_b64_tr_b16 v[184:185], v61 offset:1024
  ds_read_b64_tr_b16 v[186:187], v61 offset:6144
  ds_read_b64_tr_b16 v[188:189], v61 offset:2048
  ds_read_b64_tr_b16 v[190:191], v61 offset:7168
  ds_read_b64_tr_b16 v[192:193], v61 offset:3072
  ds_read_b64_tr_b16 v[194:195], v61 offset:8192
  ds_read_b64_tr_b16 v[196:197], v61 offset:4096
  ds_read_b64_tr_b16 v[198:199], v61 offset:9216
  s_waitcnt lgkmcnt(8)
  buffer_store_dwordx4 v[180:183], v5, s[36:39], s56 offen sc1
  s_waitcnt lgkmcnt(6)
  buffer_store_dwordx4 v[184:187], v5, s[36:39], s57 offen sc1
  s_waitcnt lgkmcnt(4)
  buffer_store_dwordx4 v[188:191], v5, s[36:39], s58 offen sc1
  s_waitcnt lgkmcnt(2)
  buffer_store_dwordx4 v[192:195], v5, s[36:39], s59 offen sc1
  s_waitcnt lgkmcnt(0)
  buffer_store_dwordx4 v[196:199], v5, s[36:39], s60 offen sc1
  v_add_u32 v61, 40960, v61
  v_add_u32 v5, 5120, v5
K0_p3:
  s_cmp_ge_u32 s15, 4
  s_cbranch_scc1 P1_start
P0_end:
  s_cmp_ge_u32 s2, 208
  s_cbranch_scc1 P1_start
  s_waitcnt vmcnt(0)
P0_bar:
  s_barrier
P0_post:
P1_start:
  s_mov_b32 s3, s15
  s_mov_b32 s69, s15
  s_cmp_ge_u32 s2, 198
  v_and_b32 v0, 63, v0
  s_cbranch_scc1 K12_wp
  s_and_b32 s4, s2, 7
  s_lshr_b32 s5, s2, 3
  s_mul_i32 s6, s5, 43
  s_lshr_b32 s6, s6, 8
  s_mul_i32 s7, s6, 6
  s_sub_u32 s7, s5, s7
  s_lshl_b32 s6, s6, 3
  s_add_u32 s6, s6, s4
  s_cmp_ge_u32 s2, 192
  s_cselect_b32 s6, 32, s6
  s_cselect_b32 s7, s4, s7
  s_cmp_ge_u32 s7, 3
  s_cselect_b32 s44, 1, 0
  s_cselect_b32 s4, 3, 0
  s_sub_u32 s7, s7, s4
  s_cmp_eq_u32 s7, 0
  s_cselect_b32 s45, 0, 1
  s_mul_i32 s4, s7, 3
  s_cselect_b32 s7, 4, 3
  s_add_u32 s45, s45, s4
  s_and_b32 s3, s3, 3
  s_and_b32 s59, s6, 31
  s_cmp_eq_u32 s59, 0
  s_cselect_b32 s59, 2, 0
  s_and_b32 s59, s59, s3
  s_lshr_b32 s60, s3, 1
  s_lshl_b32 s60, s60, 5
  s_add_u32 s60, s60, s6
  s_lshl_b32 s60, s60, 1
  s_and_b32 s49, s3, 1
  s_add_u32 s60, s60, s49
  s_mul_i32 s60, s60, 20480
  s_add_u32 s60, s60, 745472
  s_cmp_eq_u32 s59, 0
  s_cselect_b32 s60, s60, 24576
  s_cselect_b32 s49, 1280, 0
  s_cmp_eq_u32 s44, 0
  s_mov_b32 s61, 25856
  s_cselect_b32 s61, s61, 34048
  s_mov_b32 s58, 0x42804280
  s_cselect_b32 s58, s58, 0xc2804280
  s_cmp_eq_u32 s6, 0
  s_cselect_b32 s58, s58, 0
  s_lshr_b32 s48, s69, 2
  s_lshl_b32 s48, s48, 3
  v_lshrrev_b32 v5, 3, v0
  v_add_u32 v5, s48, v5
  v_and_b32 v6, 7, v0
  v_mul_u32_u24 v248, s49, v5
  v_lshl_add_u32 v248, v6, 4, v248
  v_lshlrev_b32 v2, 4, v0
  s_lshl_b32 s48, s69, 11
  s_add_u32 s48, s48, 40960
  v_add_u32 v249, s48, v2
  v_lshl_add_u32 v250, v6, 4, s48
  v_and_b32 v7, 3, v0
  v_bfe_u32 v8, v0, 2, 1
  v_lshlrev_b32 v252, 1, v7
  v_xor_b32 v252, v252, v5
  v_lshl_add_u32 v252, v7, 4, v252
  v_xor_b32 v251, v252, v8
  v_lshlrev_b32 v251, 4, v251
  v_lshl_add_u32 v251, v8, 10, v251
  v_lshlrev_b32 v252, 4, v252
  v_lshl_add_u32 v252, v8, 3, v252
  s_mul_i32 s48, s3, 5120
  v_add_u32 v251, s48, v251
  v_add_u32 v252, s48, v252
  s_cmp_ge_u32 s69, 4
  s_cbranch_scc1 K12_helper
  s_add_u32 s45, s45, s3
  s_mul_i32 s46, s44, 10
  s_add_u32 s46, s46, s45
  v_and_b32 v3, 15, v0
  v_lshrrev_b32 v4, 4, v0
  v_lshlrev_b32 v9, 1, v4
  v_xor_b32 v9, v9, v3
  v_lshl_add_u32 v9, v4, 4, v9
  v_lshlrev_b32 v9, 4, v9
  v_xor_b32 v1, 16, v9
  v_and_b32 v6, 31, v0
  v_lshl_add_u32 v7, v6, 6, s6
  v_sub_u32 v8, 2048, v7
  v_cmp_gt_u32 vcc, 32, v0
  v_and_b32 v8, 2047, v8
  s_nop 0
  v_cndmask_b32 v7, v8, v7, vcc
  v_mul_u32_u24 v7, 642, v7
  v_mov_b32 v88, 0
  v_mov_b32 v89, 0
  s_mov_b64 s[4:5], 0
  s_mul_i32 s52, s3, 4608
  s_add_u32 s52, s52, 57344
  v_mul_u32_u24 v10, 144, v3
  v_lshl_add_u32 v10, v4, 3, v10
  v_add_u32 v10, s52, v10
  s_bfe_u32 s53, s6, 0x30001
  v_and_b32 v12, 7, v0
  v_lshrrev_b32 v13, 3, v0
  v_xor_b32 v11, s53, v12
  v_lshlrev_b32 v11, 4, v11
  v_mul_u32_u24 v14, 144, v13
  v_add3_u32 v11, v11, v14, s52
  v_mul_u32_u24 v13, 84480, v13
  v_lshl_add_u32 v12, v12, 4, v13
  s_lshl_b32 s47, s45, 5
  s_add_u32 s47, s47, s44
  v_lshl_add_u32 v56, v3, 1, s47
  v_mov_b32 v57, 320
  v_cmp_eq_u32 vcc, 0, v56
  v_lshl_add_u32 v58, v4, 2, 1
  s_nop 0
  v_cndmask_b32 v57, v56, v57, vcc
  v_cvt_f32_u32 v56, v56
  v_cvt_f32_u32 v57, v57
  v_cvt_f32_u32 v58, v58
  v_mul_f32 v56, 0x3a4ccccd, v56
  v_mul_f32 v57, 0x3a4ccccd, v57
  v_mul_f32 v59, v58, v57
  v_mul_f32 v58, v58, v56
  s_lshl_b32 s51, s3, 6
  s_add_u32 s51, s51, 75776
  s_add_u32 s50, s6, s44
  s_lshl_b32 s50, s50, 1
  s_and_b32 s50, s50, 63
  s_add_u32 s50, s50, s51
  v_mul_u32_u24 v13, 1280, v4
  v_lshl_add_u32 v13, v3, 2, v13
  s_sub_u32 s53, s44, s6
  s_lshl_b32 s53, s53, 1
  s_and_b32 s53, s53, 63
  s_add_u32 s53, s53, s51
  s_add_u32 s53, s53, 21120
  v_add_u32 v15, s53, v13
  v_add_u32 v13, s50, v13
  v_add_u32 v14, 118016, v2
  s_lshl_b32 s64, s45, 1
  s_add_u32 s64, s64, s44
  s_mul_i32 s64, s64, 33
  s_add_u32 s64, s64, s6
  s_lshl_b32 s64, s64, 7
  s_add_u32 s64, s64, 3366912
  s_add_u32 s65, s64, 675840
  s_add_u32 s66, s64, 1351680
  s_add_u32 s67, s64, 2027520
  s_mov_b32 s54, 0x80008000
  v_pk_mul_f32 v[104:105], 0, 0
  v_pk_mul_f32 v[106:107], 0, 0
  v_pk_mul_f32 v[108:109], 0, 0
  v_pk_mul_f32 v[110:111], 0, 0
  v_pk_mul_f32 v[112:113], 0, 0
  v_pk_mul_f32 v[114:115], 0, 0
  v_pk_mul_f32 v[116:117], 0, 0
  v_pk_mul_f32 v[118:119], 0, 0
  v_pk_mul_f32 v[120:121], 0, 0
  v_pk_mul_f32 v[122:123], 0, 0
  v_pk_mul_f32 v[124:125], 0, 0
  v_pk_mul_f32 v[126:127], 0, 0
  s_waitcnt vmcnt(4)
  v_pk_mul_f32 v[128:129], 0, 0
  v_pk_mul_f32 v[130:131], 0, 0
  v_pk_mul_f32 v[132:133], 0, 0
  v_pk_mul_f32 v[134:135], 0, 0
  s_waitcnt lgkmcnt(0)
  s_mov_b32 s36, s30
  s_mov_b32 s37, s31
  s_mov_b32 s38, 24416256
  s_mov_b32 s39, 0x20000
  s_cmp_eq_u32 s46, 0
  s_cbranch_scc0 K12_nospec0
  v_cmp_eq_u32 s[4:5], 0, v3
  s_mov_b32 s32, s10
  s_mov_b32 s33, s11
  s_mov_b32 s34, 1314816
  s_mov_b32 s35, 0x20000
  s_mov_b32 s40, s12
  s_mov_b32 s41, s13
  s_mov_b32 s42, 1314816
  s_mov_b32 s43, 0x20000
  buffer_load_short_d16_hi v88, v7, s[32:35], 0 offen offset:640
  buffer_load_short_d16_hi v89, v7, s[40:43], 0 offen offset:640
K12_nospec0:
  v_fmamk_f32 v65, v56, 0x40000000, v58
  v_fmamk_f32 v66, v56, 0x42000000, v58
  v_fmamk_f32 v67, v56, 0x42080000, v58
  v_fmamk_f32 v68, v56, 0x42800000, v58
  v_fmamk_f32 v69, v56, 0x42840000, v58
  v_fmamk_f32 v70, v56, 0x42c00000, v58
  v_fmamk_f32 v71, v56, 0x42c40000, v58
  v_cos_f32 v64, v58
  v_cos_f32 v65, v65
  v_cos_f32 v66, v66
  v_cos_f32 v67, v67
  v_cos_f32 v68, v68
  v_cos_f32 v69, v69
  v_cos_f32 v70, v70
  v_cos_f32 v71, v71
  v_cvt_pk_bf16_f32 v16, v64, v65
  v_cvt_pk_bf16_f32 v17, v66, v67
  v_cvt_pk_bf16_f32 v18, v68, v69
  v_cvt_pk_bf16_f32 v19, v70, v71
  v_fmamk_f32 v73, v57, 0x40000000, v59
  v_fmamk_f32 v74, v57, 0x42000000, v59
  v_fmamk_f32 v75, v57, 0x42080000, v59
  v_fmamk_f32 v76, v57, 0x42800000, v59
  v_fmamk_f32 v77, v57, 0x42840000, v59
  v_fmamk_f32 v78, v57, 0x42c00000, v59
  v_fmamk_f32 v79, v57, 0x42c40000, v59
  v_sin_f32 v72, v59
  v_sin_f32 v73, v73
  v_sin_f32 v74, v74
  v_sin_f32 v75, v75
  v_sin_f32 v76, v76
  v_sin_f32 v77, v77
  v_sin_f32 v78, v78
  v_sin_f32 v79, v79
  v_cvt_pk_bf16_f32 v36, v72, v73
  v_cvt_pk_bf16_f32 v37, v74, v75
  v_cvt_pk_bf16_f32 v38, v76, v77
  v_cvt_pk_bf16_f32 v39, v78, v79
  v_fmamk_f32 v60, v56, 0x41800000, v58
  v_fmamk_f32 v65, v56, 0x40000000, v60
  v_fmamk_f32 v66, v56, 0x42000000, v60
  v_fmamk_f32 v67, v56, 0x42080000, v60
  v_fmamk_f32 v68, v56, 0x42800000, v60
  v_fmamk_f32 v69, v56, 0x42840000, v60
  v_fmamk_f32 v70, v56, 0x42c00000, v60
  v_fmamk_f32 v71, v56, 0x42c40000, v60
  v_cos_f32 v64, v60
  v_cos_f32 v65, v65
  v_cos_f32 v66, v66
  v_cos_f32 v67, v67
  v_cos_f32 v68, v68
  v_cos_f32 v69, v69
  v_cos_f32 v70, v70
  v_cos_f32 v71, v71
  v_cvt_pk_bf16_f32 v20, v64, v65
  v_cvt_pk_bf16_f32 v21, v66, v67
  v_cvt_pk_bf16_f32 v22, v68, v69
  v_cvt_pk_bf16_f32 v23, v70, v71
  v_fmamk_f32 v60, v57, 0x41800000, v59
  v_fmamk_f32 v73, v57, 0x40000000, v60
  v_fmamk_f32 v74, v57, 0x42000000, v60
  v_fmamk_f32 v75, v57, 0x42080000, v60
  v_fmamk_f32 v76, v57, 0x42800000, v60
  v_fmamk_f32 v77, v57, 0x42840000, v60
  v_fmamk_f32 v78, v57, 0x42c00000, v60
  v_fmamk_f32 v79, v57, 0x42c40000, v60
  v_sin_f32 v72, v60
  v_sin_f32 v73, v73
  v_sin_f32 v74, v74
  v_sin_f32 v75, v75
  v_sin_f32 v76, v76
  v_sin_f32 v77, v77
  v_sin_f32 v78, v78
  v_sin_f32 v79, v79
  v_cvt_pk_bf16_f32 v40, v72, v73
  v_cvt_pk_bf16_f32 v41, v74, v75
  v_cvt_pk_bf16_f32 v42, v76, v77
  v_cvt_pk_bf16_f32 v43, v78, v79
  v_fmamk_f32 v60, v56, 0x43000000, v58
  v_fmamk_f32 v65, v56, 0x40000000, v60
  v_fmamk_f32 v66, v56, 0x42000000, v60
  v_fmamk_f32 v67, v56, 0x42080000, v60
  v_fmamk_f32 v68, v56, 0x42800000, v60
  v_fmamk_f32 v69, v56, 0x42840000, v60
  v_fmamk_f32 v70, v56, 0x42c00000, v60
  v_fmamk_f32 v71, v56, 0x42c40000, v60
  v_cos_f32 v64, v60
  v_cos_f32 v65, v65
  v_cos_f32 v66, v66
  v_cos_f32 v67, v67
  v_cos_f32 v68, v68
  v_cos_f32 v69, v69
  v_cos_f32 v70, v70
  v_cos_f32 v71, v71
  v_cvt_pk_bf16_f32 v24, v64, v65
  v_cvt_pk_bf16_f32 v25, v66, v67
  v_cvt_pk_bf16_f32 v26, v68, v69
  v_cvt_pk_bf16_f32 v27, v70, v71
  v_fmamk_f32 v60, v57, 0x43000000, v59
  v_fmamk_f32 v73, v57, 0x40000000, v60
  v_fmamk_f32 v74, v57, 0x42000000, v60
  v_fmamk_f32 v75, v57, 0x42080000, v60
  v_fmamk_f32 v76, v57, 0x42800000, v60
  v_fmamk_f32 v77, v57, 0x42840000, v60
  v_fmamk_f32 v78, v57, 0x42c00000, v60
  v_fmamk_f32 v79, v57, 0x42c40000, v60
  v_sin_f32 v72, v60
  v_sin_f32 v73, v73
  v_sin_f32 v74, v74
  v_sin_f32 v75, v75
  v_sin_f32 v76, v76
  v_sin_f32 v77, v77
  v_sin_f32 v78, v78
  v_sin_f32 v79, v79
  v_cvt_pk_bf16_f32 v44, v72, v73
  v_cvt_pk_bf16_f32 v45, v74, v75
  v_cvt_pk_bf16_f32 v46, v76, v77
  v_cvt_pk_bf16_f32 v47, v78, v79
  v_fmamk_f32 v60, v56, 0x43100000, v58
  v_fmamk_f32 v65, v56, 0x40000000, v60
  v_fmamk_f32 v66, v56, 0x42000000, v60
  v_fmamk_f32 v67, v56, 0x42080000, v60
  v_fmamk_f32 v68, v56, 0x42800000, v60
  v_fmamk_f32 v69, v56, 0x42840000, v60
  v_fmamk_f32 v70, v56, 0x42c00000, v60
  v_fmamk_f32 v71, v56, 0x42c40000, v60
  v_cos_f32 v64, v60
  v_cos_f32 v65, v65
  v_cos_f32 v66, v66
  v_cos_f32 v67, v67
  v_cos_f32 v68, v68
  v_cos_f32 v69, v69
  v_cos_f32 v70, v70
  v_cos_f32 v71, v71
  v_cvt_pk_bf16_f32 v28, v64, v65
  v_cvt_pk_bf16_f32 v29, v66, v67
  v_cvt_pk_bf16_f32 v30, v68, v69
  v_cvt_pk_bf16_f32 v31, v70, v71
  v_fmamk_f32 v60, v57, 0x43100000, v59
  v_fmamk_f32 v73, v57, 0x40000000, v60
  v_fmamk_f32 v74, v57, 0x42000000, v60
  v_fmamk_f32 v75, v57, 0x42080000, v60
  v_fmamk_f32 v76, v57, 0x42800000, v60
  v_fmamk_f32 v77, v57, 0x42840000, v60
  v_fmamk_f32 v78, v57, 0x42c00000, v60
  v_fmamk_f32 v79, v57, 0x42c40000, v60
  v_sin_f32 v72, v60
  v_sin_f32 v73, v73
  v_sin_f32 v74, v74
  v_sin_f32 v75, v75
  v_sin_f32 v76, v76
  v_sin_f32 v77, v77
  v_sin_f32 v78, v78
  v_sin_f32 v79, v79
  v_cvt_pk_bf16_f32 v48, v72, v73
  v_cvt_pk_bf16_f32 v49, v74, v75
  v_cvt_pk_bf16_f32 v50, v76, v77
  v_cvt_pk_bf16_f32 v51, v78, v79
  v_fmamk_f32 v60, v56, 0x43800000, v58
  v_fmamk_f32 v65, v56, 0x40000000, v60
  v_fmamk_f32 v66, v56, 0x42000000, v60
  v_fmamk_f32 v67, v56, 0x42080000, v60
  v_fmamk_f32 v68, v56, 0x41800000, v60
  v_fmamk_f32 v69, v56, 0x41900000, v60
  v_fmamk_f32 v70, v56, 0x42400000, v60
  v_fmamk_f32 v71, v56, 0x42480000, v60
  v_cos_f32 v64, v60
  v_cos_f32 v65, v65
  v_cos_f32 v66, v66
  v_cos_f32 v67, v67
  v_cos_f32 v68, v68
  v_cos_f32 v69, v69
  v_cos_f32 v70, v70
  v_cos_f32 v71, v71
  v_cvt_pk_bf16_f32 v32, v64, v65
  v_cvt_pk_bf16_f32 v33, v66, v67
  v_cvt_pk_bf16_f32 v34, v68, v69
  v_cvt_pk_bf16_f32 v35, v70, v71
  v_fmamk_f32 v60, v57, 0x43800000, v59
  v_fmamk_f32 v73, v57, 0x40000000, v60
  v_fmamk_f32 v74, v57, 0x42000000, v60
  v_fmamk_f32 v75, v57, 0x42080000, v60
  v_fmamk_f32 v76, v57, 0x41800000, v60
  v_fmamk_f32 v77, v57, 0x41900000, v60
  v_fmamk_f32 v78, v57, 0x42400000, v60
  v_fmamk_f32 v79, v57, 0x42480000, v60
  v_sin_f32 v72, v60
  v_sin_f32 v73, v73
  v_sin_f32 v74, v74
  v_sin_f32 v75, v75
  v_sin_f32 v76, v76
  v_sin_f32 v77, v77
  v_sin_f32 v78, v78
  v_sin_f32 v79, v79
  v_cvt_pk_bf16_f32 v52, v72, v73
  v_cvt_pk_bf16_f32 v53, v74, v75
  v_cvt_pk_bf16_f32 v54, v76, v77
  v_cvt_pk_bf16_f32 v55, v78, v79
  s_cmp_eq_u32 s46, 0
  s_cbranch_scc0 K12_nospec1
  s_waitcnt vmcnt(1)
  v_mov_b32 v90, v88
  s_waitcnt vmcnt(0)
  v_mov_b32 v91, v89
  v_lshl_add_u32 v6, v6, 2, s52
  v_lshl_add_u32 v7, v4, 4, s52
  v_permlane32_swap_b32 v88, v90
  v_permlane32_swap_b32 v89, v91
  v_add_f32 v88, v88, v90
  v_sub_f32 v89, v89, v91
  v_mul_f32 v88, 0.5, v88
  v_mul_f32 v89, 0.5, v89
  ds_write_b32 v6, v88
  ds_write_b32 v6, v89 offset:128
  ds_read_b128 v[168:171], v7
  ds_read_b128 v[172:175], v7 offset:64
  ds_read_b128 v[176:179], v7 offset:128
  ds_read_b128 v[180:183], v7 offset:192
K12_nospec1:
  s_cmp_eq_u32 s15, 3
  s_cbranch_scc0 K12_mw
  s_and_b32 s47, s2, 7
  s_lshl_b32 s47, s47, 10
  s_add_u32 s47, s47, 21784576
  v_and_b32 v92, 15, v0
  v_lshlrev_b32 v92, 6, v92
  s_mov_b32 s14, 0x10000
  s_nop 4
SP_g0m:
  buffer_load_dword v93, v92, s[36:39], s47 offen offset:0 sc0 sc1
  s_sub_u32 s14, s14, 1
  s_waitcnt vmcnt(0)
  v_cmp_ne_u32 vcc, 1, v93
  s_cmp_eq_u32 s14, 0
  s_cbranch_scc1 SG_g0m
  s_nop 3
  s_cbranch_vccnz SP_g0m
SG_g0m:
  s_nop 1
K12_mw:
  s_barrier
  buffer_load_dwordx4 v[56:59], v2, s[36:39], s61 offen sc1
  s_mov_b64 exec, 0xffff
  buffer_load_dwordx4 v[60:63], v2, s[36:39], s61 offen offset:1024 sc1
  s_mov_b64 exec, -1
  buffer_load_dwordx4 v[184:187], v248, s[36:39], s60 offen offset:0 sc1
  buffer_load_dwordx4 v[188:191], v248, s[36:39], s60 offen offset:128 sc1
  buffer_load_dwordx4 v[192:195], v248, s[36:39], s60 offen offset:256 sc1
  buffer_load_dwordx4 v[196:199], v248, s[36:39], s60 offen offset:384 sc1
  buffer_load_dwordx4 v[200:203], v248, s[36:39], s60 offen offset:512 sc1
  buffer_load_dwordx4 v[204:207], v248, s[36:39], s60 offen offset:640 sc1
  buffer_load_dwordx4 v[208:211], v248, s[36:39], s60 offen offset:768 sc1
  buffer_load_dwordx4 v[212:215], v248, s[36:39], s60 offen offset:896 sc1
  buffer_load_dwordx4 v[216:219], v248, s[36:39], s60 offen offset:1024 sc1
  buffer_load_dwordx4 v[220:223], v248, s[36:39], s60 offen offset:1152 sc1
  ds_read_u16_d16_hi v104, v13 offset:0
  ds_read_u16_d16_hi v112, v13 offset:10560
  ds_read_u16_d16_hi v120, v15 offset:0
  ds_read_u16_d16_hi v128, v15 offset:10560
  ds_read_u16_d16_hi v105, v13 offset:320
  ds_read_u16_d16_hi v113, v13 offset:10880
  ds_read_u16_d16_hi v121, v15 offset:320
  ds_read_u16_d16_hi v129, v15 offset:10880
  ds_read_u16_d16_hi v106, v13 offset:640
  ds_read_u16_d16_hi v114, v13 offset:11200
  ds_read_u16_d16_hi v122, v15 offset:640
  ds_read_u16_d16_hi v130, v15 offset:11200
  ds_read_u16_d16_hi v107, v13 offset:960
  ds_read_u16_d16_hi v115, v13 offset:11520
  ds_read_u16_d16_hi v123, v15 offset:960
  ds_read_u16_d16_hi v131, v15 offset:11520
  ds_read_u16_d16_hi v108, v13 offset:5120
  ds_read_u16_d16_hi v116, v13 offset:15680
  ds_read_u16_d16_hi v124, v15 offset:5120
  ds_read_u16_d16_hi v132, v15 offset:15680
  ds_read_u16_d16_hi v109, v13 offset:5440
  ds_read_u16_d16_hi v117, v13 offset:16000
  ds_read_u16_d16_hi v125, v15 offset:5440
  ds_read_u16_d16_hi v133, v15 offset:16000
  ds_read_u16_d16_hi v110, v13 offset:5760
  ds_read_u16_d16_hi v118, v13 offset:16320
  ds_read_u16_d16_hi v126, v15 offset:5760
  ds_read_u16_d16_hi v134, v15 offset:16320
  ds_read_u16_d16_hi v111, v13 offset:6080
  ds_read_u16_d16_hi v119, v13 offset:16640
  ds_read_u16_d16_hi v127, v15 offset:6080
  ds_read_u16_d16_hi v135, v15 offset:16640
  s_waitcnt vmcnt(12) lgkmcnt(15)
  v_pk_add_f32 v[136:137], v[104:105], v[120:121]
  v_pk_add_f32 v[144:145], v[112:113], v[128:129] neg_lo:[0,1] neg_hi:[0,1]
  v_pk_add_f32 v[152:153], v[104:105], v[120:121] neg_lo:[0,1] neg_hi:[0,1]
  v_pk_add_f32 v[160:161], v[112:113], v[128:129]
  v_pk_add_f32 v[138:139], v[106:107], v[122:123]
  v_pk_add_f32 v[146:147], v[114:115], v[130:131] neg_lo:[0,1] neg_hi:[0,1]
  v_pk_add_f32 v[154:155], v[106:107], v[122:123] neg_lo:[0,1] neg_hi:[0,1]
  v_pk_add_f32 v[162:163], v[114:115], v[130:131]
  s_waitcnt lgkmcnt(9)
  v_pk_add_f32 v[140:141], v[108:109], v[124:125]
  s_waitcnt lgkmcnt(8)
  v_pk_add_f32 v[148:149], v[116:117], v[132:133] neg_lo:[0,1] neg_hi:[0,1]
  v_pk_add_f32 v[156:157], v[108:109], v[124:125] neg_lo:[0,1] neg_hi:[0,1]
  v_pk_add_f32 v[164:165], v[116:117], v[132:133]
  s_waitcnt lgkmcnt(1)
  v_pk_add_f32 v[142:143], v[110:111], v[126:127]
  s_waitcnt lgkmcnt(0)
  v_pk_add_f32 v[150:151], v[118:119], v[134:135] neg_lo:[0,1] neg_hi:[0,1]
  v_pk_add_f32 v[158:159], v[110:111], v[126:127] neg_lo:[0,1] neg_hi:[0,1]
  v_pk_add_f32 v[166:167], v[118:119], v[134:135]
  s_not_b64 exec, s[4:5]
  v_pk_mul_f32 v[168:169], v[136:137], 1.0 op_sel_hi:[1,0]
  v_pk_mul_f32 v[176:177], v[144:145], 1.0 op_sel_hi:[1,0]
  v_pk_mul_f32 v[170:171], v[138:139], 1.0 op_sel_hi:[1,0]
  v_pk_mul_f32 v[178:179], v[146:147], 1.0 op_sel_hi:[1,0]
  v_pk_mul_f32 v[172:173], v[140:141], 1.0 op_sel_hi:[1,0]
  v_pk_mul_f32 v[180:181], v[148:149], 1.0 op_sel_hi:[1,0]
  v_pk_mul_f32 v[174:175], v[142:143], 1.0 op_sel_hi:[1,0]
  v_pk_mul_f32 v[182:183], v[150:151], 1.0 op_sel_hi:[1,0]
  s_cmp_eq_u32 s46, 0
  s_cbranch_scc0 K12_nospec
  s_mov_b64 exec, s[4:5]
  v_mul_f32 v136, 0.5, v136
  v_mul_f32 v144, 0.5, v144
  v_mov_b32 v152, 0
  v_mov_b32 v160, 0
  v_mul_f32 v137, 0.5, v137
  v_mul_f32 v145, 0.5, v145
  v_mov_b32 v153, 0
  v_mov_b32 v161, 0
  v_mul_f32 v138, 0.5, v138
  v_mul_f32 v146, 0.5, v146
  v_mov_b32 v154, 0
  v_mov_b32 v162, 0
  v_mul_f32 v139, 0.5, v139
  v_mul_f32 v147, 0.5, v147
  v_mov_b32 v155, 0
  v_mov_b32 v163, 0
  v_mul_f32 v140, 0.5, v140
  v_mul_f32 v148, 0.5, v148
  v_mov_b32 v156, 0
  v_mov_b32 v164, 0
  v_mul_f32 v141, 0.5, v141
  v_mul_f32 v149, 0.5, v149
  v_mov_b32 v157, 0
  v_mov_b32 v165, 0
  v_mul_f32 v142, 0.5, v142
  v_mul_f32 v150, 0.5, v150
  v_mov_b32 v158, 0
  v_mov_b32 v166, 0
  v_mul_f32 v143, 0.5, v143
  v_mul_f32 v151, 0.5, v151
  v_mov_b32 v159, 0
  v_mov_b32 v167, 0
  s_mov_b64 exec, -1
K12_nospec:
  s_waitcnt vmcnt(10)
  v_mov_b32 v72, v60
  s_cmp_eq_u32 s59, 0
  s_cbranch_scc1 K12_hnm
  v_mov_b32 v56, s58
  v_mov_b32 v57, s58
  v_mov_b32 v58, s58
  v_mov_b32 v59, s58
  v_mov_b32 v60, s58
  v_mov_b32 v61, s58
  v_mov_b32 v62, s58
  v_mov_b32 v63, s58
K12_hnm:
  ds_write_b128 v249, v[56:59]
  ds_write_b128 v249, v[60:63] offset:1024
  ds_read_b128 v[224:227], v250 offset:0
  ds_read_b128 v[228:231], v250 offset:128
  ds_read_b128 v[232:235], v250 offset:256
  ds_read_b128 v[236:239], v250 offset:384
  ds_read_b128 v[240:243], v250 offset:512
  ds_read_b128 v[244:247], v250 offset:640
  ds_read_b128 v[104:107], v250 offset:768
  ds_read_b128 v[108:111], v250 offset:896
  ds_read_b128 v[112:115], v250 offset:1024
  ds_read_b128 v[116:119], v250 offset:1152
  s_waitcnt vmcnt(9) lgkmcnt(9)
  v_dot2_f32_bf16 v72, v184, v224, 0
  v_dot2_f32_bf16 v73, v186, v226, 0
  v_dot2_f32_bf16 v74, v185, v225, 0
  v_dot2_f32_bf16 v75, v187, v227, 0
  s_waitcnt vmcnt(8) lgkmcnt(8)
  v_dot2_f32_bf16 v80, v188, v228, 0
  v_dot2_f32_bf16 v81, v190, v230, 0
  v_dot2_f32_bf16 v82, v189, v229, 0
  v_dot2_f32_bf16 v83, v191, v231, 0
  s_waitcnt vmcnt(7) lgkmcnt(7)
  v_dot2_f32_bf16 v88, v192, v232, 0
  v_dot2_f32_bf16 v89, v194, v234, 0
  v_dot2_f32_bf16 v90, v193, v233, 0
  v_dot2_f32_bf16 v91, v195, v235, 0
  s_waitcnt vmcnt(6) lgkmcnt(6)
  v_dot2_f32_bf16 v96, v196, v236, 0
  v_dot2_f32_bf16 v97, v198, v238, 0
  v_dot2_f32_bf16 v98, v197, v237, 0
  v_dot2_f32_bf16 v99, v199, v239, 0
  v_pk_add_f32 v[76:77], v[72:73], v[74:75]
  v_pk_add_f32 v[78:79], v[72:73], v[74:75] neg_lo:[0,1] neg_hi:[0,1]
  v_pk_add_f32 v[84:85], v[80:81], v[82:83]
  v_pk_add_f32 v[86:87], v[80:81], v[82:83] neg_lo:[0,1] neg_hi:[0,1]
  v_pk_add_f32 v[92:93], v[88:89], v[90:91]
  v_pk_add_f32 v[94:95], v[88:89], v[90:91] neg_lo:[0,1] neg_hi:[0,1]
  v_pk_add_f32 v[100:101], v[96:97], v[98:99]
  v_pk_add_f32 v[102:103], v[96:97], v[98:99] neg_lo:[0,1] neg_hi:[0,1]
  v_cvt_pk_bf16_f32 v56, v76, v77
  v_cvt_pk_bf16_f32 v60, v78, v79
  v_cvt_pk_bf16_f32 v57, v84, v85
  v_cvt_pk_bf16_f32 v61, v86, v87
  v_cvt_pk_bf16_f32 v58, v92, v93
  v_cvt_pk_bf16_f32 v62, v94, v95
  v_cvt_pk_bf16_f32 v59, v100, v101
  v_cvt_pk_bf16_f32 v63, v102, v103
  ds_write_b128 v251, v[56:59] offset:0
  ds_write_b128 v251, v[60:63] offset:20480
  s_waitcnt vmcnt(5) lgkmcnt(7)
  v_dot2_f32_bf16 v72, v200, v240, 0
  v_dot2_f32_bf16 v73, v202, v242, 0
  v_dot2_f32_bf16 v74, v201, v241, 0
  v_dot2_f32_bf16 v75, v203, v243, 0
  s_waitcnt vmcnt(4) lgkmcnt(6)
  v_dot2_f32_bf16 v80, v204, v244, 0
  v_dot2_f32_bf16 v81, v206, v246, 0
  v_dot2_f32_bf16 v82, v205, v245, 0
  v_dot2_f32_bf16 v83, v207, v247, 0
  s_waitcnt vmcnt(3) lgkmcnt(5)
  v_dot2_f32_bf16 v88, v208, v104, 0
  v_dot2_f32_bf16 v89, v210, v106, 0
  v_dot2_f32_bf16 v90, v209, v105, 0
  v_dot2_f32_bf16 v91, v211, v107, 0
  s_waitcnt vmcnt(2) lgkmcnt(4)
  v_dot2_f32_bf16 v96, v212, v108, 0
  v_dot2_f32_bf16 v97, v214, v110, 0
  v_dot2_f32_bf16 v98, v213, v109, 0
  v_dot2_f32_bf16 v99, v215, v111, 0
  v_pk_add_f32 v[76:77], v[72:73], v[74:75]
  v_pk_add_f32 v[78:79], v[72:73], v[74:75] neg_lo:[0,1] neg_hi:[0,1]
  v_pk_add_f32 v[84:85], v[80:81], v[82:83]
  v_pk_add_f32 v[86:87], v[80:81], v[82:83] neg_lo:[0,1] neg_hi:[0,1]
  v_pk_add_f32 v[92:93], v[88:89], v[90:91]
  v_pk_add_f32 v[94:95], v[88:89], v[90:91] neg_lo:[0,1] neg_hi:[0,1]
  v_pk_add_f32 v[100:101], v[96:97], v[98:99]
  v_pk_add_f32 v[102:103], v[96:97], v[98:99] neg_lo:[0,1] neg_hi:[0,1]
  v_cvt_pk_bf16_f32 v64, v76, v77
  v_cvt_pk_bf16_f32 v68, v78, v79
  v_cvt_pk_bf16_f32 v65, v84, v85
  v_cvt_pk_bf16_f32 v69, v86, v87
  v_cvt_pk_bf16_f32 v66, v92, v93
  v_cvt_pk_bf16_f32 v70, v94, v95
  v_cvt_pk_bf16_f32 v67, v100, v101
  v_cvt_pk_bf16_f32 v71, v102, v103
  ds_write_b128 v251, v[64:67] offset:2048
  ds_write_b128 v251, v[68:71] offset:22528
  s_waitcnt vmcnt(1) lgkmcnt(5)
  v_dot2_f32_bf16 v72, v216, v112, 0
  v_dot2_f32_bf16 v73, v218, v114, 0
  v_dot2_f32_bf16 v74, v217, v113, 0
  v_dot2_f32_bf16 v75, v219, v115, 0
  s_waitcnt vmcnt(0) lgkmcnt(4)
  v_dot2_f32_bf16 v80, v220, v116, 0
  v_dot2_f32_bf16 v81, v222, v118, 0
  v_dot2_f32_bf16 v82, v221, v117, 0
  v_dot2_f32_bf16 v83, v223, v119, 0
  v_pk_add_f32 v[76:77], v[72:73], v[74:75]
  v_pk_add_f32 v[78:79], v[72:73], v[74:75] neg_lo:[0,1] neg_hi:[0,1]
  s_nop 0
  v_pk_add_f32 v[84:85], v[80:81], v[82:83]
  v_pk_add_f32 v[86:87], v[80:81], v[82:83] neg_lo:[0,1] neg_hi:[0,1]
  v_cvt_pk_bf16_f32 v56, v76, v77
  v_cvt_pk_bf16_f32 v60, v78, v79
  v_cvt_pk_bf16_f32 v57, v84, v85
  v_cvt_pk_bf16_f32 v61, v86, v87
  ds_write_b64 v252, v[56:57] offset:4096
  ds_write_b64 v252, v[60:61] offset:24576
  s_waitcnt lgkmcnt(0)
  s_barrier
  s_cmp_ge_u32 s3, s7
  s_cbranch_scc1 P1_end
  ds_read_b128 v[216:219], v9 offset:0
  ds_read_b128 v[220:223], v9 offset:5120
  ds_read_b128 v[224:227], v9 offset:10240
  ds_read_b128 v[228:231], v9 offset:15360
  ds_read_b128 v[232:235], v9 offset:20480
  ds_read_b128 v[236:239], v9 offset:25600
  ds_read_b128 v[240:243], v9 offset:30720
  ds_read_b128 v[244:247], v9 offset:35840
  ds_read_b128 v[248:251], v1 offset:1024
  ds_read_b128 v[252:255], v1 offset:6144
  s_waitcnt lgkmcnt(9)
  v_mfma_f32_16x16x32_bf16 v[184:187], v[216:219], v[16:19], 0
  ds_read_b128 v[216:219], v1 offset:11264
  s_waitcnt lgkmcnt(9)
  v_mfma_f32_16x16x32_bf16 v[188:191], v[220:223], v[16:19], 0
  ds_read_b128 v[220:223], v1 offset:16384
  s_waitcnt lgkmcnt(9)
  v_mfma_f32_16x16x32_bf16 v[192:195], v[224:227], v[16:19], 0
  ds_read_b128 v[224:227], v1 offset:21504
  s_waitcnt lgkmcnt(9)
  v_mfma_f32_16x16x32_bf16 v[196:199], v[228:231], v[16:19], 0
  ds_read_b128 v[228:231], v1 offset:26624
  s_waitcnt lgkmcnt(9)
  v_mfma_f32_16x16x32_bf16 v[200:203], v[232:235], v[36:39], 0
  ds_read_b128 v[232:235], v1 offset:31744
  s_waitcnt lgkmcnt(9)
  v_mfma_f32_16x16x32_bf16 v[204:207], v[236:239], v[36:39], 0
  ds_read_b128 v[236:239], v1 offset:36864
  s_waitcnt lgkmcnt(9)
  v_mfma_f32_16x16x32_bf16 v[208:211], v[240:243], v[36:39], 0
  ds_read_b128 v[240:243], v9 offset:2048
  s_waitcnt lgkmcnt(9)
  v_mfma_f32_16x16x32_bf16 v[212:215], v[244:247], v[36:39], 0
  ds_read_b128 v[244:247], v9 offset:7168
  s_waitcnt lgkmcnt(9)
  v_mfma_f32_16x16x32_bf16 v[184:187], v[248:251], v[20:23], v[184:187]
  ds_read_b128 v[248:251], v9 offset:12288
  s_waitcnt lgkmcnt(9)
  v_mfma_f32_16x16x32_bf16 v[188:191], v[252:255], v[20:23], v[188:191]
  ds_read_b128 v[252:255], v9 offset:17408
  s_waitcnt lgkmcnt(9)
  v_mfma_f32_16x16x32_bf16 v[192:195], v[216:219], v[20:23], v[192:195]
  ds_read_b128 v[216:219], v9 offset:22528
  s_waitcnt lgkmcnt(9)
  v_mfma_f32_16x16x32_bf16 v[196:199], v[220:223], v[20:23], v[196:199]
  ds_read_b128 v[220:223], v9 offset:27648
  s_waitcnt lgkmcnt(9)
  v_mfma_f32_16x16x32_bf16 v[200:203], v[224:227], v[40:43], v[200:203]
  ds_read_b128 v[224:227], v9 offset:32768
  s_waitcnt lgkmcnt(9)
  v_mfma_f32_16x16x32_bf16 v[204:207], v[228:231], v[40:43], v[204:207]
  ds_read_b128 v[228:231], v9 offset:37888
  s_waitcnt lgkmcnt(9)
  v_mfma_f32_16x16x32_bf16 v[208:211], v[232:235], v[40:43], v[208:211]
  ds_read_b128 v[232:235], v1 offset:3072
  s_waitcnt lgkmcnt(9)
  v_mfma_f32_16x16x32_bf16 v[212:215], v[236:239], v[40:43], v[212:215]
  ds_read_b128 v[236:239], v1 offset:8192
  s_waitcnt lgkmcnt(9)
  v_mfma_f32_16x16x32_bf16 v[184:187], v[240:243], v[24:27], v[184:187]
  ds_read_b128 v[240:243], v1 offset:13312
  s_waitcnt lgkmcnt(9)
  v_mfma_f32_16x16x32_bf16 v[188:191], v[244:247], v[24:27], v[188:191]
  ds_read_b128 v[244:247], v1 offset:18432
  s_waitcnt lgkmcnt(9)
  v_mfma_f32_16x16x32_bf16 v[192:195], v[248:251], v[24:27], v[192:195]
  ds_read_b128 v[248:251], v9 offset:4096
  s_waitcnt lgkmcnt(9)
  v_mfma_f32_16x16x32_bf16 v[196:199], v[252:255], v[24:27], v[196:199]
  ds_read_b128 v[252:255], v9 offset:9216
  s_waitcnt lgkmcnt(9)
  v_mfma_f32_16x16x32_bf16 v[200:203], v[216:219], v[44:47], v[200:203]
  ds_read_b128 v[216:219], v9 offset:14336
  s_waitcnt lgkmcnt(9)
  v_mfma_f32_16x16x32_bf16 v[204:207], v[220:223], v[44:47], v[204:207]
  ds_read_b128 v[220:223], v9 offset:19456
  s_waitcnt lgkmcnt(9)
  v_mfma_f32_16x16x32_bf16 v[208:211], v[224:227], v[44:47], v[208:211]
  ds_read_b128 v[224:227], v1 offset:23552
  s_waitcnt lgkmcnt(9)
  v_mfma_f32_16x16x32_bf16 v[212:215], v[228:231], v[44:47], v[212:215]
  ds_read_b128 v[228:231], v1 offset:28672
  s_waitcnt lgkmcnt(9)
  v_mfma_f32_16x16x32_bf16 v[184:187], v[232:235], v[28:31], v[184:187]
  ds_read_b128 v[232:235], v1 offset:33792
  s_waitcnt lgkmcnt(9)
  v_mfma_f32_16x16x32_bf16 v[188:191], v[236:239], v[28:31], v[188:191]
  ds_read_b128 v[236:239], v1 offset:38912
  s_waitcnt lgkmcnt(9)
  v_mfma_f32_16x16x32_bf16 v[192:195], v[240:243], v[28:31], v[192:195]
  ds_read_b128 v[240:243], v9 offset:24576
  s_waitcnt lgkmcnt(9)
  v_mfma_f32_16x16x32_bf16 v[196:199], v[244:247], v[28:31], v[196:199]
  ds_read_b128 v[244:247], v9 offset:29696
  s_waitcnt lgkmcnt(9)
  v_mfma_f32_16x16x32_bf16 v[184:187], v[248:251], v[32:35], v[184:187]
  ds_read_b128 v[248:251], v9 offset:34816
  s_waitcnt lgkmcnt(9)
  v_mfma_f32_16x16x32_bf16 v[188:191], v[252:255], v[32:35], v[188:191]
  ds_read_b128 v[252:255], v9 offset:39936
  s_waitcnt lgkmcnt(9)
  v_mfma_f32_16x16x32_bf16 v[192:195], v[216:219], v[32:35], v[192:195]
  ds_read_b128 v[56:59], v14 offset:0
  s_waitcnt lgkmcnt(9)
  v_mfma_f32_16x16x32_bf16 v[196:199], v[220:223], v[32:35], v[196:199]
  ds_read_b128 v[60:63], v14 offset:1024
  s_waitcnt lgkmcnt(9)
  v_mfma_f32_16x16x32_bf16 v[200:203], v[224:227], v[48:51], v[200:203]
  ds_read_b128 v[64:67], v14 offset:2048
  s_waitcnt lgkmcnt(9)
  v_mfma_f32_16x16x32_bf16 v[204:207], v[228:231], v[48:51], v[204:207]
  ds_read_b128 v[68:71], v14 offset:3072
  s_waitcnt lgkmcnt(9)
  v_mfma_f32_16x16x32_bf16 v[208:211], v[232:235], v[48:51], v[208:211]
  ds_read_b128 v[72:75], v14 offset:4096
  s_waitcnt lgkmcnt(9)
  v_mfma_f32_16x16x32_bf16 v[212:215], v[236:239], v[48:51], v[212:215]
  ds_read_b128 v[76:79], v14 offset:5120
  s_waitcnt lgkmcnt(9)
  v_mfma_f32_16x16x32_bf16 v[200:203], v[240:243], v[52:55], v[200:203]
  ds_read_b128 v[80:83], v14 offset:6144
  s_waitcnt lgkmcnt(9)
  v_mfma_f32_16x16x32_bf16 v[204:207], v[244:247], v[52:55], v[204:207]
  ds_read_b128 v[84:87], v14 offset:7168
  s_waitcnt lgkmcnt(9)
  v_mfma_f32_16x16x32_bf16 v[208:211], v[248:251], v[52:55], v[208:211]
  s_waitcnt lgkmcnt(8)
  v_mfma_f32_16x16x32_bf16 v[212:215], v[252:255], v[52:55], v[212:215]
  s_waitcnt lgkmcnt(5)
  v_xor_b32 v88, s54, v64
  v_xor_b32 v89, s54, v65
  v_xor_b32 v90, s54, v66
  v_xor_b32 v91, s54, v67
  s_waitcnt lgkmcnt(4)
  v_xor_b32 v92, s54, v68
  v_xor_b32 v93, s54, v69
  v_xor_b32 v94, s54, v70
  v_xor_b32 v95, s54, v71
  s_cmp_eq_u32 s6, 0
  s_cbranch_scc0 K12_nog0
  v_add_f32 v184, v184, v192
  v_mov_b32 v192, 0
  v_add_f32 v185, v185, v193
  v_mov_b32 v193, 0
  v_add_f32 v186, v186, v194
  v_mov_b32 v194, 0
  v_add_f32 v187, v187, v195
  v_mov_b32 v195, 0
  v_add_f32 v188, v188, v196
  v_mov_b32 v196, 0
  v_add_f32 v189, v189, v197
  v_mov_b32 v197, 0
  v_add_f32 v190, v190, v198
  v_mov_b32 v198, 0
  v_add_f32 v191, v191, v199
  v_mov_b32 v199, 0
  v_add_f32 v200, v200, v208
  v_mov_b32 v208, 0
  v_add_f32 v201, v201, v209
  v_mov_b32 v209, 0
  v_add_f32 v202, v202, v210
  v_mov_b32 v210, 0
  v_add_f32 v203, v203, v211
  v_mov_b32 v211, 0
  v_add_f32 v204, v204, v212
  v_mov_b32 v212, 0
  v_add_f32 v205, v205, v213
  v_mov_b32 v213, 0
  v_add_f32 v206, v206, v214
  v_mov_b32 v214, 0
  v_add_f32 v207, v207, v215
  v_mov_b32 v215, 0
K12_nog0:
  v_cvt_pk_bf16_f32 v216, v184, v185
  v_cvt_pk_bf16_f32 v217, v186, v187
  v_cvt_pk_bf16_f32 v218, v188, v189
  v_cvt_pk_bf16_f32 v219, v190, v191
  v_cvt_pk_bf16_f32 v220, v192, v193
  v_cvt_pk_bf16_f32 v221, v194, v195
  v_cvt_pk_bf16_f32 v222, v196, v197
  v_cvt_pk_bf16_f32 v223, v198, v199
  v_mfma_f32_16x16x32_bf16 v[16:19], v[56:59], v[216:219], 0
  v_cvt_pk_bf16_f32 v224, v200, v201
  v_mfma_f32_16x16x32_bf16 v[24:27], v[56:59], v[220:223], 0
  v_cvt_pk_bf16_f32 v225, v202, v203
  v_mfma_f32_16x16x32_bf16 v[20:23], v[60:63], v[216:219], 0
  v_cvt_pk_bf16_f32 v226, v204, v205
  v_mfma_f32_16x16x32_bf16 v[28:31], v[60:63], v[220:223], 0
  v_cvt_pk_bf16_f32 v227, v206, v207
  v_mfma_f32_16x16x32_bf16 v[16:19], v[88:91], v[220:223], v[16:19]
  v_cvt_pk_bf16_f32 v228, v208, v209
  v_mfma_f32_16x16x32_bf16 v[24:27], v[64:67], v[216:219], v[24:27]
  v_cvt_pk_bf16_f32 v229, v210, v211
  v_mfma_f32_16x16x32_bf16 v[20:23], v[92:95], v[220:223], v[20:23]
  v_cvt_pk_bf16_f32 v230, v212, v213
  v_mfma_f32_16x16x32_bf16 v[28:31], v[68:71], v[216:219], v[28:31]
  v_cvt_pk_bf16_f32 v231, v214, v215
  v_mfma_f32_16x16x32_bf16 v[32:35], v[56:59], v[224:227], 0
  s_waitcnt lgkmcnt(1)
  v_xor_b32 v96, s54, v80
  v_mfma_f32_16x16x32_bf16 v[40:43], v[56:59], v[228:231], 0
  v_xor_b32 v97, s54, v81
  v_mfma_f32_16x16x32_bf16 v[36:39], v[60:63], v[224:227], 0
  v_xor_b32 v98, s54, v82
  v_mfma_f32_16x16x32_bf16 v[44:47], v[60:63], v[228:231], 0
  v_xor_b32 v99, s54, v83
  v_mfma_f32_16x16x32_bf16 v[32:35], v[88:91], v[228:231], v[32:35]
  s_waitcnt lgkmcnt(0)
  v_xor_b32 v100, s54, v84
  v_mfma_f32_16x16x32_bf16 v[40:43], v[64:67], v[224:227], v[40:43]
  v_xor_b32 v101, s54, v85
  v_mfma_f32_16x16x32_bf16 v[36:39], v[92:95], v[228:231], v[36:39]
  v_xor_b32 v102, s54, v86
  v_mfma_f32_16x16x32_bf16 v[44:47], v[68:71], v[224:227], v[44:47]
  v_xor_b32 v103, s54, v87
  v_pk_mul_f32 v[184:185], v[136:137], v[16:17]
  v_pk_mul_f32 v[192:193], v[136:137], v[24:25]
  v_pk_mul_f32 v[200:201], v[152:153], v[16:17]
  v_pk_mul_f32 v[208:209], v[152:153], v[24:25] neg_lo:[1,0] neg_hi:[1,0]
  v_pk_fma_f32 v[184:185], v[144:145], v[24:25], v[184:185] neg_lo:[1,0,0] neg_hi:[1,0,0]
  v_pk_fma_f32 v[192:193], v[144:145], v[16:17], v[192:193]
  v_pk_fma_f32 v[200:201], v[160:161], v[24:25], v[200:201] neg_lo:[1,0,0] neg_hi:[1,0,0]
  v_pk_fma_f32 v[208:209], v[160:161], v[16:17], v[208:209] neg_lo:[1,0,0] neg_hi:[1,0,0]
  v_pk_fma_f32 v[184:185], v[152:153], v[40:41], v[184:185]
  v_pk_fma_f32 v[192:193], v[152:153], v[32:33], v[192:193] neg_lo:[1,0,0] neg_hi:[1,0,0]
  v_pk_fma_f32 v[200:201], v[168:169], v[40:41], v[200:201]
  v_pk_fma_f32 v[208:209], v[168:169], v[32:33], v[208:209]
  v_pk_fma_f32 v[184:185], v[160:161], v[32:33], v[184:185]
  v_pk_fma_f32 v[192:193], v[160:161], v[40:41], v[192:193]
  v_pk_fma_f32 v[200:201], v[176:177], v[32:33], v[200:201]
  v_pk_fma_f32 v[208:209], v[176:177], v[40:41], v[208:209] neg_lo:[1,0,0] neg_hi:[1,0,0]
  v_cvt_pk_bf16_f32 v232, v184, v185
  v_cvt_pk_bf16_f32 v236, v192, v193
  v_cvt_pk_bf16_f32 v240, v200, v201
  v_cvt_pk_bf16_f32 v244, v208, v209
  v_pk_mul_f32 v[186:187], v[138:139], v[18:19]
  v_pk_mul_f32 v[194:195], v[138:139], v[26:27]
  v_pk_mul_f32 v[202:203], v[154:155], v[18:19]
  v_pk_mul_f32 v[210:211], v[154:155], v[26:27] neg_lo:[1,0] neg_hi:[1,0]
  v_pk_fma_f32 v[186:187], v[146:147], v[26:27], v[186:187] neg_lo:[1,0,0] neg_hi:[1,0,0]
  v_pk_fma_f32 v[194:195], v[146:147], v[18:19], v[194:195]
  v_pk_fma_f32 v[202:203], v[162:163], v[26:27], v[202:203] neg_lo:[1,0,0] neg_hi:[1,0,0]
  v_pk_fma_f32 v[210:211], v[162:163], v[18:19], v[210:211] neg_lo:[1,0,0] neg_hi:[1,0,0]
  v_pk_fma_f32 v[186:187], v[154:155], v[42:43], v[186:187]
  v_pk_fma_f32 v[194:195], v[154:155], v[34:35], v[194:195] neg_lo:[1,0,0] neg_hi:[1,0,0]
  v_pk_fma_f32 v[202:203], v[170:171], v[42:43], v[202:203]
  v_pk_fma_f32 v[210:211], v[170:171], v[34:35], v[210:211]
  v_pk_fma_f32 v[186:187], v[162:163], v[34:35], v[186:187]
  v_pk_fma_f32 v[194:195], v[162:163], v[42:43], v[194:195]
  v_pk_fma_f32 v[202:203], v[178:179], v[34:35], v[202:203]
  v_pk_fma_f32 v[210:211], v[178:179], v[42:43], v[210:211] neg_lo:[1,0,0] neg_hi:[1,0,0]
  v_cvt_pk_bf16_f32 v233, v186, v187
  v_cvt_pk_bf16_f32 v237, v194, v195
  v_cvt_pk_bf16_f32 v241, v202, v203
  v_cvt_pk_bf16_f32 v245, v210, v211
  v_pk_mul_f32 v[188:189], v[140:141], v[20:21]
  v_pk_mul_f32 v[196:197], v[140:141], v[28:29]
  v_pk_mul_f32 v[204:205], v[156:157], v[20:21]
  v_pk_mul_f32 v[212:213], v[156:157], v[28:29] neg_lo:[1,0] neg_hi:[1,0]
  v_pk_fma_f32 v[188:189], v[148:149], v[28:29], v[188:189] neg_lo:[1,0,0] neg_hi:[1,0,0]
  v_pk_fma_f32 v[196:197], v[148:149], v[20:21], v[196:197]
  v_pk_fma_f32 v[204:205], v[164:165], v[28:29], v[204:205] neg_lo:[1,0,0] neg_hi:[1,0,0]
  v_pk_fma_f32 v[212:213], v[164:165], v[20:21], v[212:213] neg_lo:[1,0,0] neg_hi:[1,0,0]
  v_pk_fma_f32 v[188:189], v[156:157], v[44:45], v[188:189]
  v_pk_fma_f32 v[196:197], v[156:157], v[36:37], v[196:197] neg_lo:[1,0,0] neg_hi:[1,0,0]
  v_pk_fma_f32 v[204:205], v[172:173], v[44:45], v[204:205]
  v_pk_fma_f32 v[212:213], v[172:173], v[36:37], v[212:213]
  v_pk_fma_f32 v[188:189], v[164:165], v[36:37], v[188:189]
  v_pk_fma_f32 v[196:197], v[164:165], v[44:45], v[196:197]
  v_pk_fma_f32 v[204:205], v[180:181], v[36:37], v[204:205]
  v_pk_fma_f32 v[212:213], v[180:181], v[44:45], v[212:213] neg_lo:[1,0,0] neg_hi:[1,0,0]
  v_cvt_pk_bf16_f32 v234, v188, v189
  v_cvt_pk_bf16_f32 v238, v196, v197
  v_cvt_pk_bf16_f32 v242, v204, v205
  v_cvt_pk_bf16_f32 v246, v212, v213
  v_pk_mul_f32 v[190:191], v[142:143], v[22:23]
  v_pk_mul_f32 v[198:199], v[142:143], v[30:31]
  v_pk_mul_f32 v[206:207], v[158:159], v[22:23]
  v_pk_mul_f32 v[214:215], v[158:159], v[30:31] neg_lo:[1,0] neg_hi:[1,0]
  v_pk_fma_f32 v[190:191], v[150:151], v[30:31], v[190:191] neg_lo:[1,0,0] neg_hi:[1,0,0]
  v_pk_fma_f32 v[198:199], v[150:151], v[22:23], v[198:199]
  v_pk_fma_f32 v[206:207], v[166:167], v[30:31], v[206:207] neg_lo:[1,0,0] neg_hi:[1,0,0]
  v_pk_fma_f32 v[214:215], v[166:167], v[22:23], v[214:215] neg_lo:[1,0,0] neg_hi:[1,0,0]
  v_pk_fma_f32 v[190:191], v[158:159], v[46:47], v[190:191]
  v_pk_fma_f32 v[198:199], v[158:159], v[38:39], v[198:199] neg_lo:[1,0,0] neg_hi:[1,0,0]
  v_pk_fma_f32 v[206:207], v[174:175], v[46:47], v[206:207]
  v_pk_fma_f32 v[214:215], v[174:175], v[38:39], v[214:215]
  v_pk_fma_f32 v[190:191], v[166:167], v[38:39], v[190:191]
  v_pk_fma_f32 v[198:199], v[166:167], v[46:47], v[198:199]
  v_pk_fma_f32 v[206:207], v[182:183], v[38:39], v[206:207]
  v_pk_fma_f32 v[214:215], v[182:183], v[46:47], v[214:215] neg_lo:[1,0,0] neg_hi:[1,0,0]
  v_cvt_pk_bf16_f32 v235, v190, v191
  v_cvt_pk_bf16_f32 v239, v198, v199
  v_cvt_pk_bf16_f32 v243, v206, v207
  v_cvt_pk_bf16_f32 v247, v214, v215
  v_mfma_f32_16x16x32_bf16 v[16:19], v[232:235], v[72:75], 0
  v_mfma_f32_16x16x32_bf16 v[24:27], v[236:239], v[72:75], 0
  v_mfma_f32_16x16x32_bf16 v[32:35], v[240:243], v[80:83], 0
  v_mfma_f32_16x16x32_bf16 v[40:43], v[240:243], v[72:75], 0
  v_mfma_f32_16x16x32_bf16 v[16:19], v[236:239], v[80:83], v[16:19]
  v_mfma_f32_16x16x32_bf16 v[24:27], v[232:235], v[96:99], v[24:27]
  v_mfma_f32_16x16x32_bf16 v[32:35], v[244:247], v[72:75], v[32:35]
  v_mfma_f32_16x16x32_bf16 v[40:43], v[244:247], v[96:99], v[40:43]
  v_mfma_f32_16x16x32_bf16 v[20:23], v[232:235], v[76:79], 0
  v_mfma_f32_16x16x32_bf16 v[28:31], v[236:239], v[76:79], 0
  v_mfma_f32_16x16x32_bf16 v[36:39], v[240:243], v[84:87], 0
  v_mfma_f32_16x16x32_bf16 v[44:47], v[240:243], v[76:79], 0
  v_mfma_f32_16x16x32_bf16 v[20:23], v[236:239], v[84:87], v[20:23]
  v_mfma_f32_16x16x32_bf16 v[28:31], v[232:235], v[100:103], v[28:31]
  v_mfma_f32_16x16x32_bf16 v[36:39], v[244:247], v[76:79], v[36:39]
  v_mfma_f32_16x16x32_bf16 v[44:47], v[244:247], v[100:103], v[44:47]
  v_cvt_pk_bf16_f32 v184, v16, v17
  v_cvt_pk_bf16_f32 v185, v18, v19
  ds_write_b64 v10, v[184:185] offset:0
  v_cvt_pk_bf16_f32 v186, v24, v25
  v_cvt_pk_bf16_f32 v187, v26, v27
  ds_write_b64 v10, v[186:187] offset:32
  v_cvt_pk_bf16_f32 v188, v32, v33
  v_cvt_pk_bf16_f32 v189, v34, v35
  ds_write_b64 v10, v[188:189] offset:64
  v_cvt_pk_bf16_f32 v190, v40, v41
  v_cvt_pk_bf16_f32 v191, v42, v43
  ds_write_b64 v10, v[190:191] offset:96
  ds_read_b128 v[200:203], v11 offset:0
  ds_read_b128 v[204:207], v11 offset:1152
  v_cvt_pk_bf16_f32 v192, v20, v21
  v_cvt_pk_bf16_f32 v193, v22, v23
  ds_write_b64 v10, v[192:193] offset:2304
  v_cvt_pk_bf16_f32 v194, v28, v29
  v_cvt_pk_bf16_f32 v195, v30, v31
  ds_write_b64 v10, v[194:195] offset:2336
  v_cvt_pk_bf16_f32 v196, v36, v37
  v_cvt_pk_bf16_f32 v197, v38, v39
  ds_write_b64 v10, v[196:197] offset:2368
  v_cvt_pk_bf16_f32 v198, v44, v45
  v_cvt_pk_bf16_f32 v199, v46, v47
  ds_write_b64 v10, v[198:199] offset:2400
  ds_read_b128 v[208:211], v11 offset:2304
  ds_read_b128 v[212:215], v11 offset:3456
  s_waitcnt lgkmcnt(7)
  buffer_store_dwordx4 v[200:203], v12, s[36:39], s64 offen sc1
  s_waitcnt lgkmcnt(6)
  buffer_store_dwordx4 v[204:207], v12, s[36:39], s65 offen sc1
  s_waitcnt lgkmcnt(1)
  buffer_store_dwordx4 v[208:211], v12, s[36:39], s66 offen sc1
  s_waitcnt lgkmcnt(0)
  buffer_store_dwordx4 v[212:215], v12, s[36:39], s67 offen sc1
  s_mov_b64 exec, -1
  s_branch P1_end
K12_helper:
  s_setprio 0
  v_mul_u32_u24 v6, 13, v0
  v_lshrrev_b32 v6, 8, v6
  v_mul_u32_u24 v7, 20, v6
  v_sub_u32 v7, v0, v7
  v_lshl_add_u32 v1, v6, 6, s6
  v_sub_u32 v5, 2048, v1
  s_bitcmp1_b32 s3, 1
  s_cselect_b64 vcc, -1, 0
  s_cselect_b32 s55, 4294844032, 0
  s_cselect_b32 s53, 0, 123264
  s_add_u32 s55, s55, s53
  v_cndmask_b32 v1, v1, v5, vcc
  v_and_b32 v5, 2047, v1
  s_lshl_b32 s53, s45, 6
  s_lshl_b32 s52, s44, 1
  s_add_u32 s53, s53, s52
  v_mul_u32_u24 v1, 642, v1
  v_mul_u32_u24 v5, 642, v5
  v_add_u32 v1, s53, v1
  v_add_u32 v5, s53, v5
  v_and_b32 v8, 63, v1
  s_lshl_b32 s52, s7, 6
  v_add_u32 v8, s52, v8
  v_lshlrev_b32 v9, 4, v7
  v_cmp_lt_u32 vcc, v9, v8
  v_and_b32 v1, 0xffffffc0, v1
  v_and_b32 v5, 0xffffffc0, v5
  v_lshl_add_u32 v1, v7, 4, v1
  v_lshl_add_u32 v5, v7, 4, v5
  v_cmp_gt_u32 s[62:63], 60, v0
  s_nop 0
  s_and_b64 s[62:63], s[62:63], vcc
  s_mul_i32 s57, s3, 10560
  s_add_u32 s57, s57, 75776
  s_waitcnt lgkmcnt(0)
  s_mov_b32 s36, s30
  s_mov_b32 s37, s31
  s_mov_b32 s38, 24416256
  s_mov_b32 s39, 0x20000
  s_bitcmp1_b32 s3, 0
  s_cselect_b32 s32, s12, s10
  s_cselect_b32 s33, s13, s11
  s_mov_b32 s34, 1314816
  s_mov_b32 s35, 0x20000
  s_bitcmp1_b32 s3, 1
  s_cselect_b32 s50, 0, s6
  s_cselect_b32 s51, s6, 0
  s_cselect_b32 s52, 0, 1
  s_and_b32 s53, s6, 31
  s_or_b32 s53, s53, s52
  s_cmp_eq_u32 s53, 0
  s_cselect_b32 s56, 0.5, 1.0
  s_bitcmp1_b32 s3, 0
  s_cselect_b32 s52, 0x3e800000, 0
  s_lshl_b32 s53, s3, 11
  s_add_u32 s53, s53, 118016
  v_add_u32 v12, s53, v2
  v_lshrrev_b32 v8, 4, v0
  v_lshlrev_b32 v8, 2, v8
  v_and_b32 v6, 15, v0
  v_add_u32 v6, 0, v6
  v_lshl_add_u32 v7, v6, 6, s50
  v_mul_u32_u24 v9, s51, v6
  v_mul_u32_u24 v10, v8, v7
  v_add_u32 v10, v10, v9
  v_cvt_f32_u32 v6, v7
  v_cvt_f32_u32 v10, v10
  v_mul_f32 v6, 0x3a000000, v6
  v_mov_b32 v11, s52
  v_fmac_f32 v11, 0x3a000000, v10
  v_fmamk_f32 v225, v6, 0x3f800000, v11
  v_fmamk_f32 v226, v6, 0x40000000, v11
  v_fmamk_f32 v227, v6, 0x40400000, v11
  v_fmamk_f32 v228, v6, 0x41800000, v11
  v_fmamk_f32 v229, v6, 0x41880000, v11
  v_fmamk_f32 v230, v6, 0x41900000, v11
  v_fmamk_f32 v231, v6, 0x41980000, v11
  v_cos_f32 v224, v11
  v_cos_f32 v225, v225
  v_cos_f32 v226, v226
  v_cos_f32 v227, v227
  v_cos_f32 v228, v228
  v_cos_f32 v229, v229
  v_cos_f32 v230, v230
  v_cos_f32 v231, v231
  v_mul_f32 v224, s56, v224
  v_mul_f32 v225, s56, v225
  v_mul_f32 v226, s56, v226
  v_mul_f32 v227, s56, v227
  v_mul_f32 v228, s56, v228
  v_mul_f32 v229, s56, v229
  v_mul_f32 v230, s56, v230
  v_mul_f32 v231, s56, v231
  v_cvt_pk_bf16_f32 v232, v224, v225
  v_cvt_pk_bf16_f32 v233, v226, v227
  v_cvt_pk_bf16_f32 v234, v228, v229
  v_cvt_pk_bf16_f32 v235, v230, v231
  ds_write_b128 v12, v[232:235] offset:0
  v_and_b32 v6, 15, v0
  v_add_u32 v6, 16, v6
  v_lshl_add_u32 v7, v6, 6, s50
  v_mul_u32_u24 v9, s51, v6
  v_mul_u32_u24 v10, v8, v7
  v_add_u32 v10, v10, v9
  v_cvt_f32_u32 v6, v7
  v_cvt_f32_u32 v10, v10
  v_mul_f32 v6, 0x3a000000, v6
  v_mov_b32 v11, s52
  v_fmac_f32 v11, 0x3a000000, v10
  v_fmamk_f32 v225, v6, 0x3f800000, v11
  v_fmamk_f32 v226, v6, 0x40000000, v11
  v_fmamk_f32 v227, v6, 0x40400000, v11
  v_fmamk_f32 v228, v6, 0x41800000, v11
  v_fmamk_f32 v229, v6, 0x41880000, v11
  v_fmamk_f32 v230, v6, 0x41900000, v11
  v_fmamk_f32 v231, v6, 0x41980000, v11
  v_cos_f32 v224, v11
  v_cos_f32 v225, v225
  v_cos_f32 v226, v226
  v_cos_f32 v227, v227
  v_cos_f32 v228, v228
  v_cos_f32 v229, v229
  v_cos_f32 v230, v230
  v_cos_f32 v231, v231
  v_mul_f32 v224, s56, v224
  v_mul_f32 v225, s56, v225
  v_mul_f32 v226, s56, v226
  v_mul_f32 v227, s56, v227
  v_mul_f32 v228, s56, v228
  v_mul_f32 v229, s56, v229
  v_mul_f32 v230, s56, v230
  v_mul_f32 v231, s56, v231
  v_cvt_pk_bf16_f32 v236, v224, v225
  v_cvt_pk_bf16_f32 v237, v226, v227
  v_cvt_pk_bf16_f32 v238, v228, v229
  v_cvt_pk_bf16_f32 v239, v230, v231
  ds_write_b128 v12, v[236:239] offset:1024
  s_mov_b32 s40, s28
  s_mov_b32 s41, s29
  s_mov_b32 s42, 256
  s_mov_b32 s43, 0x20000
  v_and_b32 v244, 7, v0
  v_lshlrev_b32 v244, 2, v244
  s_and_b32 s5, s2, 15
  s_lshl_b32 s4, s5, 7
  s_add_u32 s4, s4, 21782528
  s_lshl_b32 s5, s5, 6
  s_add_u32 s5, s5, 21784576
  v_mov_b32 v240, 1
  v_mov_b32 v241, 0
  v_mov_b32 v242, 1
  v_lshlrev_b32 v243, 10, v0
  s_and_b32 s68, s2, 12
  s_cmp_eq_u32 s68, 0
  s_cselect_b32 s68, 11, 10
  s_cmp_ge_u32 s2, 160
  s_cbranch_scc1 Ha_b0
  s_barrier
Ha_b0:
  s_cmp_eq_u32 s15, 7
  s_cbranch_scc0 Ha_n2
  s_mov_b32 s14, 0x10000
  s_nop 4
SP_na:
  buffer_load_dword v245, v244, s[40:43], 0 offen offset:0 sc0 sc1
  s_sub_u32 s14, s14, 1
  s_waitcnt vmcnt(0)
  v_cmp_ne_u32 vcc, 1, v245
  s_cmp_eq_u32 s14, 0
  s_cbranch_scc1 SG_na
  s_nop 3
  s_cbranch_vccnz SP_na
SG_na:
  s_nop 1
Ha_n2:
  s_waitcnt vmcnt(0)
  s_barrier
  s_cmp_eq_u32 s15, 6
  s_cbranch_scc0 Ha_w
  s_cmp_ge_u32 s2, 180
  s_cbranch_scc0 Ha_w
  s_mov_b32 s4, 21793024
  s_mov_b32 s5, 21793280
  v_lshlrev_b32 v243, 7, v0
  s_mov_b64 exec, 1
  buffer_atomic_add v240, v241, s[36:39], s4 offen sc0 sc1
  s_waitcnt vmcnt(0)
  v_readfirstlane_b32 s4, v240
  s_mov_b64 exec, 255
  s_cmp_eq_u32 s4, 27
  s_cbranch_scc0 GA_wa
  buffer_store_dword v242, v243, s[36:39], s5 offen sc0 sc1
GA_wa:
  s_mov_b64 exec, -1
Ha_w:
  s_cmp_eq_u32 s15, 7
  s_cbranch_scc0 Ha_a
  s_cmp_ge_u32 s2, 180
  s_cbranch_scc1 Ha_a
  s_mov_b64 exec, 1
  buffer_atomic_add v240, v241, s[36:39], s4 offen sc0 sc1
  s_waitcnt vmcnt(0)
  v_readfirstlane_b32 s4, v240
  s_mov_b64 exec, 255
  s_cmp_eq_u32 s4, s68
  s_cbranch_scc0 GA_0
  buffer_store_dword v242, v243, s[36:39], s5 offen sc0 sc1
GA_0:
  s_mov_b64 exec, -1
Ha_a:
  s_mov_b64 exec, s[62:63]
  s_mov_b32 m0, s57
  s_nop 0
  buffer_load_dwordx4 v5, s[32:35], 0 offen lds
  s_mov_b64 exec, -1
  s_mov_b64 exec, s[62:63]
  v_add_u32 v1, s55, v1
  s_add_u32 m0, m0, 960
  s_nop 0
  buffer_load_dwordx4 v1, s[32:35], 0 offen lds
  s_mov_b64 exec, -1
  s_mov_b64 exec, s[62:63]
  v_add_u32 v1, s55, v1
  s_add_u32 m0, m0, 960
  s_nop 0
  buffer_load_dwordx4 v1, s[32:35], 0 offen lds
  s_mov_b64 exec, -1
  s_mov_b64 exec, s[62:63]
  v_add_u32 v1, s55, v1
  s_add_u32 m0, m0, 960
  s_nop 0
  buffer_load_dwordx4 v1, s[32:35], 0 offen lds
  s_mov_b64 exec, -1
  s_mov_b64 exec, s[62:63]
  v_add_u32 v1, s55, v1
  s_add_u32 m0, m0, 960
  s_nop 0
  buffer_load_dwordx4 v1, s[32:35], 0 offen lds
  s_mov_b64 exec, -1
  s_mov_b64 exec, s[62:63]
  v_add_u32 v1, s55, v1
  s_add_u32 m0, m0, 960
  s_nop 0
  buffer_load_dwordx4 v1, s[32:35], 0 offen lds
  s_mov_b64 exec, -1
  s_mov_b64 exec, s[62:63]
  v_add_u32 v1, s55, v1
  s_add_u32 m0, m0, 960
  s_nop 0
  buffer_load_dwordx4 v1, s[32:35], 0 offen lds
  s_mov_b64 exec, -1
  s_mov_b64 exec, s[62:63]
  v_add_u32 v1, s55, v1
  s_add_u32 m0, m0, 960
  s_nop 0
  buffer_load_dwordx4 v1, s[32:35], 0 offen lds
  s_mov_b64 exec, -1
  s_mov_b64 exec, s[62:63]
  v_add_u32 v1, s55, v1
  s_add_u32 m0, m0, 960
  s_nop 0
  buffer_load_dwordx4 v1, s[32:35], 0 offen lds
  s_mov_b64 exec, -1
  s_mov_b64 exec, s[62:63]
  v_add_u32 v1, s55, v1
  s_add_u32 m0, m0, 960
  s_nop 0
  buffer_load_dwordx4 v1, s[32:35], 0 offen lds
  s_mov_b64 exec, -1
  s_mov_b64 exec, s[62:63]
  v_add_u32 v1, s55, v1
  s_add_u32 m0, m0, 960
  s_nop 0
  buffer_load_dwordx4 v1, s[32:35], 0 offen lds
  s_mov_b64 exec, -1
K12_hw:
  s_waitcnt vmcnt(0) lgkmcnt(0)
  s_barrier
  buffer_load_dwordx4 v[208:211], v2, s[36:39], s61 offen sc1
  s_mov_b64 exec, 0xffff
  buffer_load_dwordx4 v[212:215], v2, s[36:39], s61 offen offset:1024 sc1
  s_mov_b64 exec, -1
  buffer_load_dwordx4 v[16:19], v248, s[36:39], s60 offen offset:0 sc1
  buffer_load_dwordx4 v[20:23], v248, s[36:39], s60 offen offset:128 sc1
  buffer_load_dwordx4 v[24:27], v248, s[36:39], s60 offen offset:256 sc1
  buffer_load_dwordx4 v[28:31], v248, s[36:39], s60 offen offset:384 sc1
  buffer_load_dwordx4 v[32:35], v248, s[36:39], s60 offen offset:512 sc1
  buffer_load_dwordx4 v[36:39], v248, s[36:39], s60 offen offset:640 sc1
  buffer_load_dwordx4 v[40:43], v248, s[36:39], s60 offen offset:768 sc1
  buffer_load_dwordx4 v[44:47], v248, s[36:39], s60 offen offset:896 sc1
  buffer_load_dwordx4 v[48:51], v248, s[36:39], s60 offen offset:1024 sc1
  buffer_load_dwordx4 v[52:55], v248, s[36:39], s60 offen offset:1152 sc1
  s_waitcnt vmcnt(10)
  v_mov_b32 v176, v212
  s_cmp_eq_u32 s59, 0
  s_cbranch_scc1 K12_hnh
  v_mov_b32 v208, s58
  v_mov_b32 v209, s58
  v_mov_b32 v210, s58
  v_mov_b32 v211, s58
  v_mov_b32 v212, s58
  v_mov_b32 v213, s58
  v_mov_b32 v214, s58
  v_mov_b32 v215, s58
K12_hnh:
  ds_write_b128 v249, v[208:211]
  ds_write_b128 v249, v[212:215] offset:1024
  ds_read_b128 v[96:99], v250 offset:0
  ds_read_b128 v[100:103], v250 offset:128
  ds_read_b128 v[104:107], v250 offset:256
  ds_read_b128 v[108:111], v250 offset:384
  ds_read_b128 v[112:115], v250 offset:512
  ds_read_b128 v[116:119], v250 offset:640
  ds_read_b128 v[120:123], v250 offset:768
  ds_read_b128 v[124:127], v250 offset:896
  ds_read_b128 v[128:131], v250 offset:1024
  ds_read_b128 v[132:135], v250 offset:1152
  s_waitcnt vmcnt(9) lgkmcnt(9)
  v_dot2_f32_bf16 v176, v16, v96, 0
  v_dot2_f32_bf16 v177, v18, v98, 0
  v_dot2_f32_bf16 v178, v17, v97, 0
  v_dot2_f32_bf16 v179, v19, v99, 0
  s_waitcnt vmcnt(8) lgkmcnt(8)
  v_dot2_f32_bf16 v184, v20, v100, 0
  v_dot2_f32_bf16 v185, v22, v102, 0
  v_dot2_f32_bf16 v186, v21, v101, 0
  v_dot2_f32_bf16 v187, v23, v103, 0
  s_waitcnt vmcnt(7) lgkmcnt(7)
  v_dot2_f32_bf16 v192, v24, v104, 0
  v_dot2_f32_bf16 v193, v26, v106, 0
  v_dot2_f32_bf16 v194, v25, v105, 0
  v_dot2_f32_bf16 v195, v27, v107, 0
  s_waitcnt vmcnt(6) lgkmcnt(6)
  v_dot2_f32_bf16 v200, v28, v108, 0
  v_dot2_f32_bf16 v201, v30, v110, 0
  v_dot2_f32_bf16 v202, v29, v109, 0
  v_dot2_f32_bf16 v203, v31, v111, 0
  v_pk_add_f32 v[180:181], v[176:177], v[178:179]
  v_pk_add_f32 v[182:183], v[176:177], v[178:179] neg_lo:[0,1] neg_hi:[0,1]
  v_pk_add_f32 v[188:189], v[184:185], v[186:187]
  v_pk_add_f32 v[190:191], v[184:185], v[186:187] neg_lo:[0,1] neg_hi:[0,1]
  v_pk_add_f32 v[196:197], v[192:193], v[194:195]
  v_pk_add_f32 v[198:199], v[192:193], v[194:195] neg_lo:[0,1] neg_hi:[0,1]
  v_pk_add_f32 v[204:205], v[200:201], v[202:203]
  v_pk_add_f32 v[206:207], v[200:201], v[202:203] neg_lo:[0,1] neg_hi:[0,1]
  v_cvt_pk_bf16_f32 v208, v180, v181
  v_cvt_pk_bf16_f32 v212, v182, v183
  v_cvt_pk_bf16_f32 v209, v188, v189
  v_cvt_pk_bf16_f32 v213, v190, v191
  v_cvt_pk_bf16_f32 v210, v196, v197
  v_cvt_pk_bf16_f32 v214, v198, v199
  v_cvt_pk_bf16_f32 v211, v204, v205
  v_cvt_pk_bf16_f32 v215, v206, v207
  ds_write_b128 v251, v[208:211] offset:0
  ds_write_b128 v251, v[212:215] offset:20480
  s_waitcnt vmcnt(5) lgkmcnt(7)
  v_dot2_f32_bf16 v176, v32, v112, 0
  v_dot2_f32_bf16 v177, v34, v114, 0
  v_dot2_f32_bf16 v178, v33, v113, 0
  v_dot2_f32_bf16 v179, v35, v115, 0
  s_waitcnt vmcnt(4) lgkmcnt(6)
  v_dot2_f32_bf16 v184, v36, v116, 0
  v_dot2_f32_bf16 v185, v38, v118, 0
  v_dot2_f32_bf16 v186, v37, v117, 0
  v_dot2_f32_bf16 v187, v39, v119, 0
  s_waitcnt vmcnt(3) lgkmcnt(5)
  v_dot2_f32_bf16 v192, v40, v120, 0
  v_dot2_f32_bf16 v193, v42, v122, 0
  v_dot2_f32_bf16 v194, v41, v121, 0
  v_dot2_f32_bf16 v195, v43, v123, 0
  s_waitcnt vmcnt(2) lgkmcnt(4)
  v_dot2_f32_bf16 v200, v44, v124, 0
  v_dot2_f32_bf16 v201, v46, v126, 0
  v_dot2_f32_bf16 v202, v45, v125, 0
  v_dot2_f32_bf16 v203, v47, v127, 0
  v_pk_add_f32 v[180:181], v[176:177], v[178:179]
  v_pk_add_f32 v[182:183], v[176:177], v[178:179] neg_lo:[0,1] neg_hi:[0,1]
  v_pk_add_f32 v[188:189], v[184:185], v[186:187]
  v_pk_add_f32 v[190:191], v[184:185], v[186:187] neg_lo:[0,1] neg_hi:[0,1]
  v_pk_add_f32 v[196:197], v[192:193], v[194:195]
  v_pk_add_f32 v[198:199], v[192:193], v[194:195] neg_lo:[0,1] neg_hi:[0,1]
  v_pk_add_f32 v[204:205], v[200:201], v[202:203]
  v_pk_add_f32 v[206:207], v[200:201], v[202:203] neg_lo:[0,1] neg_hi:[0,1]
  v_cvt_pk_bf16_f32 v216, v180, v181
  v_cvt_pk_bf16_f32 v220, v182, v183
  v_cvt_pk_bf16_f32 v217, v188, v189
  v_cvt_pk_bf16_f32 v221, v190, v191
  v_cvt_pk_bf16_f32 v218, v196, v197
  v_cvt_pk_bf16_f32 v222, v198, v199
  v_cvt_pk_bf16_f32 v219, v204, v205
  v_cvt_pk_bf16_f32 v223, v206, v207
  ds_write_b128 v251, v[216:219] offset:2048
  ds_write_b128 v251, v[220:223] offset:22528
  s_waitcnt vmcnt(1) lgkmcnt(5)
  v_dot2_f32_bf16 v176, v48, v128, 0
  v_dot2_f32_bf16 v177, v50, v130, 0
  v_dot2_f32_bf16 v178, v49, v129, 0
  v_dot2_f32_bf16 v179, v51, v131, 0
  s_waitcnt vmcnt(0) lgkmcnt(4)
  v_dot2_f32_bf16 v184, v52, v132, 0
  v_dot2_f32_bf16 v185, v54, v134, 0
  v_dot2_f32_bf16 v186, v53, v133, 0
  v_dot2_f32_bf16 v187, v55, v135, 0
  v_pk_add_f32 v[180:181], v[176:177], v[178:179]
  v_pk_add_f32 v[182:183], v[176:177], v[178:179] neg_lo:[0,1] neg_hi:[0,1]
  s_nop 0
  v_pk_add_f32 v[188:189], v[184:185], v[186:187]
  v_pk_add_f32 v[190:191], v[184:185], v[186:187] neg_lo:[0,1] neg_hi:[0,1]
  v_cvt_pk_bf16_f32 v208, v180, v181
  v_cvt_pk_bf16_f32 v212, v182, v183
  v_cvt_pk_bf16_f32 v209, v188, v189
  v_cvt_pk_bf16_f32 v213, v190, v191
  ds_write_b64 v252, v[208:209] offset:4096
  ds_write_b64 v252, v[212:213] offset:24576
  s_waitcnt lgkmcnt(0)
  s_barrier
  s_mov_b64 exec, -1
  s_branch P1_end
K12_wp:
  s_waitcnt lgkmcnt(0)
  s_mov_b32 s36, s30
  s_mov_b32 s37, s31
  s_mov_b32 s38, 24416256
  s_mov_b32 s39, 0x20000
  s_cmp_ge_u32 s2, 208
  s_cbranch_scc1 SD_start
  s_cmp_ge_u32 s15, 4
  s_cbranch_scc0 P1_end
  s_mov_b32 s40, s28
  s_mov_b32 s41, s29
  s_mov_b32 s42, 256
  s_mov_b32 s43, 0x20000
  v_and_b32 v244, 7, v0
  v_lshlrev_b32 v244, 2, v244
  s_and_b32 s5, s2, 15
  s_lshl_b32 s4, s5, 7
  s_add_u32 s4, s4, 21782528
  s_lshl_b32 s5, s5, 6
  s_add_u32 s5, s5, 21784576
  v_mov_b32 v240, 1
  v_mov_b32 v241, 0
  v_mov_b32 v242, 1
  v_lshlrev_b32 v243, 10, v0
  s_and_b32 s68, s2, 12
  s_cmp_eq_u32 s68, 0
  s_cselect_b32 s68, 11, 10
Hb_b0:
  s_cmp_eq_u32 s15, 7
  s_cbranch_scc0 Hb_n2
  s_mov_b32 s14, 0x10000
  s_nop 4
SP_nb:
  buffer_load_dword v245, v244, s[40:43], 0 offen offset:0 sc0 sc1
  s_sub_u32 s14, s14, 1
  s_waitcnt vmcnt(0)
  v_cmp_ne_u32 vcc, 1, v245
  s_cmp_eq_u32 s14, 0
  s_cbranch_scc1 SG_nb
  s_nop 3
  s_cbranch_vccnz SP_nb
SG_nb:
  s_nop 1
Hb_n2:
  s_waitcnt vmcnt(0)
  s_barrier
  s_cmp_eq_u32 s15, 6
  s_cbranch_scc0 Hb_w
  s_cmp_ge_u32 s2, 180
  s_cbranch_scc0 Hb_w
  s_mov_b32 s4, 21793024
  s_mov_b32 s5, 21793280
  v_lshlrev_b32 v243, 7, v0
  s_mov_b64 exec, 1
  buffer_atomic_add v240, v241, s[36:39], s4 offen sc0 sc1
  s_waitcnt vmcnt(0)
  v_readfirstlane_b32 s4, v240
  s_mov_b64 exec, 255
  s_cmp_eq_u32 s4, 27
  s_cbranch_scc0 GA_wb
  buffer_store_dword v242, v243, s[36:39], s5 offen sc0 sc1
GA_wb:
  s_mov_b64 exec, -1
Hb_w:
  s_branch P1_end
SD_start:
  s_sub_u32 s4, s2, 208
  s_and_b32 s7, s4, 7
  s_mul_i32 s5, s7, 3
  s_lshr_b32 s6, s4, 4
  s_add_u32 s5, s5, s6
  s_bfe_u32 s6, s4, 0x10003
  s_mul_i32 s7, s7, 6
  s_lshr_b32 s44, s4, 3
  s_add_u32 s7, s7, s44
  s_and_b32 s45, s3, 3
  s_lshr_b32 s46, s3, 2
  s_bfe_u32 s48, s3, 0x10001
  v_lshrrev_b32 v2, 3, v0
  v_and_b32 v3, 7, v0
  v_bfe_u32 v4, v0, 4, 1
  s_lshl_b32 s49, s48, 2
  v_lshl_add_u32 v4, v4, 1, s49
  v_xor_b32 v4, v4, v3
  v_mul_u32_u24 v2, 3072, v2
  v_lshl_add_u32 v2, v4, 4, v2
  s_mul_i32 s47, s6, 20
  s_add_u32 s47, s47, s46
  s_lshl_b32 s49, s47, 1
  s_and_b32 s50, s3, 1
  s_add_u32 s49, s49, s50
  s_mul_i32 s49, s49, 24576
  s_lshl_b32 s50, s5, 7
  s_add_u32 s49, s49, s50
  v_lshlrev_b32 v5, 4, v0
  s_waitcnt lgkmcnt(0)
  s_cmp_eq_u32 s48, 0
  s_cselect_b32 s32, s16, s18
  s_cselect_b32 s33, s17, s19
  s_mov_b32 s34, 1966080
  s_mov_b32 s35, 0x20000
  s_mov_b32 s36, s30
  s_mov_b32 s37, s31
  s_mov_b32 s38, 24416256
  s_mov_b32 s39, 0x20000
  s_cmp_ge_u32 s15, 4
  s_cbranch_scc0 SD_nd
  s_lshl_b32 m0, s45, 10
  s_sub_u32 s49, s49, 49152
  buffer_load_dwordx4 v2, s[32:35], s49 offen nt lds
  s_add_u32 m0, m0, 4096
  s_add_u32 s49, s49, 49152
  buffer_load_dwordx4 v2, s[32:35], s49 offen nt lds
  s_add_u32 m0, m0, 4096
  s_add_u32 s49, s49, 49152
  buffer_load_dwordx4 v2, s[32:35], s49 offen nt lds
  s_add_u32 m0, m0, 4096
  s_add_u32 s49, s49, 49152
  buffer_load_dwordx4 v2, s[32:35], s49 offen nt lds
  s_add_u32 m0, m0, 4096
  s_add_u32 s49, s49, 49152
  buffer_load_dwordx4 v2, s[32:35], s49 offen nt lds
  s_add_u32 m0, m0, 4096
  s_add_u32 s49, s49, 49152
  buffer_load_dwordx4 v2, s[32:35], s49 offen nt lds
  s_add_u32 m0, m0, 4096
  s_add_u32 s49, s49, 49152
  buffer_load_dwordx4 v2, s[32:35], s49 offen nt lds
  s_add_u32 m0, m0, 4096
  s_add_u32 s49, s49, 49152
  buffer_load_dwordx4 v2, s[32:35], s49 offen nt lds
  s_add_u32 m0, m0, 4096
  s_add_u32 s49, s49, 49152
  buffer_load_dwordx4 v2, s[32:35], s49 offen nt lds
  s_add_u32 m0, m0, 4096
  s_add_u32 s49, s49, 49152
  buffer_load_dwordx4 v2, s[32:35], s49 offen nt lds
  s_add_u32 m0, m0, 4096
  s_add_u32 s49, s49, 49152
  v_mov_b32 v20, 143360
  s_mov_b32 s14, 0x200000
  s_cmp_ge_u32 s2, 248
  s_cbranch_scc1 TH_g
TH_p:
  ds_read_b32 v21, v20
  s_sub_u32 s14, s14, 1
  s_waitcnt lgkmcnt(0)
  v_readfirstlane_b32 s55, v21
  s_cmp_eq_u32 s14, 0
  s_cbranch_scc1 TH_g
  s_cmp_eq_u32 s55, 4
  s_cbranch_scc0 TH_p
TH_g:
  buffer_load_dwordx4 v2, s[32:35], s49 offen nt lds
  s_add_u32 m0, m0, 4096
  s_add_u32 s49, s49, 49152
  buffer_load_dwordx4 v2, s[32:35], s49 offen nt lds
  s_add_u32 m0, m0, 4096
  s_add_u32 s49, s49, 49152
  buffer_load_dwordx4 v2, s[32:35], s49 offen nt lds
  s_add_u32 m0, m0, 4096
  s_add_u32 s49, s49, 49152
  buffer_load_dwordx4 v2, s[32:35], s49 offen nt lds
  s_add_u32 m0, m0, 4096
  s_add_u32 s49, s49, 49152
  buffer_load_dwordx4 v2, s[32:35], s49 offen nt lds
  s_add_u32 m0, m0, 4096
  s_add_u32 s49, s49, 49152
  buffer_load_dwordx4 v2, s[32:35], s49 offen nt lds
  s_add_u32 m0, m0, 4096
  s_add_u32 s49, s49, 49152
  buffer_load_dwordx4 v2, s[32:35], s49 offen nt lds
  s_add_u32 m0, m0, 4096
  s_add_u32 s49, s49, 49152
  buffer_load_dwordx4 v2, s[32:35], s49 offen nt lds
  s_add_u32 m0, m0, 4096
  s_add_u32 s49, s49, 49152
  buffer_load_dwordx4 v2, s[32:35], s49 offen nt lds
  s_add_u32 m0, m0, 4096
  s_add_u32 s49, s49, 49152
  buffer_load_dwordx4 v2, s[32:35], s49 offen nt lds
  s_add_u32 m0, m0, 4096
  s_add_u32 s49, s49, 49152
SD_nd:
  v_and_b32 v63, 15, v0
  v_bfe_u32 v18, v0, 2, 2
  v_and_b32 v19, 3, v0
  v_bfe_u32 v6, v0, 4, 1
  v_lshrrev_b32 v7, 5, v0
  v_bfe_u32 v9, v0, 3, 2
  v_xor_b32 v9, s45, v9
  v_lshlrev_b32 v9, 5, v9
  v_lshl_add_u32 v9, v6, 11, v9
  v_lshl_add_u32 v9, v7, 10, v9
  v_lshl_add_u32 v9, v18, 7, v9
  v_lshl_add_u32 v9, v19, 3, v9
  s_lshl_b32 s49, s46, 12
  v_add_u32 v9, s49, v9
  v_add_u32 v8, 40960, v9
  s_lshl_b32 s49, s46, 6
  s_add_u32 s49, s49, 122880
  v_lshl_add_u32 v10, v7, 5, s49
  s_lshl_b32 s49, s46, 5
  s_add_u32 s49, s49, 124928
  v_lshl_add_u32 v11, v7, 4, s49
  v_mov_b32 v12, 0x3f803f80
  v_mov_b32 v13, v12
  v_mov_b32 v14, v12
  v_mov_b32 v15, v12
  s_lshl_b32 s50, s5, 1
  s_lshr_b32 s51, s45, 1
  s_add_u32 s50, s50, s51
  s_mul_i32 s50, s50, 84
  s_and_b32 s51, s45, 1
  s_add_u32 s50, s50, s51
  s_lshl_b32 s51, s47, 1
  s_add_u32 s51, s51, s50
  s_lshl_b32 s51, s51, 10
  s_add_u32 s51, s51, 9347072
  s_mov_b32 s63, 0xffff0000
  s_mov_b32 s54, s3
  s_mov_b32 s57, s5
  s_cmp_eq_u32 s15, 1
  s_cbranch_scc0 SD_b
  s_mov_b32 s40, s28
  s_mov_b32 s41, s29
  s_mov_b32 s42, 256
  s_mov_b32 s43, 0x20000
  v_and_b32 v240, 7, v0
  v_lshlrev_b32 v240, 2, v240
  s_mov_b32 s14, 0x10000
  s_nop 4
SP_ns:
  buffer_load_dword v241, v240, s[40:43], 0 offen offset:0 sc0 sc1
  s_sub_u32 s14, s14, 1
  s_waitcnt vmcnt(0)
  v_cmp_ne_u32 vcc, 1, v241
  s_cmp_eq_u32 s14, 0
  s_cbranch_scc1 SG_ns
  s_nop 3
  s_cbranch_vccnz SP_ns
SG_ns:
  s_nop 1
  v_mov_b32 v240, 0
  s_mov_b32 s4, 21792896
  s_mov_b32 s14, 0x10000
  s_nop 4
SP_sf:
  buffer_load_dword v241, v240, s[36:39], s4 offen offset:0 sc0 sc1
  s_sub_u32 s14, s14, 1
  s_waitcnt vmcnt(0)
  v_cmp_ne_u32 vcc, 1, v241
  s_cmp_eq_u32 s14, 0
  s_cbranch_scc1 SG_sf
  s_nop 3
  s_cbranch_vccnz SP_sf
SG_sf:
  s_nop 1
SD_b:
  s_barrier
  s_cmp_ge_u32 s3, 3
  s_cbranch_scc1 K12_wpn
  s_mul_i32 s52, s6, 1280
  s_lshl_b32 s55, s3, 10
  s_add_u32 s52, s52, s55
  s_add_u32 s52, s52, 18432
  s_mul_i32 s56, s6, 640
  s_add_u32 s56, s56, 3840
  s_cmp_eq_u32 s3, 2
  s_cselect_b32 s52, s56, s52
  s_add_u32 m0, s55, 122880
  s_nop 0
  buffer_load_dwordx4 v5, s[36:39], s52 offen sc1 lds
K12_wpn:
  s_waitcnt vmcnt(0)
  s_barrier
  ds_read_b64_tr_b16 v[64:65], v9 offset:0
  ds_read_b64_tr_b16 v[66:67], v9 offset:512
  ds_read_b128 v[68:71], v10 offset:0
  ds_read_b128 v[72:75], v10 offset:16
  ds_read_b128 v[76:79], v11 offset:0
  ds_read_b64_tr_b16 v[80:81], v9 offset:8192
  ds_read_b64_tr_b16 v[82:83], v9 offset:8704
  ds_read_b128 v[84:87], v10 offset:128
  ds_read_b128 v[88:91], v10 offset:144
  ds_read_b128 v[92:95], v11 offset:64
  ds_read_b64_tr_b16 v[96:97], v9 offset:16384
  ds_read_b64_tr_b16 v[98:99], v9 offset:16896
  ds_read_b128 v[100:103], v10 offset:256
  ds_read_b128 v[104:107], v10 offset:272
  ds_read_b128 v[108:111], v11 offset:128
  s_waitcnt lgkmcnt(14)
  v_lshlrev_b32 v48, 16, v64
  v_and_b32 v49, s63, v64
  v_lshlrev_b32 v50, 16, v65
  v_and_b32 v51, s63, v65
  s_waitcnt lgkmcnt(13)
  v_lshlrev_b32 v52, 16, v66
  v_and_b32 v53, s63, v66
  v_lshlrev_b32 v54, 16, v67
  v_and_b32 v55, s63, v67
  s_waitcnt lgkmcnt(12)
  v_pk_mul_f32 v[48:49], v[48:49], v[68:69]
  v_pk_mul_f32 v[50:51], v[50:51], v[70:71]
  s_waitcnt lgkmcnt(11)
  v_pk_mul_f32 v[52:53], v[52:53], v[72:73]
  v_pk_mul_f32 v[54:55], v[54:55], v[74:75]
  v_cvt_pk_bf16_f32 v68, v48, v49
  v_cvt_pk_bf16_f32 v69, v50, v51
  v_cvt_pk_bf16_f32 v70, v52, v53
  v_cvt_pk_bf16_f32 v71, v54, v55
  buffer_store_dwordx4 v[68:71], v5, s[36:39], s51 offen sc1
  s_add_u32 s51, s51, 4096
  ds_read_b64_tr_b16 v[112:113], v9 offset:24576
  ds_read_b64_tr_b16 v[114:115], v9 offset:25088
  ds_read_b128 v[116:119], v10 offset:384
  ds_read_b128 v[120:123], v10 offset:400
  ds_read_b128 v[124:127], v11 offset:192
  s_waitcnt lgkmcnt(14)
  v_lshlrev_b32 v48, 16, v80
  v_and_b32 v49, s63, v80
  v_lshlrev_b32 v50, 16, v81
  v_and_b32 v51, s63, v81
  s_waitcnt lgkmcnt(13)
  v_lshlrev_b32 v52, 16, v82
  v_and_b32 v53, s63, v82
  v_lshlrev_b32 v54, 16, v83
  v_and_b32 v55, s63, v83
  s_waitcnt lgkmcnt(12)
  v_pk_mul_f32 v[48:49], v[48:49], v[84:85]
  v_pk_mul_f32 v[50:51], v[50:51], v[86:87]
  s_waitcnt lgkmcnt(11)
  v_pk_mul_f32 v[52:53], v[52:53], v[88:89]
  v_pk_mul_f32 v[54:55], v[54:55], v[90:91]
  v_cvt_pk_bf16_f32 v84, v48, v49
  v_cvt_pk_bf16_f32 v85, v50, v51
  v_cvt_pk_bf16_f32 v86, v52, v53
  v_cvt_pk_bf16_f32 v87, v54, v55
  buffer_store_dwordx4 v[84:87], v5, s[36:39], s51 offen sc1
  s_add_u32 s51, s51, 4096
  ds_read_b64_tr_b16 v[128:129], v9 offset:32768
  ds_read_b64_tr_b16 v[130:131], v9 offset:33280
  ds_read_b128 v[132:135], v10 offset:512
  ds_read_b128 v[136:139], v10 offset:528
  ds_read_b128 v[140:143], v11 offset:256
  s_waitcnt lgkmcnt(14)
  v_lshlrev_b32 v48, 16, v96
  v_and_b32 v49, s63, v96
  v_lshlrev_b32 v50, 16, v97
  v_and_b32 v51, s63, v97
  s_waitcnt lgkmcnt(13)
  v_lshlrev_b32 v52, 16, v98
  v_and_b32 v53, s63, v98
  v_lshlrev_b32 v54, 16, v99
  v_and_b32 v55, s63, v99
  s_waitcnt lgkmcnt(12)
  v_pk_mul_f32 v[48:49], v[48:49], v[100:101]
  v_pk_mul_f32 v[50:51], v[50:51], v[102:103]
  s_waitcnt lgkmcnt(11)
  v_pk_mul_f32 v[52:53], v[52:53], v[104:105]
  v_pk_mul_f32 v[54:55], v[54:55], v[106:107]
  v_cvt_pk_bf16_f32 v100, v48, v49
  v_cvt_pk_bf16_f32 v101, v50, v51
  v_cvt_pk_bf16_f32 v102, v52, v53
  v_cvt_pk_bf16_f32 v103, v54, v55
  buffer_store_dwordx4 v[100:103], v5, s[36:39], s51 offen sc1
  s_add_u32 s51, s51, 4096
  ds_read_b64_tr_b16 v[144:145], v8 offset:0
  ds_read_b64_tr_b16 v[146:147], v8 offset:512
  ds_read_b128 v[148:151], v10 offset:640
  ds_read_b128 v[152:155], v10 offset:656
  ds_read_b128 v[156:159], v11 offset:320
  s_waitcnt lgkmcnt(14)
  v_lshlrev_b32 v48, 16, v112
  v_and_b32 v49, s63, v112
  v_lshlrev_b32 v50, 16, v113
  v_and_b32 v51, s63, v113
  s_waitcnt lgkmcnt(13)
  v_lshlrev_b32 v52, 16, v114
  v_and_b32 v53, s63, v114
  v_lshlrev_b32 v54, 16, v115
  v_and_b32 v55, s63, v115
  s_waitcnt lgkmcnt(12)
  v_pk_mul_f32 v[48:49], v[48:49], v[116:117]
  v_pk_mul_f32 v[50:51], v[50:51], v[118:119]
  s_waitcnt lgkmcnt(11)
  v_pk_mul_f32 v[52:53], v[52:53], v[120:121]
  v_pk_mul_f32 v[54:55], v[54:55], v[122:123]
  v_cvt_pk_bf16_f32 v116, v48, v49
  v_cvt_pk_bf16_f32 v117, v50, v51
  v_cvt_pk_bf16_f32 v118, v52, v53
  v_cvt_pk_bf16_f32 v119, v54, v55
  buffer_store_dwordx4 v[116:119], v5, s[36:39], s51 offen sc1
  s_add_u32 s51, s51, 4096
  ds_read_b64_tr_b16 v[160:161], v8 offset:8192
  ds_read_b64_tr_b16 v[162:163], v8 offset:8704
  ds_read_b128 v[164:167], v10 offset:768
  ds_read_b128 v[168:171], v10 offset:784
  ds_read_b128 v[172:175], v11 offset:384
  s_waitcnt lgkmcnt(14)
  v_lshlrev_b32 v48, 16, v128
  v_and_b32 v49, s63, v128
  v_lshlrev_b32 v50, 16, v129
  v_and_b32 v51, s63, v129
  s_waitcnt lgkmcnt(13)
  v_lshlrev_b32 v52, 16, v130
  v_and_b32 v53, s63, v130
  v_lshlrev_b32 v54, 16, v131
  v_and_b32 v55, s63, v131
  s_waitcnt lgkmcnt(12)
  v_pk_mul_f32 v[48:49], v[48:49], v[132:133]
  v_pk_mul_f32 v[50:51], v[50:51], v[134:135]
  s_waitcnt lgkmcnt(11)
  v_pk_mul_f32 v[52:53], v[52:53], v[136:137]
  v_pk_mul_f32 v[54:55], v[54:55], v[138:139]
  v_cvt_pk_bf16_f32 v132, v48, v49
  v_cvt_pk_bf16_f32 v133, v50, v51
  v_cvt_pk_bf16_f32 v134, v52, v53
  v_cvt_pk_bf16_f32 v135, v54, v55
  buffer_store_dwordx4 v[132:135], v5, s[36:39], s51 offen sc1
  s_add_u32 s51, s51, 4096
  ds_read_b64_tr_b16 v[176:177], v8 offset:16384
  ds_read_b64_tr_b16 v[178:179], v8 offset:16896
  ds_read_b128 v[180:183], v10 offset:896
  ds_read_b128 v[184:187], v10 offset:912
  ds_read_b128 v[188:191], v11 offset:448
  s_waitcnt lgkmcnt(14)
  v_lshlrev_b32 v48, 16, v144
  v_and_b32 v49, s63, v144
  v_lshlrev_b32 v50, 16, v145
  v_and_b32 v51, s63, v145
  s_waitcnt lgkmcnt(13)
  v_lshlrev_b32 v52, 16, v146
  v_and_b32 v53, s63, v146
  v_lshlrev_b32 v54, 16, v147
  v_and_b32 v55, s63, v147
  s_waitcnt lgkmcnt(12)
  v_pk_mul_f32 v[48:49], v[48:49], v[148:149]
  v_pk_mul_f32 v[50:51], v[50:51], v[150:151]
  s_waitcnt lgkmcnt(11)
  v_pk_mul_f32 v[52:53], v[52:53], v[152:153]
  v_pk_mul_f32 v[54:55], v[54:55], v[154:155]
  v_cvt_pk_bf16_f32 v148, v48, v49
  v_cvt_pk_bf16_f32 v149, v50, v51
  v_cvt_pk_bf16_f32 v150, v52, v53
  v_cvt_pk_bf16_f32 v151, v54, v55
  buffer_store_dwordx4 v[148:151], v5, s[36:39], s51 offen sc1
  s_add_u32 s51, s51, 4096
  ds_read_b64_tr_b16 v[192:193], v8 offset:24576
  ds_read_b64_tr_b16 v[194:195], v8 offset:25088
  ds_read_b128 v[196:199], v10 offset:1024
  ds_read_b128 v[200:203], v10 offset:1040
  ds_read_b128 v[204:207], v11 offset:512
  s_waitcnt lgkmcnt(14)
  v_lshlrev_b32 v48, 16, v160
  v_and_b32 v49, s63, v160
  v_lshlrev_b32 v50, 16, v161
  v_and_b32 v51, s63, v161
  s_waitcnt lgkmcnt(13)
  v_lshlrev_b32 v52, 16, v162
  v_and_b32 v53, s63, v162
  v_lshlrev_b32 v54, 16, v163
  v_and_b32 v55, s63, v163
  s_waitcnt lgkmcnt(12)
  v_pk_mul_f32 v[48:49], v[48:49], v[164:165]
  v_pk_mul_f32 v[50:51], v[50:51], v[166:167]
  s_waitcnt lgkmcnt(11)
  v_pk_mul_f32 v[52:53], v[52:53], v[168:169]
  v_pk_mul_f32 v[54:55], v[54:55], v[170:171]
  v_cvt_pk_bf16_f32 v164, v48, v49
  v_cvt_pk_bf16_f32 v165, v50, v51
  v_cvt_pk_bf16_f32 v166, v52, v53
  v_cvt_pk_bf16_f32 v167, v54, v55
  buffer_store_dwordx4 v[164:167], v5, s[36:39], s51 offen sc1
  s_add_u32 s51, s51, 4096
  ds_read_b64_tr_b16 v[208:209], v8 offset:32768
  ds_read_b64_tr_b16 v[210:211], v8 offset:33280
  ds_read_b128 v[212:215], v10 offset:1152
  ds_read_b128 v[216:219], v10 offset:1168
  ds_read_b128 v[220:223], v11 offset:576
  s_waitcnt lgkmcnt(14)
  v_lshlrev_b32 v48, 16, v176
  v_and_b32 v49, s63, v176
  v_lshlrev_b32 v50, 16, v177
  v_and_b32 v51, s63, v177
  s_waitcnt lgkmcnt(13)
  v_lshlrev_b32 v52, 16, v178
  v_and_b32 v53, s63, v178
  v_lshlrev_b32 v54, 16, v179
  v_and_b32 v55, s63, v179
  s_waitcnt lgkmcnt(12)
  v_pk_mul_f32 v[48:49], v[48:49], v[180:181]
  v_pk_mul_f32 v[50:51], v[50:51], v[182:183]
  s_waitcnt lgkmcnt(11)
  v_pk_mul_f32 v[52:53], v[52:53], v[184:185]
  v_pk_mul_f32 v[54:55], v[54:55], v[186:187]
  v_cvt_pk_bf16_f32 v180, v48, v49
  v_cvt_pk_bf16_f32 v181, v50, v51
  v_cvt_pk_bf16_f32 v182, v52, v53
  v_cvt_pk_bf16_f32 v183, v54, v55
  buffer_store_dwordx4 v[180:183], v5, s[36:39], s51 offen sc1
  s_add_u32 s51, s51, 4096
  s_waitcnt lgkmcnt(9)
  v_lshlrev_b32 v48, 16, v192
  v_and_b32 v49, s63, v192
  v_lshlrev_b32 v50, 16, v193
  v_and_b32 v51, s63, v193
  s_waitcnt lgkmcnt(8)
  v_lshlrev_b32 v52, 16, v194
  v_and_b32 v53, s63, v194
  v_lshlrev_b32 v54, 16, v195
  v_and_b32 v55, s63, v195
  s_waitcnt lgkmcnt(7)
  v_pk_mul_f32 v[48:49], v[48:49], v[196:197]
  v_pk_mul_f32 v[50:51], v[50:51], v[198:199]
  s_waitcnt lgkmcnt(6)
  v_pk_mul_f32 v[52:53], v[52:53], v[200:201]
  v_pk_mul_f32 v[54:55], v[54:55], v[202:203]
  v_cvt_pk_bf16_f32 v196, v48, v49
  v_cvt_pk_bf16_f32 v197, v50, v51
  v_cvt_pk_bf16_f32 v198, v52, v53
  v_cvt_pk_bf16_f32 v199, v54, v55
  buffer_store_dwordx4 v[196:199], v5, s[36:39], s51 offen sc1
  s_add_u32 s51, s51, 4096
  s_waitcnt lgkmcnt(4)
  v_lshlrev_b32 v48, 16, v208
  v_and_b32 v49, s63, v208
  v_lshlrev_b32 v50, 16, v209
  v_and_b32 v51, s63, v209
  s_waitcnt lgkmcnt(3)
  v_lshlrev_b32 v52, 16, v210
  v_and_b32 v53, s63, v210
  v_lshlrev_b32 v54, 16, v211
  v_and_b32 v55, s63, v211
  s_waitcnt lgkmcnt(2)
  v_pk_mul_f32 v[48:49], v[48:49], v[212:213]
  v_pk_mul_f32 v[50:51], v[50:51], v[214:215]
  s_waitcnt lgkmcnt(1)
  v_pk_mul_f32 v[52:53], v[52:53], v[216:217]
  v_pk_mul_f32 v[54:55], v[54:55], v[218:219]
  v_cvt_pk_bf16_f32 v212, v48, v49
  v_cvt_pk_bf16_f32 v213, v50, v51
  v_cvt_pk_bf16_f32 v214, v52, v53
  v_cvt_pk_bf16_f32 v215, v54, v55
  buffer_store_dwordx4 v[212:215], v5, s[36:39], s51 offen sc1
  v_mfma_f32_32x32x16_bf16 v[32:47], v[76:79], v[64:67], 0
  v_mfma_f32_32x32x16_bf16 v[16:31], v[12:15], v[68:71], 0
  v_mfma_f32_32x32x16_bf16 v[32:47], v[92:95], v[80:83], v[32:47]
  v_mfma_f32_32x32x16_bf16 v[16:31], v[12:15], v[84:87], v[16:31]
  v_mfma_f32_32x32x16_bf16 v[32:47], v[108:111], v[96:99], v[32:47]
  v_mfma_f32_32x32x16_bf16 v[16:31], v[12:15], v[100:103], v[16:31]
  v_mfma_f32_32x32x16_bf16 v[32:47], v[124:127], v[112:115], v[32:47]
  v_mfma_f32_32x32x16_bf16 v[16:31], v[12:15], v[116:119], v[16:31]
  v_mfma_f32_32x32x16_bf16 v[32:47], v[140:143], v[128:131], v[32:47]
  v_mfma_f32_32x32x16_bf16 v[16:31], v[12:15], v[132:135], v[16:31]
  v_mfma_f32_32x32x16_bf16 v[32:47], v[156:159], v[144:147], v[32:47]
  v_mfma_f32_32x32x16_bf16 v[16:31], v[12:15], v[148:151], v[16:31]
  v_mfma_f32_32x32x16_bf16 v[32:47], v[172:175], v[160:163], v[32:47]
  v_mfma_f32_32x32x16_bf16 v[16:31], v[12:15], v[164:167], v[16:31]
  v_mfma_f32_32x32x16_bf16 v[32:47], v[188:191], v[176:179], v[32:47]
  v_mfma_f32_32x32x16_bf16 v[16:31], v[12:15], v[180:183], v[16:31]
  v_mfma_f32_32x32x16_bf16 v[32:47], v[204:207], v[192:195], v[32:47]
  v_mfma_f32_32x32x16_bf16 v[16:31], v[12:15], v[196:199], v[16:31]
  s_waitcnt lgkmcnt(0)
  v_mfma_f32_32x32x16_bf16 v[32:47], v[220:223], v[208:211], v[32:47]
  v_mfma_f32_32x32x16_bf16 v[16:31], v[12:15], v[212:215], v[16:31]
  s_nop 11
  v_mov_b32 v17, v32
  s_lshl_b32 s49, s3, 9
  s_add_u32 s49, s49, 155648
  v_lshl_add_u32 v6, v0, 3, s49
  ds_write_b64 v6, v[16:17]
  s_waitcnt lgkmcnt(0)
  s_barrier
  s_cmp_ge_u32 s3, 4
  s_cbranch_scc1 SD_nf
  ds_read_b64 v[18:19], v6 offset:2048
  s_add_u32 s51, s50, 80
  s_lshl_b32 s51, s51, 10
  s_lshl_b32 s52, s6, 9
  s_add_u32 s51, s51, s52
  s_add_u32 s51, s51, 9347072
  s_waitcnt lgkmcnt(0)
  v_pk_add_f32 v[16:17], v[16:17], v[18:19]
  v_cvt_pk_bf16_f32 v25, v16, v17
  v_lshlrev_b32 v18, 16, v25
  v_and_b32 v19, s63, v25
  v_sub_f32 v20, v16, v18
  v_sub_f32 v21, v17, v19
  v_cvt_pk_bf16_f32 v24, v18, v20
  v_cvt_pk_bf16_f32 v26, v21, v19
  v_mov_b32 v27, 0
  v_cmp_gt_u32 vcc, 32, v0
  v_add_u32 v28, 1536, v5
  s_nop 0
  v_cndmask_b32 v24, 0, v24, vcc
  v_cndmask_b32 v25, 0, v25, vcc
  v_cndmask_b32 v26, 0, v26, vcc
  v_cndmask_b32 v28, v28, v5, vcc
  buffer_store_dwordx4 v[24:27], v28, s[36:39], s51 offen sc1
SD_nf:
  s_lshl_b32 s4, s57, 2
  s_add_u32 s4, s4, s45
  s_mul_i32 s5, s4, 43
  s_lshr_b32 s5, s5, 8
  s_mul_i32 s52, s5, 208
  s_lshl_b32 s4, s4, 3
  s_add_u32 s4, s4, s52
  s_lshl_b32 s52, s6, 2
  s_add_u32 s4, s4, s52
  s_add_u32 s4, s4, 21766144
  v_lshlrev_b32 v8, 7, v0
  v_mov_b32 v9, 1
  s_waitcnt vmcnt(0)
  s_barrier
  s_cmp_ge_u32 s3, 4
  s_cbranch_scc1 P3_start
  s_mov_b64 exec, 3
  buffer_store_dword v9, v8, s[36:39], s4 offen sc0 sc1
  s_mov_b64 exec, -1
  s_mov_b64 exec, -1
  s_branch P3_start
  s_mov_b64 exec, -1
P1_end:
  s_and_b32 s5, s2, 15
  s_lshl_b32 s4, s5, 7
  s_add_u32 s4, s4, 21770240
  s_lshl_b32 s5, s5, 6
  s_add_u32 s5, s5, 21772288
  v_mov_b32 v240, 1
  v_mov_b32 v241, 0
  v_mov_b32 v242, 1
  v_lshlrev_b32 v243, 10, v0
  s_waitcnt vmcnt(0)
  s_barrier
  s_cmp_eq_u32 s15, 7
  s_cbranch_scc0 P3_start
  s_mov_b64 exec, 1
  buffer_atomic_add v240, v241, s[36:39], s4 offen sc0 sc1
  s_waitcnt vmcnt(0)
  v_readfirstlane_b32 s4, v240
  s_mov_b64 exec, 255
  s_cmp_eq_u32 s4, 12
  s_cbranch_scc0 GA_1
  buffer_store_dword v242, v243, s[36:39], s5 offen sc0 sc1
GA_1:
  s_mov_b64 exec, -1
P3_start:
  s_mov_b32 s100, s26
  s_mov_b32 s101, s27
  s_mov_b32 s3, s15
  v_mov_b32 v3, 0
  s_cmp_ge_u32 s2, 160
  s_cbranch_scc1 K3_wp
  s_and_b32 s4, s2, 7
  s_lshr_b32 s5, s2, 3
  s_mul_i32 s6, s5, 52
  s_lshr_b32 s6, s6, 8
  s_mul_i32 s7, s6, 5
  s_sub_u32 s7, s5, s7
  s_lshl_b32 s6, s6, 3
  s_add_u32 s6, s6, s4
  v_lshlrev_b32 v2, 4, v0
  s_and_b32 s46, s3, 3
  s_lshr_b32 s47, s3, 2
  s_lshl_b32 s51, s7, 2
  s_add_u32 s51, s51, s46
  s_lshl_b32 s52, s51, 7
  s_add_u32 s52, s52, 46080
  s_lshl_b32 s58, s46, 5
  s_add_u32 s58, s58, 106496
  v_mul_u32_u24 v200, 144, v0
  v_add_u32 v200, s58, v200
  s_mul_i32 s59, s47, 3
  s_xor_b32 s59, s59, s46
  v_bfe_u32 v201, v0, 2, 2
  v_xor_b32 v201, s59, v201
  v_lshlrev_b32 v201, 4, v201
  v_lshl_add_u32 v201, v0, 6, v201
  s_lshl_b32 s59, s47, 13
  s_add_u32 s59, s59, 90112
  v_add_u32 v201, s59, v201
  v_lshrrev_b32 v202, 5, v0
  v_and_b32 v203, 31, v0
  v_mul_u32_u24 v202, 40960, v202
  v_lshl_add_u32 v202, v203, 4, v202
  v_lshlrev_b32 v203, 3, v0
  s_mul_i32 s60, s6, 81920
  s_add_u32 s60, s60, 6070272
  s_lshl_b32 s61, s51, 9
  s_lshl_b32 s62, s7, 14
  s_lshl_b32 s63, s3, 9
  s_add_u32 s63, s63, 155648
  v_add_u32 v204, s63, v203
  v_add_u32 v205, 155648, v203
  s_lshl_b32 s63, s6, 9
  s_add_u32 s62, s62, s63
  s_add_u32 s62, s62, 8691712
  s_lshl_b32 s59, s7, 2
  s_add_u32 s59, s59, s63
  s_add_u32 s59, s59, 21749760
  s_mov_b32 s63, 0xffff0000
  v_mov_b32 v206, 0
  v_mov_b32 v207, 0
  v_lshlrev_b32 v198, 7, v0
  v_mov_b32 v199, 1
  s_mul_i32 s44, s6, 84480
  s_lshl_b32 s45, s3, 10
  s_add_u32 s44, s44, s45
  s_add_u32 s44, s44, 3366912
  s_cmp_ge_u32 s3, 4
  s_cbranch_scc1 K3_nomfma
  s_and_b32 s53, s3, 1
  s_lshr_b32 s54, s3, 1
  s_mul_i32 s55, s53, 320
  s_mul_i32 s53, s53, 0xbe800000
  s_lshl_b32 s56, s7, 6
  s_add_u32 s56, s56, 1
  v_and_b32 v152, 31, v0
  v_lshl_add_u32 v152, v152, 1, s56
  v_lshrrev_b32 v153, 5, v0
  v_lshl_add_u32 v153, v153, 4, s54
  v_mov_b32 v154, s55
  v_cmp_eq_u32 vcc, 0, v153
  v_cvt_f32_u32 v152, v152
  s_nop 0
  v_cndmask_b32 v154, v153, v154, vcc
  v_cvt_f32_u32 v153, v153
  v_cvt_f32_u32 v154, v154
  v_mul_f32 v152, 0x3a4ccccd, v152
  v_fma_f32 v153, v153, v152, s53
  v_fma_f32 v154, v154, v152, s53
  v_fmamk_f32 v157, v152, 0x40000000, v153
  v_fmamk_f32 v158, v152, 0x40800000, v153
  v_fmamk_f32 v159, v152, 0x40c00000, v153
  v_fmamk_f32 v160, v152, 0x41000000, v153
  v_fmamk_f32 v161, v152, 0x41200000, v153
  v_fmamk_f32 v162, v152, 0x41400000, v153
  v_fmamk_f32 v163, v152, 0x41600000, v153
  v_cos_f32 v156, v154
  v_cos_f32 v157, v157
  v_cos_f32 v158, v158
  v_cos_f32 v159, v159
  v_cos_f32 v160, v160
  v_cos_f32 v161, v161
  v_cos_f32 v162, v162
  v_cos_f32 v163, v163
  v_cvt_pk_bf16_f32 v16, v156, v157
  v_cvt_pk_bf16_f32 v17, v158, v159
  v_cvt_pk_bf16_f32 v18, v160, v161
  v_cvt_pk_bf16_f32 v19, v162, v163
  v_fmamk_f32 v155, v152, 0x42000000, v153
  v_fmamk_f32 v157, v152, 0x40000000, v155
  v_fmamk_f32 v158, v152, 0x40800000, v155
  v_fmamk_f32 v159, v152, 0x40c00000, v155
  v_fmamk_f32 v160, v152, 0x41000000, v155
  v_fmamk_f32 v161, v152, 0x41200000, v155
  v_fmamk_f32 v162, v152, 0x41400000, v155
  v_fmamk_f32 v163, v152, 0x41600000, v155
  v_cos_f32 v156, v155
  v_cos_f32 v157, v157
  v_cos_f32 v158, v158
  v_cos_f32 v159, v159
  v_cos_f32 v160, v160
  v_cos_f32 v161, v161
  v_cos_f32 v162, v162
  v_cos_f32 v163, v163
  v_cvt_pk_bf16_f32 v20, v156, v157
  v_cvt_pk_bf16_f32 v21, v158, v159
  v_cvt_pk_bf16_f32 v22, v160, v161
  v_cvt_pk_bf16_f32 v23, v162, v163
  v_fmamk_f32 v155, v152, 0x42800000, v153
  v_fmamk_f32 v157, v152, 0x40000000, v155
  v_fmamk_f32 v158, v152, 0x40800000, v155
  v_fmamk_f32 v159, v152, 0x40c00000, v155
  v_fmamk_f32 v160, v152, 0x41000000, v155
  v_fmamk_f32 v161, v152, 0x41200000, v155
  v_fmamk_f32 v162, v152, 0x41400000, v155
  v_fmamk_f32 v163, v152, 0x41600000, v155
  v_cos_f32 v156, v155
  v_cos_f32 v157, v157
  v_cos_f32 v158, v158
  v_cos_f32 v159, v159
  v_cos_f32 v160, v160
  v_cos_f32 v161, v161
  v_cos_f32 v162, v162
  v_cos_f32 v163, v163
  v_cvt_pk_bf16_f32 v24, v156, v157
  v_cvt_pk_bf16_f32 v25, v158, v159
  v_cvt_pk_bf16_f32 v26, v160, v161
  v_cvt_pk_bf16_f32 v27, v162, v163
  v_fmamk_f32 v155, v152, 0x42c00000, v153
  v_fmamk_f32 v157, v152, 0x40000000, v155
  v_fmamk_f32 v158, v152, 0x40800000, v155
  v_fmamk_f32 v159, v152, 0x40c00000, v155
  v_fmamk_f32 v160, v152, 0x41000000, v155
  v_fmamk_f32 v161, v152, 0x41200000, v155
  v_fmamk_f32 v162, v152, 0x41400000, v155
  v_fmamk_f32 v163, v152, 0x41600000, v155
  v_cos_f32 v156, v155
  v_cos_f32 v157, v157
  v_cos_f32 v158, v158
  v_cos_f32 v159, v159
  v_cos_f32 v160, v160
  v_cos_f32 v161, v161
  v_cos_f32 v162, v162
  v_cos_f32 v163, v163
  v_cvt_pk_bf16_f32 v28, v156, v157
  v_cvt_pk_bf16_f32 v29, v158, v159
  v_cvt_pk_bf16_f32 v30, v160, v161
  v_cvt_pk_bf16_f32 v31, v162, v163
  s_waitcnt lgkmcnt(0)
  s_mov_b32 s36, s30
  s_mov_b32 s37, s31
  s_mov_b32 s38, 24416256
  s_mov_b32 s39, 0x20000
  v_and_b32 v6, 31, v0
  v_lshrrev_b32 v7, 5, v0
  s_and_b32 s58, s3, 1
  s_lshl_b32 s58, s58, 2
  s_lshr_b32 s57, s3, 1
  s_mul_i32 s57, s57, 4224
  v_add_u32 v8, s58, v7
  v_bfe_u32 v9, v0, 1, 3
  v_xor_b32 v10, v8, v9
  v_lshlrev_b32 v10, 4, v10
  v_lshl_add_u32 v10, v6, 7, v10
  v_add_u32 v10, s57, v10
  v_xor_b32 v11, 32, v10
  v_add_u32 v12, 4096, v10
  v_cmp_eq_u32 vcc, 0, v6
  s_nop 1
  v_cndmask_b32 v11, v11, v12, vcc
  v_add_u32 v13, 42240, v10
  v_add_u32 v14, 42240, v11
  s_mul_i32 s58, s3, 9216
  s_add_u32 s58, s58, 106496
  v_mul_u32_u24 v12, 144, v6
  v_lshl_add_u32 v12, v7, 4, v12
  v_add_u32 v12, s58, v12
  v_add_u32 v15, 143360, v2
  v_fmamk_f32 v155, v152, 0x43000000, v153
  v_fmamk_f32 v157, v152, 0x40000000, v155
  v_fmamk_f32 v158, v152, 0x40800000, v155
  v_fmamk_f32 v159, v152, 0x40c00000, v155
  v_fmamk_f32 v160, v152, 0x41000000, v155
  v_fmamk_f32 v161, v152, 0x41200000, v155
  v_fmamk_f32 v162, v152, 0x41400000, v155
  v_fmamk_f32 v163, v152, 0x41600000, v155
  v_cos_f32 v156, v155
  v_cos_f32 v157, v157
  v_cos_f32 v158, v158
  v_cos_f32 v159, v159
  v_cos_f32 v160, v160
  v_cos_f32 v161, v161
  v_cos_f32 v162, v162
  v_cos_f32 v163, v163
  v_cvt_pk_bf16_f32 v32, v156, v157
  v_cvt_pk_bf16_f32 v33, v158, v159
  v_cvt_pk_bf16_f32 v34, v160, v161
  v_cvt_pk_bf16_f32 v35, v162, v163
  v_fmamk_f32 v155, v152, 0x43200000, v153
  v_fmamk_f32 v157, v152, 0x40000000, v155
  v_fmamk_f32 v158, v152, 0x40800000, v155
  v_fmamk_f32 v159, v152, 0x40c00000, v155
  v_fmamk_f32 v160, v152, 0x41000000, v155
  v_fmamk_f32 v161, v152, 0x41200000, v155
  v_fmamk_f32 v162, v152, 0x41400000, v155
  v_fmamk_f32 v163, v152, 0x41600000, v155
  v_cos_f32 v156, v155
  v_cos_f32 v157, v157
  v_cos_f32 v158, v158
  v_cos_f32 v159, v159
  v_cos_f32 v160, v160
  v_cos_f32 v161, v161
  v_cos_f32 v162, v162
  v_cos_f32 v163, v163
  v_cvt_pk_bf16_f32 v36, v156, v157
  v_cvt_pk_bf16_f32 v37, v158, v159
  v_cvt_pk_bf16_f32 v38, v160, v161
  v_cvt_pk_bf16_f32 v39, v162, v163
  v_fmamk_f32 v155, v152, 0x43400000, v153
  v_fmamk_f32 v157, v152, 0x40000000, v155
  v_fmamk_f32 v158, v152, 0x40800000, v155
  v_fmamk_f32 v159, v152, 0x40c00000, v155
  v_fmamk_f32 v160, v152, 0x41000000, v155
  v_fmamk_f32 v161, v152, 0x41200000, v155
  v_fmamk_f32 v162, v152, 0x41400000, v155
  v_fmamk_f32 v163, v152, 0x41600000, v155
  v_cos_f32 v156, v155
  v_cos_f32 v157, v157
  v_cos_f32 v158, v158
  v_cos_f32 v159, v159
  v_cos_f32 v160, v160
  v_cos_f32 v161, v161
  v_cos_f32 v162, v162
  v_cos_f32 v163, v163
  v_cvt_pk_bf16_f32 v40, v156, v157
  v_cvt_pk_bf16_f32 v41, v158, v159
  v_cvt_pk_bf16_f32 v42, v160, v161
  v_cvt_pk_bf16_f32 v43, v162, v163
  v_fmamk_f32 v155, v152, 0x43600000, v153
  v_fmamk_f32 v157, v152, 0x40000000, v155
  v_fmamk_f32 v158, v152, 0x40800000, v155
  v_fmamk_f32 v159, v152, 0x40c00000, v155
  v_fmamk_f32 v160, v152, 0x41000000, v155
  v_fmamk_f32 v161, v152, 0x41200000, v155
  v_fmamk_f32 v162, v152, 0x41400000, v155
  v_fmamk_f32 v163, v152, 0x41600000, v155
  v_cos_f32 v156, v155
  v_cos_f32 v157, v157
  v_cos_f32 v158, v158
  v_cos_f32 v159, v159
  v_cos_f32 v160, v160
  v_cos_f32 v161, v161
  v_cos_f32 v162, v162
  v_cos_f32 v163, v163
  v_cvt_pk_bf16_f32 v44, v156, v157
  v_cvt_pk_bf16_f32 v45, v158, v159
  v_cvt_pk_bf16_f32 v46, v160, v161
  v_cvt_pk_bf16_f32 v47, v162, v163
  v_fmamk_f32 v155, v152, 0x43800000, v153
  v_fmamk_f32 v157, v152, 0x40000000, v155
  v_fmamk_f32 v158, v152, 0x40800000, v155
  v_fmamk_f32 v159, v152, 0x40c00000, v155
  v_fmamk_f32 v160, v152, 0x41000000, v155
  v_fmamk_f32 v161, v152, 0x41200000, v155
  v_fmamk_f32 v162, v152, 0x41400000, v155
  v_fmamk_f32 v163, v152, 0x41600000, v155
  v_cos_f32 v156, v155
  v_cos_f32 v157, v157
  v_cos_f32 v158, v158
  v_cos_f32 v159, v159
  v_cos_f32 v160, v160
  v_cos_f32 v161, v161
  v_cos_f32 v162, v162
  v_cos_f32 v163, v163
  v_cvt_pk_bf16_f32 v48, v156, v157
  v_cvt_pk_bf16_f32 v49, v158, v159
  v_cvt_pk_bf16_f32 v50, v160, v161
  v_cvt_pk_bf16_f32 v51, v162, v163
  v_fmamk_f32 v155, v152, 0x43900000, v153
  v_fmamk_f32 v157, v152, 0x40000000, v155
  v_fmamk_f32 v158, v152, 0x40800000, v155
  v_fmamk_f32 v159, v152, 0x40c00000, v155
  v_fmamk_f32 v160, v152, 0x41000000, v155
  v_fmamk_f32 v161, v152, 0x41200000, v155
  v_fmamk_f32 v162, v152, 0x41400000, v155
  v_fmamk_f32 v163, v152, 0x41600000, v155
  v_cos_f32 v156, v155
  v_cos_f32 v157, v157
  v_cos_f32 v158, v158
  v_cos_f32 v159, v159
  v_cos_f32 v160, v160
  v_cos_f32 v161, v161
  v_cos_f32 v162, v162
  v_cos_f32 v163, v163
  v_cvt_pk_bf16_f32 v52, v156, v157
  v_cvt_pk_bf16_f32 v53, v158, v159
  v_cvt_pk_bf16_f32 v54, v160, v161
  v_cvt_pk_bf16_f32 v55, v162, v163
  s_cmp_eq_u32 s15, 3
  s_cbranch_scc0 K3_mw
  s_and_b32 s4, s2, 7
  s_lshl_b32 s4, s4, 10
  s_sub_u32 s5, 20608, s4
  s_add_u32 s4, s4, 21772288
  v_lshlrev_b32 v240, 6, v0
  v_mov_b32 v241, s5
  v_cmp_gt_u32 vcc, 16, v0
  s_nop 1
  v_cndmask_b32 v240, v241, v240, vcc
  s_mov_b32 s14, 0x10000
  s_nop 4
SP_g1a:
  buffer_load_dword v241, v240, s[36:39], s4 offen offset:0 sc0 sc1
  s_sub_u32 s14, s14, 1
  s_waitcnt vmcnt(0)
  v_cmp_ne_u32 vcc, 1, v241
  s_cmp_eq_u32 s14, 0
  s_cbranch_scc1 SG_g1a
  s_nop 3
  s_cbranch_vccnz SP_g1a
SG_g1a:
  s_nop 1
K3_mw:
  s_barrier
  s_mov_b32 m0, s45
  s_nop 0
  buffer_load_dwordx4 v2, s[36:39], s44 offen sc1 lds
  s_add_u32 m0, m0, 8192
  s_add_u32 s44, s44, 8192
  buffer_load_dwordx4 v2, s[36:39], s44 offen sc1 lds
  s_add_u32 m0, m0, 8192
  s_add_u32 s44, s44, 8192
  buffer_load_dwordx4 v2, s[36:39], s44 offen sc1 lds
  s_add_u32 m0, m0, 8192
  s_add_u32 s44, s44, 8192
  buffer_load_dwordx4 v2, s[36:39], s44 offen sc1 lds
  s_add_u32 m0, m0, 8192
  s_add_u32 s44, s44, 8192
  buffer_load_dwordx4 v2, s[36:39], s44 offen sc1 lds
  s_add_u32 m0, m0, 8192
  s_add_u32 s44, s44, 8192
  buffer_load_dwordx4 v2, s[36:39], s44 offen sc1 lds
  s_add_u32 m0, m0, 8192
  s_add_u32 s44, s44, 8192
  buffer_load_dwordx4 v2, s[36:39], s44 offen sc1 lds
  s_add_u32 m0, m0, 8192
  s_add_u32 s44, s44, 8192
  buffer_load_dwordx4 v2, s[36:39], s44 offen sc1 lds
  s_add_u32 m0, m0, 8192
  s_add_u32 s44, s44, 8192
  buffer_load_dwordx4 v2, s[36:39], s44 offen sc1 lds
  s_add_u32 m0, m0, 8192
  s_add_u32 s44, s44, 8192
  buffer_load_dwordx4 v2, s[36:39], s44 offen sc1 lds
  s_add_u32 m0, m0, 8192
  s_add_u32 s44, s44, 8192
  s_cmp_ge_u32 s3, 3
  s_cselect_b32 s44, 0x7f000000, s44
  buffer_load_dwordx4 v2, s[36:39], s44 offen sc1 lds
  s_add_u32 m0, m0, 8192
  s_add_u32 s44, s44, 8192
  s_add_u32 s4, s30, s52
  s_addc_u32 s5, s31, 0
  s_load_dwordx16 s[64:79], s[4:5], 0
  s_load_dwordx16 s[80:95], s[4:5], 64
  ds_read_b128 v[56:59], v15 offset:0
  ds_read_b128 v[60:63], v15 offset:1024
  ds_read_b128 v[64:67], v15 offset:2048
  ds_read_b128 v[68:71], v15 offset:3072
  ds_read_b128 v[72:75], v15 offset:4096
  ds_read_b128 v[76:79], v15 offset:5120
  ds_read_b128 v[80:83], v15 offset:6144
  ds_read_b128 v[84:87], v15 offset:7168
  ds_read_b128 v[224:227], v201
  ds_read_b128 v[228:231], v201 offset:4096
  s_waitcnt lgkmcnt(0)
  v_lshlrev_b32 v208, 16, v224
  v_and_b32 v209, s63, v224
  v_lshlrev_b32 v210, 16, v225
  v_and_b32 v211, s63, v225
  v_lshlrev_b32 v212, 16, v226
  v_and_b32 v213, s63, v226
  v_lshlrev_b32 v214, 16, v227
  v_and_b32 v215, s63, v227
  v_lshlrev_b32 v216, 16, v228
  v_and_b32 v217, s63, v228
  v_lshlrev_b32 v218, 16, v229
  v_and_b32 v219, s63, v229
  v_lshlrev_b32 v220, 16, v230
  v_and_b32 v221, s63, v230
  v_lshlrev_b32 v222, 16, v231
  v_and_b32 v223, s63, v231
  s_add_u32 s60, s60, s61
  s_add_u32 s61, s60, 20480
  s_mov_b32 s44, 0x3f803f80
  s_waitcnt lgkmcnt(0)
  s_waitcnt vmcnt(7)
  s_barrier
  ds_read_b128 v[120:123], v10 offset:0
  ds_read_b128 v[124:127], v11 offset:0
  ds_read_b128 v[128:131], v10 offset:8448
  ds_read_b128 v[132:135], v11 offset:8448
  ds_read_b128 v[136:139], v10 offset:16896
  ds_read_b128 v[140:143], v11 offset:16896
  s_waitcnt lgkmcnt(5)
  v_mfma_f32_32x32x16_bf16 v[88:103], v[120:123], v[16:19], 0
  s_waitcnt lgkmcnt(4)
  v_mfma_f32_32x32x16_bf16 v[104:119], v[124:127], v[16:19], 0
  s_waitcnt lgkmcnt(3)
  v_mfma_f32_32x32x16_bf16 v[88:103], v[128:131], v[20:23], v[88:103]
  s_waitcnt lgkmcnt(2)
  v_mfma_f32_32x32x16_bf16 v[104:119], v[132:135], v[20:23], v[104:119]
  s_waitcnt lgkmcnt(1)
  v_mfma_f32_32x32x16_bf16 v[88:103], v[136:139], v[24:27], v[88:103]
  s_waitcnt lgkmcnt(0)
  v_mfma_f32_32x32x16_bf16 v[104:119], v[140:143], v[24:27], v[104:119]
  s_waitcnt vmcnt(4)
  s_barrier
  ds_read_b128 v[120:123], v10 offset:25344
  ds_read_b128 v[124:127], v11 offset:25344
  ds_read_b128 v[128:131], v10 offset:33792
  ds_read_b128 v[132:135], v11 offset:33792
  ds_read_b128 v[136:139], v13 offset:0
  ds_read_b128 v[140:143], v14 offset:0
  s_waitcnt lgkmcnt(5)
  v_mfma_f32_32x32x16_bf16 v[88:103], v[120:123], v[28:31], v[88:103]
  s_waitcnt lgkmcnt(4)
  v_mfma_f32_32x32x16_bf16 v[104:119], v[124:127], v[28:31], v[104:119]
  s_waitcnt lgkmcnt(3)
  v_mfma_f32_32x32x16_bf16 v[88:103], v[128:131], v[32:35], v[88:103]
  s_waitcnt lgkmcnt(2)
  v_mfma_f32_32x32x16_bf16 v[104:119], v[132:135], v[32:35], v[104:119]
  s_waitcnt lgkmcnt(1)
  v_mfma_f32_32x32x16_bf16 v[88:103], v[136:139], v[36:39], v[88:103]
  s_waitcnt lgkmcnt(0)
  v_mfma_f32_32x32x16_bf16 v[104:119], v[140:143], v[36:39], v[104:119]
  s_waitcnt vmcnt(2)
  s_barrier
  ds_read_b128 v[120:123], v13 offset:8448
  ds_read_b128 v[124:127], v14 offset:8448
  ds_read_b128 v[128:131], v13 offset:16896
  ds_read_b128 v[132:135], v14 offset:16896
  s_waitcnt lgkmcnt(3)
  v_mfma_f32_32x32x16_bf16 v[88:103], v[120:123], v[40:43], v[88:103]
  s_waitcnt lgkmcnt(2)
  v_mfma_f32_32x32x16_bf16 v[104:119], v[124:127], v[40:43], v[104:119]
  s_waitcnt lgkmcnt(1)
  v_mfma_f32_32x32x16_bf16 v[88:103], v[128:131], v[44:47], v[88:103]
  s_waitcnt lgkmcnt(0)
  v_mfma_f32_32x32x16_bf16 v[104:119], v[132:135], v[44:47], v[104:119]
  s_waitcnt vmcnt(0)
  s_barrier
  ds_read_b128 v[120:123], v13 offset:25344
  ds_read_b128 v[124:127], v13 offset:33792
  ds_read_b128 v[128:131], v14 offset:25344
  ds_read_b128 v[132:135], v14 offset:33792
  s_waitcnt lgkmcnt(3)
  v_mfma_f32_32x32x16_bf16 v[88:103], v[120:123], v[48:51], v[88:103]
  s_waitcnt lgkmcnt(2)
  v_mfma_f32_32x32x16_bf16 v[88:103], v[124:127], v[52:55], v[88:103]
  s_waitcnt lgkmcnt(1)
  v_mfma_f32_32x32x16_bf16 v[104:119], v[128:131], v[48:51], v[104:119]
  s_waitcnt lgkmcnt(0)
  v_mfma_f32_32x32x16_bf16 v[104:119], v[132:135], v[52:55], v[104:119]
  s_nop 7
  v_cvt_pk_bf16_f32 v152, v88, v89
  v_cvt_pk_bf16_f32 v153, v90, v91
  v_cvt_pk_bf16_f32 v154, v92, v93
  v_cvt_pk_bf16_f32 v155, v94, v95
  s_nop 1
  v_mfma_f32_32x32x16_bf16 v[16:31], v[152:155], v[56:59], 0
  v_cvt_pk_bf16_f32 v156, v96, v97
  v_cvt_pk_bf16_f32 v157, v98, v99
  v_cvt_pk_bf16_f32 v158, v100, v101
  v_cvt_pk_bf16_f32 v159, v102, v103
  s_nop 1
  v_mfma_f32_32x32x16_bf16 v[16:31], v[156:159], v[60:63], v[16:31]
  v_cvt_pk_bf16_f32 v160, v104, v105
  v_cvt_pk_bf16_f32 v161, v106, v107
  v_cvt_pk_bf16_f32 v162, v108, v109
  v_cvt_pk_bf16_f32 v163, v110, v111
  s_nop 1
  v_mfma_f32_32x32x16_bf16 v[16:31], v[160:163], v[64:67], v[16:31]
  v_cvt_pk_bf16_f32 v164, v112, v113
  v_cvt_pk_bf16_f32 v165, v114, v115
  v_cvt_pk_bf16_f32 v166, v116, v117
  v_cvt_pk_bf16_f32 v167, v118, v119
  s_nop 1
  v_mfma_f32_32x32x16_bf16 v[16:31], v[164:167], v[68:71], v[16:31]
  v_mfma_f32_32x32x16_bf16 v[32:47], v[152:155], v[72:75], 0
  v_mfma_f32_32x32x16_bf16 v[32:47], v[156:159], v[76:79], v[32:47]
  v_mfma_f32_32x32x16_bf16 v[32:47], v[160:163], v[80:83], v[32:47]
  v_mfma_f32_32x32x16_bf16 v[32:47], v[164:167], v[84:87], v[32:47]
  s_nop 7
  ds_write_b128 v12, v[16:19] offset:0
  ds_write_b128 v12, v[20:23] offset:32
  ds_write_b128 v12, v[24:27] offset:64
  ds_write_b128 v12, v[28:31] offset:96
  ds_write_b128 v12, v[32:35] offset:4608
  ds_write_b128 v12, v[36:39] offset:4640
  ds_write_b128 v12, v[40:43] offset:4672
  ds_write_b128 v12, v[44:47] offset:4704
  s_waitcnt lgkmcnt(0)
  s_barrier
  ds_read_b128 v[16:19], v200 offset:0
  ds_read_b128 v[24:27], v200 offset:9216
  ds_read_b128 v[32:35], v200 offset:18432
  ds_read_b128 v[40:43], v200 offset:27648
  ds_read_b128 v[20:23], v200 offset:16
  ds_read_b128 v[28:31], v200 offset:9232
  ds_read_b128 v[36:39], v200 offset:18448
  ds_read_b128 v[44:47], v200 offset:27664
  s_waitcnt lgkmcnt(6)
  v_pk_add_f32 v[16:17], v[16:17], v[24:25]
  s_waitcnt lgkmcnt(4)
  v_pk_add_f32 v[32:33], v[32:33], v[40:41]
  v_pk_add_f32 v[24:25], v[16:17], v[32:33]
  v_pk_add_f32 v[40:41], v[16:17], v[32:33] neg_lo:[0,1] neg_hi:[0,1]
  v_fmac_f32 v208, s64, v24
  v_fmac_f32 v209, s68, v25
  v_fmac_f32 v216, s65, v40
  v_fmac_f32 v217, s69, v41
  v_pk_add_f32 v[18:19], v[18:19], v[26:27]
  v_pk_add_f32 v[34:35], v[34:35], v[42:43]
  v_pk_add_f32 v[26:27], v[18:19], v[34:35]
  v_pk_add_f32 v[42:43], v[18:19], v[34:35] neg_lo:[0,1] neg_hi:[0,1]
  v_fmac_f32 v210, s72, v26
  v_fmac_f32 v211, s76, v27
  v_fmac_f32 v218, s73, v42
  v_fmac_f32 v219, s77, v43
  s_waitcnt lgkmcnt(2)
  v_pk_add_f32 v[20:21], v[20:21], v[28:29]
  s_waitcnt lgkmcnt(0)
  v_pk_add_f32 v[36:37], v[36:37], v[44:45]
  v_pk_add_f32 v[28:29], v[20:21], v[36:37]
  v_pk_add_f32 v[44:45], v[20:21], v[36:37] neg_lo:[0,1] neg_hi:[0,1]
  v_fmac_f32 v212, s80, v28
  v_fmac_f32 v213, s84, v29
  v_fmac_f32 v220, s81, v44
  v_fmac_f32 v221, s85, v45
  v_pk_add_f32 v[22:23], v[22:23], v[30:31]
  v_pk_add_f32 v[38:39], v[38:39], v[46:47]
  v_pk_add_f32 v[30:31], v[22:23], v[38:39]
  v_pk_add_f32 v[46:47], v[22:23], v[38:39] neg_lo:[0,1] neg_hi:[0,1]
  v_fmac_f32 v214, s88, v30
  v_fmac_f32 v215, s92, v31
  v_fmac_f32 v222, s89, v46
  v_fmac_f32 v223, s93, v47
  v_cvt_pk_bf16_f32 v224, v208, v209
  v_cvt_pk_bf16_f32 v225, v210, v211
  v_cvt_pk_bf16_f32 v226, v212, v213
  v_cvt_pk_bf16_f32 v227, v214, v215
  buffer_store_dwordx4 v[224:227], v202, s[36:39], s60 offen sc1
  v_cvt_pk_bf16_f32 v228, v216, v217
  v_cvt_pk_bf16_f32 v229, v218, v219
  v_cvt_pk_bf16_f32 v230, v220, v221
  v_cvt_pk_bf16_f32 v231, v222, v223
  buffer_store_dwordx4 v[228:231], v202, s[36:39], s61 offen sc1
  v_dot2c_f32_bf16 v206, s44, v224
  v_dot2c_f32_bf16 v207, v224, v224
  v_dot2c_f32_bf16 v206, s44, v225
  v_dot2c_f32_bf16 v207, v225, v225
  v_dot2c_f32_bf16 v206, s44, v226
  v_dot2c_f32_bf16 v207, v226, v226
  v_dot2c_f32_bf16 v206, s44, v227
  v_dot2c_f32_bf16 v207, v227, v227
  v_dot2c_f32_bf16 v206, s44, v228
  v_dot2c_f32_bf16 v207, v228, v228
  v_dot2c_f32_bf16 v206, s44, v229
  v_dot2c_f32_bf16 v207, v229, v229
  v_dot2c_f32_bf16 v206, s44, v230
  v_dot2c_f32_bf16 v207, v230, v230
  v_dot2c_f32_bf16 v206, s44, v231
  v_dot2c_f32_bf16 v207, v231, v231
  s_nop 2
  ds_write_b64 v204, v[206:207]
  s_waitcnt vmcnt(0) lgkmcnt(0)
  s_barrier
  s_cmp_eq_u32 s3, 0
  s_cbranch_scc0 K3_n0
  s_mov_b64 exec, 15
  buffer_store_dword v199, v198, s[36:39], s59 offen sc0 sc1
  s_mov_b64 exec, -1
  s_mov_b64 exec, -1
K3_n0:
  s_branch K45_entry
K3_nomfma:
  s_lshr_b32 s48, s46, 1
  s_lshl_b32 s48, s48, 5
  s_bitcmp1_b32 s46, 0
  s_cselect_b32 s49, 0x3e800000, 0
  s_cselect_b32 s50, 0x42000000, 0
  v_and_b32 v4, 31, v0
  v_add_u32 v4, s48, v4
  v_lshrrev_b32 v5, 5, v0
  v_lshlrev_b32 v5, 2, v5
  v_cmp_eq_u32 vcc, 0, v5
  v_cvt_f32_u32 v4, v4
  v_cvt_f32_u32 v5, v5
  v_mul_f32 v4, 0x3c800000, v4
  v_fma_f32 v5, v5, v4, s49
  v_mul_f32 v6, s50, v4
  v_cndmask_b32 v6, v5, v6, vcc
  v_fmamk_f32 v7, v4, 0x41800000, v5
  s_lshl_b32 s48, s46, 11
  s_add_u32 s48, s48, 143360
  v_add_u32 v8, s48, v2
  v_fmamk_f32 v17, v4, 0x3f800000, v5
  v_fmamk_f32 v18, v4, 0x40000000, v5
  v_fmamk_f32 v19, v4, 0x40400000, v5
  v_fmamk_f32 v20, v4, 0x41000000, v5
  v_fmamk_f32 v21, v4, 0x41100000, v5
  v_fmamk_f32 v22, v4, 0x41200000, v5
  v_fmamk_f32 v23, v4, 0x41300000, v5
  v_cos_f32 v16, v6
  v_cos_f32 v17, v17
  v_cos_f32 v18, v18
  v_cos_f32 v19, v19
  v_cos_f32 v20, v20
  v_cos_f32 v21, v21
  v_cos_f32 v22, v22
  v_cos_f32 v23, v23
  v_cvt_pk_bf16_f32 v24, v16, v17
  v_cvt_pk_bf16_f32 v25, v18, v19
  v_cvt_pk_bf16_f32 v26, v20, v21
  v_cvt_pk_bf16_f32 v27, v22, v23
  v_fmamk_f32 v17, v4, 0x3f800000, v7
  v_fmamk_f32 v18, v4, 0x40000000, v7
  v_fmamk_f32 v19, v4, 0x40400000, v7
  v_fmamk_f32 v20, v4, 0x41000000, v7
  v_fmamk_f32 v21, v4, 0x41100000, v7
  v_fmamk_f32 v22, v4, 0x41200000, v7
  v_fmamk_f32 v23, v4, 0x41300000, v7
  v_cos_f32 v16, v7
  v_cos_f32 v17, v17
  v_cos_f32 v18, v18
  v_cos_f32 v19, v19
  v_cos_f32 v20, v20
  v_cos_f32 v21, v21
  v_cos_f32 v22, v22
  v_cos_f32 v23, v23
  v_cvt_pk_bf16_f32 v28, v16, v17
  v_cvt_pk_bf16_f32 v29, v18, v19
  v_cvt_pk_bf16_f32 v30, v20, v21
  v_cvt_pk_bf16_f32 v31, v22, v23
  s_waitcnt lgkmcnt(0)
  ds_write_b128 v8, v[24:27]
  ds_write_b128 v8, v[28:31] offset:1024
  s_mov_b32 s36, s30
  s_mov_b32 s37, s31
  s_mov_b32 s38, 24416256
  s_mov_b32 s39, 0x20000
  s_mov_b32 s32, s8
  s_mov_b32 s33, s9
  s_mov_b32 s34, 2621440
  s_mov_b32 s35, 0x20000
  v_lshrrev_b32 v3, 2, v0
  v_and_b32 v4, 3, v0
  v_lshrrev_b32 v5, 4, v0
  v_xor_b32 v4, v4, v5
  v_mul_u32_u24 v3, 40960, v3
  v_lshl_add_u32 v3, v4, 4, v3
  s_lshl_b32 s48, s7, 6
  s_sub_u32 s49, 576, s48
  s_cmp_ge_u32 s46, 2
  s_cselect_b32 s48, s49, s48
  s_add_u32 s49, s46, 1
  s_bitcmp1_b32 s49, 1
  s_cselect_b32 s49, 640, 0
  s_add_u32 s48, s48, s49
  s_mul_i32 s49, s6, 1280
  s_add_u32 s48, s48, s49
  s_lshl_b32 s50, s46, 12
  s_add_u32 m0, s50, 90112
  s_nop 0
  buffer_load_dwordx4 v3, s[32:35], s48 offen lds
  s_add_u32 m0, m0, 1024
  s_add_u32 s48, s48, 655360
  buffer_load_dwordx4 v3, s[32:35], s48 offen lds
  s_add_u32 m0, m0, 1024
  s_add_u32 s48, s48, 655360
  buffer_load_dwordx4 v3, s[32:35], s48 offen lds
  s_add_u32 m0, m0, 1024
  s_add_u32 s48, s48, 655360
  buffer_load_dwordx4 v3, s[32:35], s48 offen lds
  s_add_u32 m0, m0, 1024
  s_add_u32 s48, s48, 655360
  s_and_b32 s53, s2, 7
  s_lshl_b32 s53, s53, 7
  s_add_u32 s53, s53, 21793280
  s_mov_b32 s14, 0x10000
  s_nop 4
SP_wk:
  buffer_load_dword v5, v206, s[36:39], s53 offen offset:0 sc0 sc1
  s_sub_u32 s14, s14, 1
  s_waitcnt vmcnt(0)
  v_cmp_ne_u32 vcc, 1, v5
  s_cmp_eq_u32 s14, 0
  s_cbranch_scc1 SG_wk
  s_nop 3
  s_cbranch_vccnz SP_wk
SG_wk:
  s_nop 1
  s_waitcnt vmcnt(0) lgkmcnt(0)
  s_barrier
  s_mov_b32 m0, s45
  s_nop 0
  buffer_load_dwordx4 v2, s[36:39], s44 offen sc1 lds
  s_add_u32 m0, m0, 8192
  s_add_u32 s44, s44, 8192
  buffer_load_dwordx4 v2, s[36:39], s44 offen sc1 lds
  s_add_u32 m0, m0, 8192
  s_add_u32 s44, s44, 8192
  buffer_load_dwordx4 v2, s[36:39], s44 offen sc1 lds
  s_add_u32 m0, m0, 8192
  s_add_u32 s44, s44, 8192
  buffer_load_dwordx4 v2, s[36:39], s44 offen sc1 lds
  s_add_u32 m0, m0, 8192
  s_add_u32 s44, s44, 8192
  buffer_load_dwordx4 v2, s[36:39], s44 offen sc1 lds
  s_add_u32 m0, m0, 8192
  s_add_u32 s44, s44, 8192
  buffer_load_dwordx4 v2, s[36:39], s44 offen sc1 lds
  s_add_u32 m0, m0, 8192
  s_add_u32 s44, s44, 8192
  buffer_load_dwordx4 v2, s[36:39], s44 offen sc1 lds
  s_add_u32 m0, m0, 8192
  s_add_u32 s44, s44, 8192
  buffer_load_dwordx4 v2, s[36:39], s44 offen sc1 lds
  s_add_u32 m0, m0, 8192
  s_add_u32 s44, s44, 8192
  buffer_load_dwordx4 v2, s[36:39], s44 offen sc1 lds
  s_add_u32 m0, m0, 8192
  s_add_u32 s44, s44, 8192
  buffer_load_dwordx4 v2, s[36:39], s44 offen sc1 lds
  s_add_u32 m0, m0, 8192
  s_add_u32 s44, s44, 8192
  s_cmp_ge_u32 s3, 3
  s_cselect_b32 s44, 0x7f000000, s44
  buffer_load_dwordx4 v2, s[36:39], s44 offen sc1 lds
  s_add_u32 m0, m0, 8192
  s_add_u32 s44, s44, 8192
  s_add_u32 s4, s30, s52
  s_addc_u32 s5, s31, 0
  s_load_dwordx16 s[64:79], s[4:5], 0
  s_load_dwordx16 s[80:95], s[4:5], 64
  ds_read_b128 v[224:227], v201
  ds_read_b128 v[228:231], v201 offset:4096
  s_waitcnt lgkmcnt(0)
  v_lshlrev_b32 v208, 16, v224
  v_and_b32 v209, s63, v224
  v_lshlrev_b32 v210, 16, v225
  v_and_b32 v211, s63, v225
  v_lshlrev_b32 v212, 16, v226
  v_and_b32 v213, s63, v226
  v_lshlrev_b32 v214, 16, v227
  v_and_b32 v215, s63, v227
  v_lshlrev_b32 v216, 16, v228
  v_and_b32 v217, s63, v228
  v_lshlrev_b32 v218, 16, v229
  v_and_b32 v219, s63, v229
  v_lshlrev_b32 v220, 16, v230
  v_and_b32 v221, s63, v230
  v_lshlrev_b32 v222, 16, v231
  v_and_b32 v223, s63, v231
  s_sub_u32 s61, s60, s61
  s_add_u32 s60, s61, 40448
  s_add_u32 s61, s61, 19968
  s_mov_b32 s44, 0x3f803f80
  s_waitcnt vmcnt(7)
  s_barrier
  s_waitcnt vmcnt(4)
  s_barrier
  s_waitcnt vmcnt(2)
  s_barrier
  s_waitcnt vmcnt(0)
  s_barrier
  s_lshr_b32 s56, s2, 5
  s_mul_i32 s57, s56, 245760
  s_mul_i32 s58, s46, 61440
  s_add_u32 s57, s57, s58
  s_add_u32 s57, s57, 13475840
  v_add_u32 v3, 4096, v2
  s_add_u32 s58, s56, 0
  s_and_b32 s58, s58, 3
  s_mul_i32 s58, s58, 15360
  s_add_u32 s96, s57, s58
  s_add_u32 s58, s56, 1
  s_and_b32 s58, s58, 3
  s_mul_i32 s58, s58, 15360
  s_add_u32 s97, s57, s58
  s_add_u32 s58, s56, 2
  s_and_b32 s58, s58, 3
  s_mul_i32 s58, s58, 15360
  s_add_u32 s98, s57, s58
  s_add_u32 s58, s56, 3
  s_and_b32 s58, s58, 3
  s_mul_i32 s58, s58, 15360
  s_add_u32 s99, s57, s58
  buffer_load_dwordx4 v[96:99], v2, s[36:39], s96 offen offset:0 sc1
  buffer_load_dwordx4 v[100:103], v2, s[36:39], s96 offen offset:1024 sc1
  buffer_load_dwordx4 v[104:107], v2, s[36:39], s96 offen offset:2048 sc1
  buffer_load_dwordx4 v[108:111], v2, s[36:39], s96 offen offset:3072 sc1
  buffer_load_dwordx4 v[112:115], v3, s[36:39], s96 offen offset:0 sc1
  buffer_load_dwordx4 v[116:119], v2, s[36:39], s97 offen offset:0 sc1
  buffer_load_dwordx4 v[120:123], v2, s[36:39], s97 offen offset:1024 sc1
  buffer_load_dwordx4 v[124:127], v2, s[36:39], s97 offen offset:2048 sc1
  buffer_load_dwordx4 v[128:131], v2, s[36:39], s97 offen offset:3072 sc1
  buffer_load_dwordx4 v[132:135], v3, s[36:39], s97 offen offset:0 sc1
  buffer_load_dwordx4 v[136:139], v2, s[36:39], s98 offen offset:0 sc1
  buffer_load_dwordx4 v[140:143], v2, s[36:39], s98 offen offset:1024 sc1
  s_waitcnt lgkmcnt(0)
  s_barrier
  ds_read_b128 v[16:19], v200 offset:0
  ds_read_b128 v[24:27], v200 offset:9216
  ds_read_b128 v[32:35], v200 offset:18432
  ds_read_b128 v[40:43], v200 offset:27648
  ds_read_b128 v[20:23], v200 offset:16
  ds_read_b128 v[28:31], v200 offset:9232
  ds_read_b128 v[36:39], v200 offset:18448
  ds_read_b128 v[44:47], v200 offset:27664
  s_waitcnt lgkmcnt(6)
  v_pk_add_f32 v[16:17], v[16:17], v[24:25] neg_lo:[0,1] neg_hi:[0,1]
  s_waitcnt lgkmcnt(4)
  v_pk_add_f32 v[32:33], v[32:33], v[40:41] neg_lo:[0,1] neg_hi:[0,1]
  v_pk_add_f32 v[24:25], v[16:17], v[32:33]
  v_pk_add_f32 v[40:41], v[16:17], v[32:33] neg_lo:[0,1] neg_hi:[0,1]
  v_fmac_f32 v215, s66, v24
  v_fmac_f32 v214, s70, v25
  v_fmac_f32 v223, s67, v40
  v_fmac_f32 v222, s71, v41
  v_pk_add_f32 v[18:19], v[18:19], v[26:27] neg_lo:[0,1] neg_hi:[0,1]
  v_pk_add_f32 v[34:35], v[34:35], v[42:43] neg_lo:[0,1] neg_hi:[0,1]
  v_pk_add_f32 v[26:27], v[18:19], v[34:35]
  v_pk_add_f32 v[42:43], v[18:19], v[34:35] neg_lo:[0,1] neg_hi:[0,1]
  v_fmac_f32 v213, s74, v26
  v_fmac_f32 v212, s78, v27
  v_fmac_f32 v221, s75, v42
  v_fmac_f32 v220, s79, v43
  s_waitcnt lgkmcnt(2)
  v_pk_add_f32 v[20:21], v[20:21], v[28:29] neg_lo:[0,1] neg_hi:[0,1]
  s_waitcnt lgkmcnt(0)
  v_pk_add_f32 v[36:37], v[36:37], v[44:45] neg_lo:[0,1] neg_hi:[0,1]
  v_pk_add_f32 v[28:29], v[20:21], v[36:37]
  v_pk_add_f32 v[44:45], v[20:21], v[36:37] neg_lo:[0,1] neg_hi:[0,1]
  v_fmac_f32 v211, s82, v28
  v_fmac_f32 v210, s86, v29
  v_fmac_f32 v219, s83, v44
  v_fmac_f32 v218, s87, v45
  v_pk_add_f32 v[22:23], v[22:23], v[30:31] neg_lo:[0,1] neg_hi:[0,1]
  v_pk_add_f32 v[38:39], v[38:39], v[46:47] neg_lo:[0,1] neg_hi:[0,1]
  v_pk_add_f32 v[30:31], v[22:23], v[38:39]
  v_pk_add_f32 v[46:47], v[22:23], v[38:39] neg_lo:[0,1] neg_hi:[0,1]
  v_fmac_f32 v209, s90, v30
  v_fmac_f32 v208, s94, v31
  v_fmac_f32 v217, s91, v46
  v_fmac_f32 v216, s95, v47
  v_cvt_pk_bf16_f32 v224, v208, v209
  v_cvt_pk_bf16_f32 v225, v210, v211
  v_cvt_pk_bf16_f32 v226, v212, v213
  v_cvt_pk_bf16_f32 v227, v214, v215
  buffer_store_dwordx4 v[224:227], v202, s[36:39], s60 offen sc1
  v_cvt_pk_bf16_f32 v228, v216, v217
  v_cvt_pk_bf16_f32 v229, v218, v219
  v_cvt_pk_bf16_f32 v230, v220, v221
  v_cvt_pk_bf16_f32 v231, v222, v223
  buffer_store_dwordx4 v[228:231], v202, s[36:39], s61 offen sc1
  v_dot2c_f32_bf16 v206, s44, v224
  v_dot2c_f32_bf16 v207, v224, v224
  v_dot2c_f32_bf16 v206, s44, v225
  v_dot2c_f32_bf16 v207, v225, v225
  v_dot2c_f32_bf16 v206, s44, v226
  v_dot2c_f32_bf16 v207, v226, v226
  v_dot2c_f32_bf16 v206, s44, v227
  v_dot2c_f32_bf16 v207, v227, v227
  v_dot2c_f32_bf16 v206, s44, v228
  v_dot2c_f32_bf16 v207, v228, v228
  v_dot2c_f32_bf16 v206, s44, v229
  v_dot2c_f32_bf16 v207, v229, v229
  v_dot2c_f32_bf16 v206, s44, v230
  v_dot2c_f32_bf16 v207, v230, v230
  v_dot2c_f32_bf16 v206, s44, v231
  v_dot2c_f32_bf16 v207, v231, v231
  s_nop 2
  ds_write_b64 v204, v[206:207]
  buffer_load_dwordx4 v[144:147], v2, s[36:39], s98 offen offset:2048 sc1
  buffer_load_dwordx4 v[148:151], v2, s[36:39], s98 offen offset:3072 sc1
  buffer_load_dwordx4 v[152:155], v3, s[36:39], s98 offen offset:0 sc1
  buffer_load_dwordx4 v[156:159], v2, s[36:39], s99 offen offset:0 sc1
  buffer_load_dwordx4 v[160:163], v2, s[36:39], s99 offen offset:1024 sc1
  s_waitcnt vmcnt(5) lgkmcnt(0)
  s_barrier
  s_mov_b32 s45, s59
  s_cmp_eq_u32 s3, 7
  s_cbranch_scc0 K45_entry
  ds_read_b64 v[16:17], v205 offset:0
  ds_read_b64 v[18:19], v205 offset:512
  ds_read_b64 v[20:21], v205 offset:1024
  ds_read_b64 v[22:23], v205 offset:1536
  ds_read_b64 v[24:25], v205 offset:2048
  ds_read_b64 v[26:27], v205 offset:2560
  ds_read_b64 v[28:29], v205 offset:3072
  ds_read_b64 v[30:31], v205 offset:3584
  s_waitcnt lgkmcnt(6)
  v_pk_add_f32 v[16:17], v[16:17], v[18:19]
  s_waitcnt lgkmcnt(4)
  v_pk_add_f32 v[20:21], v[20:21], v[22:23]
  s_waitcnt lgkmcnt(2)
  v_pk_add_f32 v[24:25], v[24:25], v[26:27]
  s_waitcnt lgkmcnt(0)
  v_pk_add_f32 v[28:29], v[28:29], v[30:31]
  v_pk_add_f32 v[16:17], v[16:17], v[20:21]
  v_pk_add_f32 v[24:25], v[24:25], v[28:29]
  v_pk_add_f32 v[16:17], v[16:17], v[24:25]
  buffer_store_dwordx2 v[16:17], v203, s[36:39], s62 offen sc1
  s_branch K45_entry
K3_wp:
  s_mov_b32 s45, 0x7f000000
  s_mov_b64 exec, -1
K3_pw:
  s_cmp_eq_u32 s15, 7
  s_cbranch_scc0 K3_pw2
  s_and_b32 s4, s2, 7
  s_lshl_b32 s4, s4, 7
  s_add_u32 s4, s4, 21793280
  v_mov_b32 v240, 0
  s_mov_b32 s14, 0x10000
  s_nop 4
SP_g1b:
  buffer_load_dword v241, v240, s[36:39], s4 offen offset:0 sc0 sc1
  s_sub_u32 s14, s14, 1
  s_waitcnt vmcnt(0)
  v_cmp_ne_u32 vcc, 1, v241
  s_cmp_eq_u32 s14, 0
  s_cbranch_scc1 SG_g1b
  s_nop 3
  s_cbranch_vccnz SP_g1b
SG_g1b:
  s_nop 1
  s_and_b32 s4, s2, 7
  s_lshl_b32 s4, s4, 10
  s_add_u32 s4, s4, 21772288
  v_and_b32 v240, 15, v0
  v_lshlrev_b32 v240, 6, v240
  s_mov_b32 s14, 0x10000
  s_nop 4
SP_g1c:
  buffer_load_dword v241, v240, s[36:39], s4 offen offset:0 sc0 sc1
  s_sub_u32 s14, s14, 1
  s_waitcnt vmcnt(0)
  v_cmp_ne_u32 vcc, 1, v241
  s_cmp_eq_u32 s14, 0
  s_cbranch_scc1 SG_g1c
  s_nop 3
  s_cbranch_vccnz SP_g1c
SG_g1c:
  s_nop 1
K3_pw2:
  s_barrier
  s_cmp_ge_u32 s3, 4
  s_cbranch_scc0 K45_entry
K3_pl:
  s_and_b32 s46, s3, 3
  v_lshlrev_b32 v2, 4, v0
  s_lshr_b32 s56, s2, 5
  s_mul_i32 s57, s56, 245760
  s_mul_i32 s58, s46, 61440
  s_add_u32 s57, s57, s58
  s_add_u32 s57, s57, 13475840
  v_add_u32 v3, 4096, v2
  s_add_u32 s58, s56, 0
  s_and_b32 s58, s58, 3
  s_mul_i32 s58, s58, 15360
  s_add_u32 s96, s57, s58
  s_add_u32 s58, s56, 1
  s_and_b32 s58, s58, 3
  s_mul_i32 s58, s58, 15360
  s_add_u32 s97, s57, s58
  s_add_u32 s58, s56, 2
  s_and_b32 s58, s58, 3
  s_mul_i32 s58, s58, 15360
  s_add_u32 s98, s57, s58
  s_add_u32 s58, s56, 3
  s_and_b32 s58, s58, 3
  s_mul_i32 s58, s58, 15360
  s_add_u32 s99, s57, s58
  buffer_load_dwordx4 v[96:99], v2, s[36:39], s96 offen offset:0 sc1
  buffer_load_dwordx4 v[100:103], v2, s[36:39], s96 offen offset:1024 sc1
  buffer_load_dwordx4 v[104:107], v2, s[36:39], s96 offen offset:2048 sc1
  buffer_load_dwordx4 v[108:111], v2, s[36:39], s96 offen offset:3072 sc1
  buffer_load_dwordx4 v[112:115], v3, s[36:39], s96 offen offset:0 sc1
  buffer_load_dwordx4 v[116:119], v2, s[36:39], s97 offen offset:0 sc1
  buffer_load_dwordx4 v[120:123], v2, s[36:39], s97 offen offset:1024 sc1
  buffer_load_dwordx4 v[124:127], v2, s[36:39], s97 offen offset:2048 sc1
  buffer_load_dwordx4 v[128:131], v2, s[36:39], s97 offen offset:3072 sc1
  buffer_load_dwordx4 v[132:135], v3, s[36:39], s97 offen offset:0 sc1
  buffer_load_dwordx4 v[136:139], v2, s[36:39], s98 offen offset:0 sc1
  buffer_load_dwordx4 v[140:143], v2, s[36:39], s98 offen offset:1024 sc1
  buffer_load_dwordx4 v[144:147], v2, s[36:39], s98 offen offset:2048 sc1
  buffer_load_dwordx4 v[148:151], v2, s[36:39], s98 offen offset:3072 sc1
  buffer_load_dwordx4 v[152:155], v3, s[36:39], s98 offen offset:0 sc1
  buffer_load_dwordx4 v[156:159], v2, s[36:39], s99 offen offset:0 sc1
  buffer_load_dwordx4 v[160:163], v2, s[36:39], s99 offen offset:1024 sc1
K45_entry:
  s_mov_b32 s47, s3
  s_and_b32 s4, s2, 1
  s_lshl_b32 s4, s4, 3
  s_bfe_u32 s5, s2, 196611
  s_add_u32 s4, s4, s5
  s_bfe_u32 s5, s2, 131073
  s_lshl_b32 s5, s5, 2
  s_lshr_b32 s6, s2, 6
  s_add_u32 s5, s5, s6
  v_lshlrev_b32 v2, 4, v0
  s_cmp_ge_u32 s3, 4
  s_cbranch_scc0 K4_compute
  s_sub_u32 s3, s3, 4
  s_mul_i32 s7, s5, 258048
  s_mul_i32 s8, s3, 3072
  s_add_u32 s7, s7, s8
  s_add_u32 s7, s7, 9347072
  s_lshl_b32 s24, s5, 8
  s_and_b32 s25, s2, 1
  s_lshl_b32 s25, s25, 7
  s_add_u32 s24, s24, s25
  s_add_u32 s24, s24, 21766144
  v_and_b32 v252, 3, v0
  v_lshlrev_b32 v252, 2, v252
  v_and_b32 v253, 7, v0
  v_lshlrev_b32 v253, 2, v253
  buffer_load_dword v254, v252, s[36:39], s24 offen sc0 sc1
  s_mul_i32 s22, s3, 20480
  s_add_u32 s22, s22, 73728
  buffer_load_dwordx4 v[164:167], v2, s[36:39], s99 offen offset:2048 sc1
  buffer_load_dwordx4 v[168:171], v2, s[36:39], s99 offen offset:3072 sc1
  buffer_load_dwordx4 v[172:175], v3, s[36:39], s99 offen offset:0 sc1
  s_add_u32 s96, s96, 5120
  buffer_load_dwordx4 v[176:179], v2, s[36:39], s96 offen offset:0 sc1
  s_waitcnt vmcnt(4)
  v_cmp_ne_u32 vcc, 1, v254
  s_nop 4
  s_cbranch_vccz K4_wok0
  s_mov_b32 s21, 0x10000
  s_nop 1
SP_w0:
  buffer_load_dword v254, v252, s[36:39], s24 offen offset:0 sc0 sc1
  s_sub_u32 s21, s21, 1
  s_waitcnt vmcnt(0)
  v_cmp_ne_u32 vcc, 1, v254
  s_cmp_eq_u32 s21, 0
  s_cbranch_scc1 SG_w0
  s_nop 3
  s_cbranch_vccnz SP_w0
SG_w0:
K4_wok0:
  s_add_u32 m0, s8, 0
  s_nop 0
  buffer_load_dwordx4 v2, s[36:39], s7 offen sc1 lds
  buffer_load_dwordx4 v2, s[36:39], s7 offen offset:1024 sc1 lds
  buffer_load_dwordx4 v2, s[36:39], s7 offen offset:2048 sc1 lds
  s_add_u32 s7, s7, 12288
  s_add_u32 m0, s8, 12288
  s_nop 0
  buffer_load_dwordx4 v2, s[36:39], s7 offen sc1 lds
  buffer_load_dwordx4 v2, s[36:39], s7 offen offset:1024 sc1 lds
  buffer_load_dwordx4 v2, s[36:39], s7 offen offset:2048 sc1 lds
  s_add_u32 s7, s7, 12288
  s_add_u32 m0, s8, 24576
  s_nop 0
  buffer_load_dwordx4 v2, s[36:39], s7 offen sc1 lds
  buffer_load_dwordx4 v2, s[36:39], s7 offen offset:1024 sc1 lds
  buffer_load_dwordx4 v2, s[36:39], s7 offen offset:2048 sc1 lds
  s_add_u32 s7, s7, 12288
  s_add_u32 m0, s8, 36864
  s_nop 0
  buffer_load_dwordx4 v2, s[36:39], s7 offen sc1 lds
  buffer_load_dwordx4 v2, s[36:39], s7 offen offset:1024 sc1 lds
  buffer_load_dwordx4 v2, s[36:39], s7 offen offset:2048 sc1 lds
  s_add_u32 s7, s7, 12288
  s_add_u32 m0, s8, 49152
  s_nop 0
  buffer_load_dwordx4 v2, s[36:39], s7 offen sc1 lds
  buffer_load_dwordx4 v2, s[36:39], s7 offen offset:1024 sc1 lds
  buffer_load_dwordx4 v2, s[36:39], s7 offen offset:2048 sc1 lds
  s_add_u32 s7, s7, 12288
  s_add_u32 m0, s8, 61440
  s_nop 0
  buffer_load_dwordx4 v2, s[36:39], s7 offen sc1 lds
  buffer_load_dwordx4 v2, s[36:39], s7 offen offset:1024 sc1 lds
  buffer_load_dwordx4 v2, s[36:39], s7 offen offset:2048 sc1 lds
  s_add_u32 s7, s7, 12288
  buffer_load_dwordx4 v[180:183], v2, s[36:39], s96 offen offset:1024 sc1
  buffer_load_dwordx4 v[184:187], v2, s[36:39], s96 offen offset:2048 sc1
  buffer_load_dwordx4 v[188:191], v2, s[36:39], s96 offen offset:3072 sc1
  buffer_load_dwordx4 v[192:195], v3, s[36:39], s96 offen offset:0 sc1
  buffer_load_dword v255, v253, s[36:39], s24 offen offset:16 sc0 sc1
  s_setprio 0
  s_waitcnt vmcnt(20)
  s_barrier
  s_cmp_eq_u32 s3, 3
  s_cbranch_scc0 K4_notf
  v_lshlrev_b32 v12, 7, v0
  v_mov_b32 v13, 1
  s_mov_b64 exec, 15
  buffer_store_dword v13, v12, s[36:39], s45 offen offset:32 sc0 sc1
  s_mov_b64 exec, -1
K4_notf:
  s_waitcnt vmcnt(17)
  s_barrier
  s_waitcnt vmcnt(14)
  s_barrier
  s_add_u32 m0, s8, 0
  s_nop 0
  buffer_load_dwordx4 v2, s[36:39], s7 offen sc1 lds
  buffer_load_dwordx4 v2, s[36:39], s7 offen offset:1024 sc1 lds
  buffer_load_dwordx4 v2, s[36:39], s7 offen offset:2048 sc1 lds
  s_add_u32 s7, s7, 12288
  s_and_b32 s4, s2, 7
  s_lshl_b32 s4, s4, 2
  s_bfe_u32 s5, s2, 0x20003
  s_add_u32 s4, s4, s5
  s_lshr_b32 s5, s2, 5
  s_mul_i32 s10, s4, 196608
  s_mul_i32 s21, s3, 12288
  s_add_u32 s10, s10, s21
  s_add_u32 s10, s10, 15441920
  s_add_u32 s20, s5, 0
  s_and_b32 s20, s20, 3
  s_mul_i32 s21, s20, 3072
  s_add_u32 s40, s10, s21
  s_add_u32 s20, s5, 1
  s_and_b32 s20, s20, 3
  s_mul_i32 s21, s20, 3072
  s_add_u32 s41, s10, s21
  s_add_u32 s20, s5, 2
  s_and_b32 s20, s20, 3
  s_mul_i32 s21, s20, 3072
  s_add_u32 s42, s10, s21
  s_add_u32 s20, s5, 3
  s_and_b32 s20, s20, 3
  s_mul_i32 s21, s20, 3072
  s_add_u32 s43, s10, s21
  s_add_u32 s20, s3, 1
  s_and_b32 s20, s20, 3
  s_mul_i32 s21, s20, 49152
  v_add_u32 v12, s21, v2
  s_mul_i32 s21, s20, 15360
  s_add_u32 s21, s21, 83968
  v_add_u32 v13, s21, v2
  s_add_u32 s20, s3, 2
  s_and_b32 s20, s20, 3
  s_mul_i32 s21, s20, 49152
  v_add_u32 v4, s21, v2
  s_mul_i32 s21, s20, 15360
  s_add_u32 s21, s21, 78848
  v_add_u32 v14, s21, v2
  s_add_u32 s20, s3, 3
  s_and_b32 s20, s20, 3
  s_mul_i32 s21, s20, 49152
  v_add_u32 v5, s21, v2
  s_mul_i32 s21, s20, 15360
  s_add_u32 s21, s21, 73728
  v_add_u32 v15, s21, v2
  s_add_u32 s20, s3, 4
  s_and_b32 s20, s20, 3
  s_mul_i32 s21, s20, 49152
  v_add_u32 v6, s21, v2
  v_add_u32 v3, 4096, v2
  s_lshl_b32 s14, s4, 1
  s_lshr_b32 s21, s3, 1
  s_add_u32 s14, s14, s21
  s_mul_i32 s14, s14, 40960
  s_mul_i32 s21, s5, 5120
  s_add_u32 s14, s14, s21
  s_and_b32 s21, s3, 1
  s_lshl_b32 s21, s21, 8
  s_add_u32 s14, s14, s21
  s_add_u32 s14, s14, 6070272
  s_add_u32 s15, s14, 4096
  v_and_b32 v7, 15, v0
  v_lshrrev_b32 v8, 5, v0
  v_bfe_u32 v9, v0, 4, 1
  v_lshlrev_b32 v10, 4, v7
  v_lshl_add_u32 v10, v8, 9, v10
  v_lshl_add_u32 v10, v9, 3, v10
  v_lshrrev_b32 v8, 4, v0
  v_mul_u32_u24 v7, 176, v7
  v_lshl_add_u32 v7, v8, 3, v7
  s_mul_i32 s17, s3, 2816
  s_add_u32 s17, s17, 135168
  v_add_u32 v7, s17, v7
  s_mul_i32 s16, s4, 1280
  s_mul_i32 s21, s5, 160
  s_add_u32 s16, s16, s21
  s_mul_i32 s21, s3, 655360
  s_add_u32 s16, s16, s21
  s_mov_b32 s18, 0xffff0000
  s_lshl_b32 s19, s4, 2
  s_add_u32 s19, s19, s3
  s_lshl_b32 s19, s19, 7
  s_add_u32 s19, s19, 21733376
  s_mul_i32 s22, s3, 20480
  s_add_u32 s22, s22, 73728
  v_add_u32 v8, s22, v2
  v_and_b32 v1, 7, v0
  v_lshlrev_b32 v1, 2, v1
  s_mul_i32 s21, s3, 15360
  s_add_u32 s21, s21, 73728
  v_add_u32 v9, s21, v2
  v_add_u32 v11, s8, v2
  s_mov_b32 s32, s100
  s_mov_b32 s33, s101
  s_mov_b32 s34, 2621440
  s_mov_b32 s35, 0x20000
  s_waitcnt vmcnt(14)
  s_barrier
  s_waitcnt vmcnt(3)
  v_cmp_ne_u32 vcc, 1, v255
  s_nop 4
  s_cbranch_vccz K4_wok
  s_mov_b32 s21, 0x10000
  s_nop 1
SP_w1:
  buffer_load_dword v255, v253, s[36:39], s24 offen offset:16 sc0 sc1
  s_sub_u32 s21, s21, 1
  s_waitcnt vmcnt(0)
  v_cmp_ne_u32 vcc, 1, v255
  s_cmp_eq_u32 s21, 0
  s_cbranch_scc1 SG_w1
  s_nop 3
  s_cbranch_vccnz SP_w1
SG_w1:
K4_wok:
  s_add_u32 m0, s8, 12288
  s_nop 0
  buffer_load_dwordx4 v2, s[36:39], s7 offen sc1 lds
  buffer_load_dwordx4 v2, s[36:39], s7 offen offset:1024 sc1 lds
  buffer_load_dwordx4 v2, s[36:39], s7 offen offset:2048 sc1 lds
  s_add_u32 s7, s7, 12288
  s_waitcnt vmcnt(14)
  s_barrier
  s_add_u32 m0, s8, 24576
  s_nop 0
  buffer_load_dwordx4 v2, s[36:39], s7 offen sc1 lds
  buffer_load_dwordx4 v2, s[36:39], s7 offen offset:1024 sc1 lds
  buffer_load_dwordx4 v2, s[36:39], s7 offen offset:2048 sc1 lds
  s_add_u32 s7, s7, 12288
  s_waitcnt vmcnt(14)
  s_barrier
  s_add_u32 m0, s8, 36864
  s_nop 0
  buffer_load_dwordx4 v2, s[36:39], s7 offen sc1 lds
  buffer_load_dwordx4 v2, s[36:39], s7 offen offset:1024 sc1 lds
  buffer_load_dwordx4 v2, s[36:39], s7 offen offset:2048 sc1 lds
  s_add_u32 s7, s7, 12288
  s_waitcnt vmcnt(9)
  s_barrier
  s_add_u32 m0, s8, 49152
  s_nop 0
  buffer_load_dwordx4 v2, s[36:39], s7 offen sc1 lds
  buffer_load_dwordx4 v2, s[36:39], s7 offen offset:1024 sc1 lds
  buffer_load_dwordx4 v2, s[36:39], s7 offen offset:2048 sc1 lds
  s_add_u32 s7, s7, 12288
  s_add_u32 s97, s97, 5120
  s_add_u32 m0, s22, 0
  s_nop 0
  buffer_load_dwordx4 v2, s[36:39], s97 offen offset:0 sc1 lds
  s_add_u32 m0, s22, 0
  s_nop 0
  buffer_load_dwordx4 v2, s[36:39], s97 offen offset:1024 sc1 lds
  s_add_u32 m0, s22, 0
  s_nop 0
  buffer_load_dwordx4 v2, s[36:39], s97 offen offset:2048 sc1 lds
  s_waitcnt vmcnt(12)
  s_barrier
  s_add_u32 m0, s8, 61440
  s_nop 0
  buffer_load_dwordx4 v2, s[36:39], s7 offen sc1 lds
  buffer_load_dwordx4 v2, s[36:39], s7 offen offset:1024 sc1 lds
  buffer_load_dwordx4 v2, s[36:39], s7 offen offset:2048 sc1 lds
  s_add_u32 s7, s7, 12288
  s_add_u32 m0, s22, 0
  s_nop 0
  buffer_load_dwordx4 v2, s[36:39], s97 offen offset:3072 sc1 lds
  s_add_u32 m0, s22, 4096
  s_nop 0
  buffer_load_dwordx4 v3, s[36:39], s97 offen offset:0 sc1 lds
  s_add_u32 s98, s98, 5120
  s_add_u32 m0, s22, 5120
  s_nop 0
  buffer_load_dwordx4 v2, s[36:39], s98 offen offset:0 sc1 lds
  s_waitcnt vmcnt(15)
  s_barrier
  s_add_u32 m0, s8, 0
  s_nop 0
  buffer_load_dwordx4 v2, s[36:39], s7 offen sc1 lds
  buffer_load_dwordx4 v2, s[36:39], s7 offen offset:1024 sc1 lds
  buffer_load_dwordx4 v2, s[36:39], s7 offen offset:2048 sc1 lds
  s_add_u32 s7, s7, 12288
  s_add_u32 m0, s22, 5120
  s_nop 0
  buffer_load_dwordx4 v2, s[36:39], s98 offen offset:1024 sc1 lds
  s_add_u32 m0, s22, 5120
  s_nop 0
  buffer_load_dwordx4 v2, s[36:39], s98 offen offset:2048 sc1 lds
  s_add_u32 m0, s22, 5120
  s_nop 0
  buffer_load_dwordx4 v2, s[36:39], s98 offen offset:3072 sc1 lds
  s_waitcnt vmcnt(18)
  s_barrier
  s_add_u32 m0, s8, 12288
  s_nop 0
  buffer_load_dwordx4 v2, s[36:39], s7 offen sc1 lds
  buffer_load_dwordx4 v2, s[36:39], s7 offen offset:1024 sc1 lds
  buffer_load_dwordx4 v2, s[36:39], s7 offen offset:2048 sc1 lds
  s_add_u32 s7, s7, 12288
  s_add_u32 m0, s22, 9216
  s_nop 0
  buffer_load_dwordx4 v3, s[36:39], s98 offen offset:0 sc1 lds
  s_add_u32 s99, s99, 5120
  s_add_u32 m0, s22, 10240
  s_nop 0
  buffer_load_dwordx4 v2, s[36:39], s99 offen offset:0 sc1 lds
  s_add_u32 m0, s22, 10240
  s_nop 0
  buffer_load_dwordx4 v2, s[36:39], s99 offen offset:1024 sc1 lds
  s_waitcnt vmcnt(21)
  s_barrier
  s_add_u32 m0, s8, 24576
  s_nop 0
  buffer_load_dwordx4 v2, s[36:39], s7 offen sc1 lds
  buffer_load_dwordx4 v2, s[36:39], s7 offen offset:1024 sc1 lds
  buffer_load_dwordx4 v2, s[36:39], s7 offen offset:2048 sc1 lds
  s_add_u32 s7, s7, 12288
  s_add_u32 m0, s22, 10240
  s_nop 0
  buffer_load_dwordx4 v2, s[36:39], s99 offen offset:2048 sc1 lds
  s_add_u32 m0, s22, 10240
  s_nop 0
  buffer_load_dwordx4 v2, s[36:39], s99 offen offset:3072 sc1 lds
  s_add_u32 m0, s22, 14336
  s_nop 0
  buffer_load_dwordx4 v3, s[36:39], s99 offen offset:0 sc1 lds
  s_waitcnt vmcnt(21)
  s_barrier
  s_add_u32 m0, s8, 36864
  s_nop 0
  buffer_load_dwordx4 v2, s[36:39], s7 offen sc1 lds
  buffer_load_dwordx4 v2, s[36:39], s7 offen offset:1024 sc1 lds
  buffer_load_dwordx4 v2, s[36:39], s7 offen offset:2048 sc1 lds
  s_add_u32 s7, s7, 12288
  s_add_u32 s96, s96, 5120
  s_add_u32 m0, s22, 15360
  s_nop 0
  buffer_load_dwordx4 v2, s[36:39], s96 offen offset:0 sc1 lds
  s_add_u32 m0, s22, 15360
  s_nop 0
  buffer_load_dwordx4 v2, s[36:39], s96 offen offset:1024 sc1 lds
  s_add_u32 m0, s22, 15360
  s_nop 0
  buffer_load_dwordx4 v2, s[36:39], s96 offen offset:2048 sc1 lds
  s_waitcnt vmcnt(21)
  s_barrier
  s_add_u32 m0, s8, 49152
  s_nop 0
  buffer_load_dwordx4 v2, s[36:39], s7 offen sc1 lds
  buffer_load_dwordx4 v2, s[36:39], s7 offen offset:1024 sc1 lds
  buffer_load_dwordx4 v2, s[36:39], s7 offen offset:2048 sc1 lds
  s_add_u32 s7, s7, 12288
  s_add_u32 m0, s22, 15360
  s_nop 0
  buffer_load_dwordx4 v2, s[36:39], s96 offen offset:3072 sc1 lds
  s_add_u32 m0, s22, 19456
  s_nop 0
  buffer_load_dwordx4 v3, s[36:39], s96 offen offset:0 sc1 lds
  s_waitcnt vmcnt(20)
  s_barrier
  s_add_u32 m0, s8, 61440
  s_nop 0
  buffer_load_dwordx4 v2, s[36:39], s7 offen sc1 lds
  buffer_load_dwordx4 v2, s[36:39], s7 offen offset:1024 sc1 lds
  buffer_load_dwordx4 v2, s[36:39], s7 offen offset:2048 sc1 lds
  s_add_u32 s7, s7, 12288
  buffer_load_dword v254, v1, s[36:39], s19 offen sc0 sc1
  s_waitcnt vmcnt(18)
  s_barrier
  s_add_u32 m0, s8, 0
  s_nop 0
  buffer_load_dwordx4 v2, s[36:39], s7 offen sc1 lds
  buffer_load_dwordx4 v2, s[36:39], s7 offen offset:1024 sc1 lds
  buffer_load_dwordx4 v2, s[36:39], s7 offen offset:2048 sc1 lds
  s_add_u32 s7, s7, 12288
  s_waitcnt vmcnt(15)
  s_barrier
  s_add_u32 m0, s8, 12288
  s_nop 0
  buffer_load_dwordx4 v2, s[36:39], s7 offen sc1 lds
  buffer_load_dwordx4 v2, s[36:39], s7 offen offset:1024 sc1 lds
  buffer_load_dwordx4 v2, s[36:39], s7 offen offset:2048 sc1 lds
  s_add_u32 s7, s7, 12288
  s_waitcnt vmcnt(6)
  v_cmp_ne_u32 vcc, 1, v254
  s_nop 4
  s_cbranch_vccz K5_goa
  s_mov_b32 s21, 0x10000
K5_polla:
  buffer_load_dword v254, v1, s[36:39], s19 offen offset:0 sc0 sc1
  s_sub_u32 s21, s21, 1
  s_waitcnt vmcnt(0)
  v_cmp_ne_u32 vcc, 1, v254
  s_cmp_eq_u32 s21, 0
  s_cbranch_scc1 K5_goa
  s_nop 3
  s_cbranch_vccnz K5_polla
K5_goa:
  buffer_load_dwordx4 v[196:199], v12, s[36:39], s40 offen offset:0 sc1
  buffer_load_dwordx4 v[200:203], v4, s[36:39], s40 offen offset:0 sc1
  buffer_load_dwordx4 v[204:207], v5, s[36:39], s40 offen offset:0 sc1
  s_waitcnt vmcnt(15)
  s_barrier
  s_add_u32 m0, s8, 24576
  s_nop 0
  buffer_load_dwordx4 v2, s[36:39], s7 offen sc1 lds
  buffer_load_dwordx4 v2, s[36:39], s7 offen offset:1024 sc1 lds
  buffer_load_dwordx4 v2, s[36:39], s7 offen offset:2048 sc1 lds
  s_add_u32 s7, s7, 12288
  buffer_load_dwordx4 v[208:211], v6, s[36:39], s40 offen offset:0 sc1
  buffer_load_dwordx4 v[212:215], v12, s[36:39], s41 offen offset:0 sc1
  buffer_load_dwordx4 v[216:219], v4, s[36:39], s41 offen offset:0 sc1
  s_waitcnt vmcnt(16)
  s_barrier
  s_add_u32 s97, s97, 5120
  s_add_u32 s23, s97, 0
  s_add_u32 m0, s8, 36864
  s_nop 0
  buffer_load_dwordx4 v2, s[36:39], s23 offen sc1 lds
  s_add_u32 s23, s97, 1024
  s_add_u32 m0, s8, 37888
  s_nop 0
  buffer_load_dwordx4 v2, s[36:39], s23 offen sc1 lds
  s_add_u32 s23, s97, 2048
  s_add_u32 m0, s8, 38912
  s_nop 0
  buffer_load_dwordx4 v2, s[36:39], s23 offen sc1 lds
  buffer_load_dwordx4 v[220:223], v5, s[36:39], s41 offen offset:0 sc1
  buffer_load_dwordx4 v[224:227], v6, s[36:39], s41 offen offset:0 sc1
  buffer_load_dwordx4 v[228:231], v12, s[36:39], s42 offen offset:0 sc1
  s_waitcnt vmcnt(18)
  s_barrier
  s_add_u32 s23, s97, 3072
  s_add_u32 m0, s8, 49152
  s_nop 0
  buffer_load_dwordx4 v2, s[36:39], s23 offen sc1 lds
  s_add_u32 s23, s97, 4096
  s_add_u32 m0, s8, 50176
  s_nop 0
  buffer_load_dwordx4 v2, s[36:39], s23 offen sc1 lds
  s_add_u32 s98, s98, 5120
  s_add_u32 s23, s98, 0
  s_add_u32 m0, s8, 51200
  s_nop 0
  buffer_load_dwordx4 v2, s[36:39], s23 offen sc1 lds
  buffer_load_dwordx4 v[232:235], v4, s[36:39], s42 offen offset:0 sc1
  buffer_load_dwordx4 v[236:239], v5, s[36:39], s42 offen offset:0 sc1
  buffer_load_dwordx4 v[240:243], v6, s[36:39], s42 offen offset:0 sc1
  s_waitcnt vmcnt(21)
  s_barrier
  s_add_u32 s23, s98, 1024
  s_add_u32 m0, s8, 61440
  s_nop 0
  buffer_load_dwordx4 v2, s[36:39], s23 offen sc1 lds
  s_add_u32 s23, s98, 2048
  s_add_u32 m0, s8, 62464
  s_nop 0
  buffer_load_dwordx4 v2, s[36:39], s23 offen sc1 lds
  s_add_u32 s23, s98, 3072
  s_add_u32 m0, s8, 63488
  s_nop 0
  buffer_load_dwordx4 v2, s[36:39], s23 offen sc1 lds
  buffer_load_dwordx4 v[244:247], v12, s[36:39], s43 offen offset:0 sc1
  buffer_load_dwordx4 v[248:251], v4, s[36:39], s43 offen offset:0 sc1
  s_waitcnt vmcnt(20)
  s_barrier
  s_add_u32 s23, s98, 4096
  s_add_u32 m0, s8, 0
  s_nop 0
  buffer_load_dwordx4 v2, s[36:39], s23 offen sc1 lds
  s_add_u32 s99, s99, 5120
  s_add_u32 s23, s99, 0
  s_add_u32 m0, s8, 1024
  s_nop 0
  buffer_load_dwordx4 v2, s[36:39], s23 offen sc1 lds
  s_add_u32 s23, s99, 1024
  s_add_u32 m0, s8, 2048
  s_nop 0
  buffer_load_dwordx4 v2, s[36:39], s23 offen sc1 lds
  buffer_load_dword v254, v1, s[36:39], s19 offen offset:32 sc0 sc1
  s_waitcnt vmcnt(40)
  s_barrier
  v_mfma_f32_16x16x32_bf16 v[16:19], v[96:99], v[196:199], 0
  v_mfma_f32_16x16x32_bf16 v[20:23], v[100:103], v[196:199], 0
  v_mfma_f32_16x16x32_bf16 v[24:27], v[104:107], v[196:199], 0
  v_mfma_f32_16x16x32_bf16 v[28:31], v[108:111], v[196:199], 0
  v_mfma_f32_16x16x32_bf16 v[32:35], v[112:115], v[196:199], 0
  v_mfma_f32_16x16x32_bf16 v[36:39], v[96:99], v[200:203], 0
  buffer_load_dwordx4 v[196:199], v5, s[36:39], s43 offen offset:0 sc1
  v_mfma_f32_16x16x32_bf16 v[40:43], v[100:103], v[200:203], 0
  v_mfma_f32_16x16x32_bf16 v[44:47], v[104:107], v[200:203], 0
  v_mfma_f32_16x16x32_bf16 v[48:51], v[108:111], v[200:203], 0
  v_mfma_f32_16x16x32_bf16 v[52:55], v[112:115], v[200:203], 0
  v_mfma_f32_16x16x32_bf16 v[56:59], v[96:99], v[204:207], 0
  v_mfma_f32_16x16x32_bf16 v[60:63], v[100:103], v[204:207], 0
  buffer_load_dwordx4 v[200:203], v6, s[36:39], s43 offen offset:0 sc1
  v_mfma_f32_16x16x32_bf16 v[64:67], v[104:107], v[204:207], 0
  v_mfma_f32_16x16x32_bf16 v[68:71], v[108:111], v[204:207], 0
  v_mfma_f32_16x16x32_bf16 v[72:75], v[112:115], v[204:207], 0
  s_waitcnt vmcnt(25)
  v_mfma_f32_16x16x32_bf16 v[76:79], v[96:99], v[208:211], 0
  v_mfma_f32_16x16x32_bf16 v[80:83], v[100:103], v[208:211], 0
  v_mfma_f32_16x16x32_bf16 v[84:87], v[104:107], v[208:211], 0
  s_waitcnt vmcnt(2)
  v_cmp_ne_u32 vcc, 1, v254
  s_nop 4
  s_cbranch_vccz K5_gob
  s_mov_b32 s21, 0x10000
K5_pollb:
  buffer_load_dword v254, v1, s[36:39], s19 offen offset:32 sc0 sc1
  s_sub_u32 s21, s21, 1
  s_waitcnt vmcnt(0)
  v_cmp_ne_u32 vcc, 1, v254
  s_cmp_eq_u32 s21, 0
  s_cbranch_scc1 K5_gob
  s_nop 3
  s_cbranch_vccnz K5_pollb
K5_gob:
  buffer_load_dwordx4 v[204:207], v12, s[36:39], s40 offen offset:1024 sc1
  v_mfma_f32_16x16x32_bf16 v[88:91], v[108:111], v[208:211], 0
  v_mfma_f32_16x16x32_bf16 v[92:95], v[112:115], v[208:211], 0
  v_mfma_f32_16x16x32_bf16 v[16:19], v[116:119], v[212:215], v[16:19]
  v_mfma_f32_16x16x32_bf16 v[20:23], v[120:123], v[212:215], v[20:23]
  v_mfma_f32_16x16x32_bf16 v[24:27], v[124:127], v[212:215], v[24:27]
  v_mfma_f32_16x16x32_bf16 v[28:31], v[128:131], v[212:215], v[28:31]
  buffer_load_dwordx4 v[96:99], v4, s[36:39], s40 offen offset:1024 sc1
  v_mfma_f32_16x16x32_bf16 v[32:35], v[132:135], v[212:215], v[32:35]
  v_mfma_f32_16x16x32_bf16 v[36:39], v[116:119], v[216:219], v[36:39]
  v_mfma_f32_16x16x32_bf16 v[40:43], v[120:123], v[216:219], v[40:43]
  v_mfma_f32_16x16x32_bf16 v[44:47], v[124:127], v[216:219], v[44:47]
  v_mfma_f32_16x16x32_bf16 v[48:51], v[128:131], v[216:219], v[48:51]
  v_mfma_f32_16x16x32_bf16 v[52:55], v[132:135], v[216:219], v[52:55]
  buffer_load_dwordx4 v[100:103], v5, s[36:39], s40 offen offset:1024 sc1
  v_mfma_f32_16x16x32_bf16 v[56:59], v[116:119], v[220:223], v[56:59]
  v_mfma_f32_16x16x32_bf16 v[60:63], v[120:123], v[220:223], v[60:63]
  v_mfma_f32_16x16x32_bf16 v[64:67], v[124:127], v[220:223], v[64:67]
  v_mfma_f32_16x16x32_bf16 v[68:71], v[128:131], v[220:223], v[68:71]
  v_mfma_f32_16x16x32_bf16 v[72:75], v[132:135], v[220:223], v[72:75]
  v_mfma_f32_16x16x32_bf16 v[76:79], v[116:119], v[224:227], v[76:79]
  buffer_load_dwordx4 v[104:107], v6, s[36:39], s40 offen offset:1024 sc1
  v_mfma_f32_16x16x32_bf16 v[80:83], v[120:123], v[224:227], v[80:83]
  v_mfma_f32_16x16x32_bf16 v[84:87], v[124:127], v[224:227], v[84:87]
  v_mfma_f32_16x16x32_bf16 v[88:91], v[128:131], v[224:227], v[88:91]
  v_mfma_f32_16x16x32_bf16 v[92:95], v[132:135], v[224:227], v[92:95]
  v_mfma_f32_16x16x32_bf16 v[16:19], v[136:139], v[228:231], v[16:19]
  v_mfma_f32_16x16x32_bf16 v[20:23], v[140:143], v[228:231], v[20:23]
  buffer_load_dwordx4 v[108:111], v12, s[36:39], s41 offen offset:1024 sc1
  v_mfma_f32_16x16x32_bf16 v[24:27], v[144:147], v[228:231], v[24:27]
  v_mfma_f32_16x16x32_bf16 v[28:31], v[148:151], v[228:231], v[28:31]
  v_mfma_f32_16x16x32_bf16 v[32:35], v[152:155], v[228:231], v[32:35]
  v_mfma_f32_16x16x32_bf16 v[36:39], v[136:139], v[232:235], v[36:39]
  v_mfma_f32_16x16x32_bf16 v[40:43], v[140:143], v[232:235], v[40:43]
  v_mfma_f32_16x16x32_bf16 v[44:47], v[144:147], v[232:235], v[44:47]
  buffer_load_dwordx4 v[112:115], v4, s[36:39], s41 offen offset:1024 sc1
  v_mfma_f32_16x16x32_bf16 v[48:51], v[148:151], v[232:235], v[48:51]
  v_mfma_f32_16x16x32_bf16 v[52:55], v[152:155], v[232:235], v[52:55]
  v_mfma_f32_16x16x32_bf16 v[56:59], v[136:139], v[236:239], v[56:59]
  v_mfma_f32_16x16x32_bf16 v[60:63], v[140:143], v[236:239], v[60:63]
  v_mfma_f32_16x16x32_bf16 v[64:67], v[144:147], v[236:239], v[64:67]
  v_mfma_f32_16x16x32_bf16 v[68:71], v[148:151], v[236:239], v[68:71]
  buffer_load_dwordx4 v[208:211], v5, s[36:39], s41 offen offset:1024 sc1
  v_mfma_f32_16x16x32_bf16 v[72:75], v[152:155], v[236:239], v[72:75]
  v_mfma_f32_16x16x32_bf16 v[76:79], v[136:139], v[240:243], v[76:79]
  v_mfma_f32_16x16x32_bf16 v[80:83], v[140:143], v[240:243], v[80:83]
  v_mfma_f32_16x16x32_bf16 v[84:87], v[144:147], v[240:243], v[84:87]
  v_mfma_f32_16x16x32_bf16 v[88:91], v[148:151], v[240:243], v[88:91]
  v_mfma_f32_16x16x32_bf16 v[92:95], v[152:155], v[240:243], v[92:95]
  buffer_load_dwordx4 v[212:215], v6, s[36:39], s41 offen offset:1024 sc1
  v_mfma_f32_16x16x32_bf16 v[16:19], v[156:159], v[244:247], v[16:19]
  v_mfma_f32_16x16x32_bf16 v[20:23], v[160:163], v[244:247], v[20:23]
  v_mfma_f32_16x16x32_bf16 v[24:27], v[164:167], v[244:247], v[24:27]
  v_mfma_f32_16x16x32_bf16 v[28:31], v[168:171], v[244:247], v[28:31]
  v_mfma_f32_16x16x32_bf16 v[32:35], v[172:175], v[244:247], v[32:35]
  v_mfma_f32_16x16x32_bf16 v[36:39], v[156:159], v[248:251], v[36:39]
  buffer_load_dwordx4 v[216:219], v12, s[36:39], s42 offen offset:1024 sc1
  v_mfma_f32_16x16x32_bf16 v[40:43], v[160:163], v[248:251], v[40:43]
  v_mfma_f32_16x16x32_bf16 v[44:47], v[164:167], v[248:251], v[44:47]
  v_mfma_f32_16x16x32_bf16 v[48:51], v[168:171], v[248:251], v[48:51]
  v_mfma_f32_16x16x32_bf16 v[52:55], v[172:175], v[248:251], v[52:55]
  s_waitcnt vmcnt(10)
  v_mfma_f32_16x16x32_bf16 v[56:59], v[156:159], v[196:199], v[56:59]
  buffer_load_dword v254, v1, s[36:39], s19 offen offset:64 sc0 sc1
  v_mfma_f32_16x16x32_bf16 v[60:63], v[160:163], v[196:199], v[60:63]
  buffer_load_dwordx4 v[220:223], v4, s[36:39], s42 offen offset:1024 sc1
  v_mfma_f32_16x16x32_bf16 v[64:67], v[164:167], v[196:199], v[64:67]
  v_mfma_f32_16x16x32_bf16 v[68:71], v[168:171], v[196:199], v[68:71]
  v_mfma_f32_16x16x32_bf16 v[72:75], v[172:175], v[196:199], v[72:75]
  s_waitcnt vmcnt(11)
  v_mfma_f32_16x16x32_bf16 v[76:79], v[156:159], v[200:203], v[76:79]
  v_mfma_f32_16x16x32_bf16 v[80:83], v[160:163], v[200:203], v[80:83]
  v_mfma_f32_16x16x32_bf16 v[84:87], v[164:167], v[200:203], v[84:87]
  buffer_load_dwordx4 v[116:119], v5, s[36:39], s42 offen offset:1024 sc1
  v_mfma_f32_16x16x32_bf16 v[88:91], v[168:171], v[200:203], v[88:91]
  v_mfma_f32_16x16x32_bf16 v[92:95], v[172:175], v[200:203], v[92:95]
  s_waitcnt vmcnt(11)
  v_mfma_f32_16x16x32_bf16 v[16:19], v[176:179], v[204:207], v[16:19]
  ds_read_b128 v[120:123], v8 offset:0
  v_mfma_f32_16x16x32_bf16 v[20:23], v[180:183], v[204:207], v[20:23]
  v_mfma_f32_16x16x32_bf16 v[24:27], v[184:187], v[204:207], v[24:27]
  ds_read_b128 v[124:127], v8 offset:1024
  v_mfma_f32_16x16x32_bf16 v[28:31], v[188:191], v[204:207], v[28:31]
  buffer_load_dwordx4 v[128:131], v6, s[36:39], s42 offen offset:1024 sc1
  v_mfma_f32_16x16x32_bf16 v[32:35], v[192:195], v[204:207], v[32:35]
  ds_read_b128 v[132:135], v8 offset:2048
  s_waitcnt vmcnt(11)
  v_mfma_f32_16x16x32_bf16 v[36:39], v[176:179], v[96:99], v[36:39]
  v_mfma_f32_16x16x32_bf16 v[40:43], v[180:183], v[96:99], v[40:43]
  ds_read_b128 v[224:227], v8 offset:3072
  v_mfma_f32_16x16x32_bf16 v[44:47], v[184:187], v[96:99], v[44:47]
  v_mfma_f32_16x16x32_bf16 v[48:51], v[188:191], v[96:99], v[48:51]
  ds_read_b128 v[228:231], v8 offset:4096
  v_mfma_f32_16x16x32_bf16 v[52:55], v[192:195], v[96:99], v[52:55]
  buffer_load_dwordx4 v[232:235], v12, s[36:39], s43 offen offset:1024 sc1
  s_waitcnt vmcnt(11)
  v_mfma_f32_16x16x32_bf16 v[56:59], v[176:179], v[100:103], v[56:59]
  v_mfma_f32_16x16x32_bf16 v[60:63], v[180:183], v[100:103], v[60:63]
  v_mfma_f32_16x16x32_bf16 v[64:67], v[184:187], v[100:103], v[64:67]
  v_mfma_f32_16x16x32_bf16 v[68:71], v[188:191], v[100:103], v[68:71]
  v_mfma_f32_16x16x32_bf16 v[72:75], v[192:195], v[100:103], v[72:75]
  s_waitcnt vmcnt(10)
  v_mfma_f32_16x16x32_bf16 v[76:79], v[176:179], v[104:107], v[76:79]
  buffer_load_dwordx4 v[236:239], v4, s[36:39], s43 offen offset:1024 sc1
  v_mfma_f32_16x16x32_bf16 v[80:83], v[180:183], v[104:107], v[80:83]
  v_mfma_f32_16x16x32_bf16 v[84:87], v[184:187], v[104:107], v[84:87]
  v_mfma_f32_16x16x32_bf16 v[88:91], v[188:191], v[104:107], v[88:91]
  v_mfma_f32_16x16x32_bf16 v[92:95], v[192:195], v[104:107], v[92:95]
  s_waitcnt vmcnt(10) lgkmcnt(4)
  v_mfma_f32_16x16x32_bf16 v[16:19], v[120:123], v[108:111], v[16:19]
  ds_read_b128 v[136:139], v8 offset:5120
  s_waitcnt lgkmcnt(4)
  v_mfma_f32_16x16x32_bf16 v[20:23], v[124:127], v[108:111], v[20:23]
  buffer_load_dwordx4 v[140:143], v5, s[36:39], s43 offen offset:1024 sc1
  s_waitcnt lgkmcnt(3)
  v_mfma_f32_16x16x32_bf16 v[24:27], v[132:135], v[108:111], v[24:27]
  ds_read_b128 v[144:147], v8 offset:6144
  s_waitcnt lgkmcnt(3)
  v_mfma_f32_16x16x32_bf16 v[28:31], v[224:227], v[108:111], v[28:31]
  s_waitcnt lgkmcnt(2)
  v_mfma_f32_16x16x32_bf16 v[32:35], v[228:231], v[108:111], v[32:35]
  ds_read_b128 v[148:151], v8 offset:7168
  s_waitcnt vmcnt(10)
  v_mfma_f32_16x16x32_bf16 v[36:39], v[120:123], v[112:115], v[36:39]
  v_mfma_f32_16x16x32_bf16 v[40:43], v[124:127], v[112:115], v[40:43]
  ds_read_b128 v[152:155], v8 offset:8192
  v_mfma_f32_16x16x32_bf16 v[44:47], v[132:135], v[112:115], v[44:47]
  buffer_load_dwordx4 v[240:243], v6, s[36:39], s43 offen offset:1024 sc1
  v_mfma_f32_16x16x32_bf16 v[48:51], v[224:227], v[112:115], v[48:51]
  ds_read_b128 v[244:247], v8 offset:9216
  v_mfma_f32_16x16x32_bf16 v[52:55], v[228:231], v[112:115], v[52:55]
  s_waitcnt vmcnt(10)
  v_mfma_f32_16x16x32_bf16 v[56:59], v[120:123], v[208:211], v[56:59]
  v_mfma_f32_16x16x32_bf16 v[60:63], v[124:127], v[208:211], v[60:63]
  buffer_load_dwordx4 v[248:251], v2, s[36:39], s99 offen offset:2048 sc1
  v_mfma_f32_16x16x32_bf16 v[64:67], v[132:135], v[208:211], v[64:67]
  v_mfma_f32_16x16x32_bf16 v[68:71], v[224:227], v[208:211], v[68:71]
  v_mfma_f32_16x16x32_bf16 v[72:75], v[228:231], v[208:211], v[72:75]
  s_waitcnt vmcnt(10)
  v_mfma_f32_16x16x32_bf16 v[76:79], v[120:123], v[212:215], v[76:79]
  buffer_load_dwordx4 v[196:199], v2, s[36:39], s99 offen offset:3072 sc1
  v_mfma_f32_16x16x32_bf16 v[80:83], v[124:127], v[212:215], v[80:83]
  v_mfma_f32_16x16x32_bf16 v[84:87], v[132:135], v[212:215], v[84:87]
  v_mfma_f32_16x16x32_bf16 v[88:91], v[224:227], v[212:215], v[88:91]
  v_mfma_f32_16x16x32_bf16 v[92:95], v[228:231], v[212:215], v[92:95]
  buffer_load_dwordx4 v[156:159], v3, s[36:39], s99 offen offset:0 sc1
  s_waitcnt vmcnt(11) lgkmcnt(4)
  v_mfma_f32_16x16x32_bf16 v[16:19], v[136:139], v[216:219], v[16:19]
  ds_read_b128 v[160:163], v8 offset:10240
  s_waitcnt lgkmcnt(4)
  v_mfma_f32_16x16x32_bf16 v[20:23], v[144:147], v[216:219], v[20:23]
  s_waitcnt lgkmcnt(3)
  v_mfma_f32_16x16x32_bf16 v[24:27], v[148:151], v[216:219], v[24:27]
  ds_read_b128 v[164:167], v8 offset:11264
  s_waitcnt lgkmcnt(3)
  v_mfma_f32_16x16x32_bf16 v[28:31], v[152:155], v[216:219], v[28:31]
  s_waitcnt vmcnt(10)
  v_cmp_ne_u32 vcc, 1, v254
  s_nop 4
  s_cbranch_vccz K5_goc
  s_mov_b32 s21, 0x10000
K5_pollc:
  buffer_load_dword v254, v1, s[36:39], s19 offen offset:64 sc0 sc1
  s_sub_u32 s21, s21, 1
  s_waitcnt vmcnt(0)
  v_cmp_ne_u32 vcc, 1, v254
  s_cmp_eq_u32 s21, 0
  s_cbranch_scc1 K5_goc
  s_nop 3
  s_cbranch_vccnz K5_pollc
K5_goc:
  buffer_load_dwordx4 v[168:171], v12, s[36:39], s40 offen offset:2048 sc1
  s_waitcnt lgkmcnt(2)
  v_mfma_f32_16x16x32_bf16 v[32:35], v[244:247], v[216:219], v[32:35]
  ds_read_b128 v[172:175], v8 offset:12288
  s_waitcnt vmcnt(10)
  v_mfma_f32_16x16x32_bf16 v[36:39], v[136:139], v[220:223], v[36:39]
  v_mfma_f32_16x16x32_bf16 v[40:43], v[144:147], v[220:223], v[40:43]
  ds_read_b128 v[200:203], v8 offset:13312
  v_mfma_f32_16x16x32_bf16 v[44:47], v[148:151], v[220:223], v[44:47]
  buffer_load_dwordx4 v[204:207], v4, s[36:39], s40 offen offset:2048 sc1
  v_mfma_f32_16x16x32_bf16 v[48:51], v[152:155], v[220:223], v[48:51]
  ds_read_b128 v[96:99], v8 offset:14336
  v_mfma_f32_16x16x32_bf16 v[52:55], v[244:247], v[220:223], v[52:55]
  s_waitcnt vmcnt(10)
  v_mfma_f32_16x16x32_bf16 v[56:59], v[136:139], v[116:119], v[56:59]
  v_mfma_f32_16x16x32_bf16 v[60:63], v[144:147], v[116:119], v[60:63]
  buffer_load_dwordx4 v[100:103], v5, s[36:39], s40 offen offset:2048 sc1
  v_mfma_f32_16x16x32_bf16 v[64:67], v[148:151], v[116:119], v[64:67]
  v_mfma_f32_16x16x32_bf16 v[68:71], v[152:155], v[116:119], v[68:71]
  v_mfma_f32_16x16x32_bf16 v[72:75], v[244:247], v[116:119], v[72:75]
  s_waitcnt vmcnt(10)
  v_mfma_f32_16x16x32_bf16 v[76:79], v[136:139], v[128:131], v[76:79]
  buffer_load_dwordx4 v[176:179], v6, s[36:39], s40 offen offset:2048 sc1
  v_mfma_f32_16x16x32_bf16 v[80:83], v[144:147], v[128:131], v[80:83]
  v_mfma_f32_16x16x32_bf16 v[84:87], v[148:151], v[128:131], v[84:87]
  v_mfma_f32_16x16x32_bf16 v[88:91], v[152:155], v[128:131], v[88:91]
  v_mfma_f32_16x16x32_bf16 v[92:95], v[244:247], v[128:131], v[92:95]
  buffer_load_dwordx4 v[180:183], v12, s[36:39], s41 offen offset:2048 sc1
  s_waitcnt vmcnt(11) lgkmcnt(4)
  v_mfma_f32_16x16x32_bf16 v[16:19], v[160:163], v[232:235], v[16:19]
  ds_read_b128 v[184:187], v8 offset:15360
  s_waitcnt lgkmcnt(4)
  v_mfma_f32_16x16x32_bf16 v[20:23], v[164:167], v[232:235], v[20:23]
  s_waitcnt lgkmcnt(3)
  v_mfma_f32_16x16x32_bf16 v[24:27], v[172:175], v[232:235], v[24:27]
  ds_read_b128 v[188:191], v8 offset:16384
  s_waitcnt lgkmcnt(3)
  v_mfma_f32_16x16x32_bf16 v[28:31], v[200:203], v[232:235], v[28:31]
  buffer_load_dwordx4 v[192:195], v4, s[36:39], s41 offen offset:2048 sc1
  s_waitcnt lgkmcnt(2)
  v_mfma_f32_16x16x32_bf16 v[32:35], v[96:99], v[232:235], v[32:35]
  ds_read_b128 v[104:107], v8 offset:17408
  s_waitcnt vmcnt(11)
  v_mfma_f32_16x16x32_bf16 v[36:39], v[160:163], v[236:239], v[36:39]
  v_mfma_f32_16x16x32_bf16 v[40:43], v[164:167], v[236:239], v[40:43]
  ds_read_b128 v[108:111], v8 offset:18432
  v_mfma_f32_16x16x32_bf16 v[44:47], v[172:175], v[236:239], v[44:47]
  buffer_load_dwordx4 v[112:115], v5, s[36:39], s41 offen offset:2048 sc1
  v_mfma_f32_16x16x32_bf16 v[48:51], v[200:203], v[236:239], v[48:51]
  ds_read_b128 v[208:211], v8 offset:19456
  v_mfma_f32_16x16x32_bf16 v[52:55], v[96:99], v[236:239], v[52:55]
  s_waitcnt vmcnt(11)
  v_mfma_f32_16x16x32_bf16 v[56:59], v[160:163], v[140:143], v[56:59]
  v_mfma_f32_16x16x32_bf16 v[60:63], v[164:167], v[140:143], v[60:63]
  buffer_load_dwordx4 v[120:123], v6, s[36:39], s41 offen offset:2048 sc1
  v_mfma_f32_16x16x32_bf16 v[64:67], v[172:175], v[140:143], v[64:67]
  v_mfma_f32_16x16x32_bf16 v[68:71], v[200:203], v[140:143], v[68:71]
  v_mfma_f32_16x16x32_bf16 v[72:75], v[96:99], v[140:143], v[72:75]
  s_waitcnt vmcnt(11)
  v_mfma_f32_16x16x32_bf16 v[76:79], v[160:163], v[240:243], v[76:79]
  buffer_load_dwordx4 v[124:127], v12, s[36:39], s42 offen offset:2048 sc1
  v_mfma_f32_16x16x32_bf16 v[80:83], v[164:167], v[240:243], v[80:83]
  v_mfma_f32_16x16x32_bf16 v[84:87], v[172:175], v[240:243], v[84:87]
  v_mfma_f32_16x16x32_bf16 v[88:91], v[200:203], v[240:243], v[88:91]
  v_mfma_f32_16x16x32_bf16 v[92:95], v[96:99], v[240:243], v[92:95]
  buffer_load_dwordx4 v[132:135], v4, s[36:39], s42 offen offset:2048 sc1
  s_waitcnt vmcnt(9) lgkmcnt(4)
  v_mfma_f32_16x16x32_bf16 v[16:19], v[184:187], v[168:171], v[16:19]
  ds_read_b128 v[224:227], v11 offset:36864
  s_waitcnt lgkmcnt(4)
  v_mfma_f32_16x16x32_bf16 v[20:23], v[188:191], v[168:171], v[20:23]
  s_waitcnt lgkmcnt(3)
  v_mfma_f32_16x16x32_bf16 v[24:27], v[104:107], v[168:171], v[24:27]
  ds_read_b128 v[228:231], v11 offset:37888
  s_waitcnt lgkmcnt(3)
  v_mfma_f32_16x16x32_bf16 v[28:31], v[108:111], v[168:171], v[28:31]
  buffer_load_dwordx4 v[212:215], v5, s[36:39], s42 offen offset:2048 sc1
  s_waitcnt lgkmcnt(2)
  v_mfma_f32_16x16x32_bf16 v[32:35], v[208:211], v[168:171], v[32:35]
  ds_read_b128 v[216:219], v11 offset:38912
  s_waitcnt vmcnt(9)
  v_mfma_f32_16x16x32_bf16 v[36:39], v[184:187], v[204:207], v[36:39]
  v_mfma_f32_16x16x32_bf16 v[40:43], v[188:191], v[204:207], v[40:43]
  ds_read_b128 v[220:223], v11 offset:49152
  v_mfma_f32_16x16x32_bf16 v[44:47], v[104:107], v[204:207], v[44:47]
  buffer_load_dwordx4 v[116:119], v6, s[36:39], s42 offen offset:2048 sc1
  v_mfma_f32_16x16x32_bf16 v[48:51], v[108:111], v[204:207], v[48:51]
  ds_read_b128 v[136:139], v11 offset:50176
  v_mfma_f32_16x16x32_bf16 v[52:55], v[208:211], v[204:207], v[52:55]
  s_waitcnt vmcnt(9)
  v_mfma_f32_16x16x32_bf16 v[56:59], v[184:187], v[100:103], v[56:59]
  v_mfma_f32_16x16x32_bf16 v[60:63], v[188:191], v[100:103], v[60:63]
  buffer_load_dwordx4 v[144:147], v12, s[36:39], s43 offen offset:2048 sc1
  v_mfma_f32_16x16x32_bf16 v[64:67], v[104:107], v[100:103], v[64:67]
  v_mfma_f32_16x16x32_bf16 v[68:71], v[108:111], v[100:103], v[68:71]
  v_mfma_f32_16x16x32_bf16 v[72:75], v[208:211], v[100:103], v[72:75]
  s_waitcnt vmcnt(9)
  v_mfma_f32_16x16x32_bf16 v[76:79], v[184:187], v[176:179], v[76:79]
  buffer_load_dwordx4 v[148:151], v4, s[36:39], s43 offen offset:2048 sc1
  v_mfma_f32_16x16x32_bf16 v[80:83], v[188:191], v[176:179], v[80:83]
  v_mfma_f32_16x16x32_bf16 v[84:87], v[104:107], v[176:179], v[84:87]
  v_mfma_f32_16x16x32_bf16 v[88:91], v[108:111], v[176:179], v[88:91]
  v_mfma_f32_16x16x32_bf16 v[92:95], v[208:211], v[176:179], v[92:95]
  buffer_load_dwordx4 v[152:155], v5, s[36:39], s43 offen offset:2048 sc1
  s_waitcnt vmcnt(10) lgkmcnt(4)
  v_mfma_f32_16x16x32_bf16 v[16:19], v[224:227], v[180:183], v[16:19]
  ds_read_b128 v[244:247], v11 offset:51200
  s_waitcnt lgkmcnt(4)
  v_mfma_f32_16x16x32_bf16 v[20:23], v[228:231], v[180:183], v[20:23]
  s_waitcnt lgkmcnt(3)
  v_mfma_f32_16x16x32_bf16 v[24:27], v[216:219], v[180:183], v[24:27]
  ds_read_b128 v[128:131], v11 offset:61440
  s_waitcnt lgkmcnt(3)
  v_mfma_f32_16x16x32_bf16 v[28:31], v[220:223], v[180:183], v[28:31]
  buffer_load_dwordx4 v[232:235], v6, s[36:39], s43 offen offset:2048 sc1
  s_waitcnt lgkmcnt(2)
  v_mfma_f32_16x16x32_bf16 v[32:35], v[136:139], v[180:183], v[32:35]
  ds_read_b128 v[236:239], v11 offset:62464
  s_waitcnt vmcnt(10)
  v_mfma_f32_16x16x32_bf16 v[36:39], v[224:227], v[192:195], v[36:39]
  v_mfma_f32_16x16x32_bf16 v[40:43], v[228:231], v[192:195], v[40:43]
  ds_read_b128 v[140:143], v11 offset:63488
  s_barrier
  v_mfma_f32_16x16x32_bf16 v[44:47], v[216:219], v[192:195], v[44:47]
  v_mfma_f32_16x16x32_bf16 v[48:51], v[220:223], v[192:195], v[48:51]
  ds_read_b128 v[160:163], v11 offset:0
  v_mfma_f32_16x16x32_bf16 v[52:55], v[136:139], v[192:195], v[52:55]
  s_waitcnt vmcnt(9)
  v_mfma_f32_16x16x32_bf16 v[56:59], v[224:227], v[112:115], v[56:59]
  ds_read_b128 v[164:167], v11 offset:1024
  v_mfma_f32_16x16x32_bf16 v[60:63], v[228:231], v[112:115], v[60:63]
  v_mfma_f32_16x16x32_bf16 v[64:67], v[216:219], v[112:115], v[64:67]
  ds_read_b128 v[172:175], v11 offset:2048
  v_mfma_f32_16x16x32_bf16 v[68:71], v[220:223], v[112:115], v[68:71]
  v_mfma_f32_16x16x32_bf16 v[72:75], v[136:139], v[112:115], v[72:75]
  s_waitcnt vmcnt(8)
  v_mfma_f32_16x16x32_bf16 v[76:79], v[224:227], v[120:123], v[76:79]
  v_mfma_f32_16x16x32_bf16 v[80:83], v[228:231], v[120:123], v[80:83]
  v_mfma_f32_16x16x32_bf16 v[84:87], v[216:219], v[120:123], v[84:87]
  v_mfma_f32_16x16x32_bf16 v[88:91], v[220:223], v[120:123], v[88:91]
  v_mfma_f32_16x16x32_bf16 v[92:95], v[136:139], v[120:123], v[92:95]
  s_waitcnt vmcnt(7) lgkmcnt(6)
  v_mfma_f32_16x16x32_bf16 v[16:19], v[244:247], v[124:127], v[16:19]
  v_add_u32 v252, 0, v0
  v_mul_u32_u24 v253, 205, v252
  v_lshrrev_b32 v253, 11, v253
  v_mul_u32_u24 v255, 10, v253
  v_sub_u32 v255, v252, v255
  v_mul_u32_u24 v200, 176, v253
  v_lshl_add_u32 v200, v255, 4, v200
  v_add_u32 v200, s17, v200
  v_mul_u32_u24 v201, 40960, v253
  v_lshl_add_u32 v201, v255, 4, v201
  v_add_u32 v252, 64, v0
  v_mul_u32_u24 v253, 205, v252
  v_lshrrev_b32 v253, 11, v253
  v_mul_u32_u24 v255, 10, v253
  v_sub_u32 v255, v252, v255
  v_mul_u32_u24 v202, 176, v253
  v_lshl_add_u32 v202, v255, 4, v202
  v_add_u32 v202, s17, v202
  v_mul_u32_u24 v203, 40960, v253
  v_lshl_add_u32 v203, v255, 4, v203
  v_add_u32 v252, 128, v0
  v_mul_u32_u24 v253, 205, v252
  v_lshrrev_b32 v253, 11, v253
  v_mul_u32_u24 v255, 10, v253
  v_sub_u32 v255, v252, v255
  v_mul_u32_u24 v96, 176, v253
  v_lshl_add_u32 v96, v255, 4, v96
  v_add_u32 v96, s17, v96
  v_mul_u32_u24 v97, 40960, v253
  v_lshl_add_u32 v97, v255, 4, v97
  s_waitcnt lgkmcnt(5)
  v_mfma_f32_16x16x32_bf16 v[20:23], v[128:131], v[124:127], v[20:23]
  s_waitcnt lgkmcnt(4)
  v_mfma_f32_16x16x32_bf16 v[24:27], v[236:239], v[124:127], v[24:27]
  s_waitcnt lgkmcnt(3)
  v_mfma_f32_16x16x32_bf16 v[28:31], v[140:143], v[124:127], v[28:31]
  s_waitcnt lgkmcnt(2)
  v_mfma_f32_16x16x32_bf16 v[32:35], v[160:163], v[124:127], v[32:35]
  v_lshrrev_b32 v252, 4, v0
  v_lshlrev_b32 v252, 4, v252
  s_mul_i32 s21, s5, 320
  s_add_u32 s21, s21, 20992
  buffer_load_dwordx2 v[242:243], v10, s[36:39], s14 offen offset:0 sc1
  s_waitcnt vmcnt(4) lgkmcnt(1)
  v_mfma_f32_16x16x32_bf16 v[16:19], v[164:167], v[144:147], v[16:19]
  s_waitcnt lgkmcnt(0)
  v_mfma_f32_16x16x32_bf16 v[20:23], v[172:175], v[144:147], v[20:23]
  buffer_load_dwordx4 v[168:171], v252, s[36:39], s21 offen offset:0 sc1
  v_mfma_f32_16x16x32_bf16 v[24:27], v[248:251], v[144:147], v[24:27]
  v_mfma_f32_16x16x32_bf16 v[28:31], v[196:199], v[144:147], v[28:31]
  buffer_load_dwordx2 v[206:207], v10, s[36:39], s14 offen offset:1024 sc1
  v_mfma_f32_16x16x32_bf16 v[32:35], v[156:159], v[144:147], v[32:35]
  v_mfma_f32_16x16x32_bf16 v[36:39], v[244:247], v[132:135], v[36:39]
  buffer_load_dwordx4 v[100:103], v252, s[36:39], s21 offen offset:64 sc1
  v_mfma_f32_16x16x32_bf16 v[40:43], v[128:131], v[132:135], v[40:43]
  ds_write_b128 v13, v[16:19] offset:0
  v_mfma_f32_16x16x32_bf16 v[44:47], v[236:239], v[132:135], v[44:47]
  buffer_load_dwordx2 v[186:187], v10, s[36:39], s14 offen offset:2048 sc1
  v_mfma_f32_16x16x32_bf16 v[48:51], v[140:143], v[132:135], v[48:51]
  ds_write_b128 v13, v[20:23] offset:1024
  v_mfma_f32_16x16x32_bf16 v[52:55], v[160:163], v[132:135], v[52:55]
  buffer_load_dwordx4 v[188:191], v252, s[36:39], s21 offen offset:128 sc1
  s_waitcnt vmcnt(8)
  v_mfma_f32_16x16x32_bf16 v[36:39], v[164:167], v[148:151], v[36:39]
  ds_write_b128 v13, v[24:27] offset:2048
  v_mfma_f32_16x16x32_bf16 v[40:43], v[172:175], v[148:151], v[40:43]
  buffer_load_dwordx2 v[106:107], v10, s[36:39], s14 offen offset:3072 sc1
  v_mfma_f32_16x16x32_bf16 v[44:47], v[248:251], v[148:151], v[44:47]
  ds_write_b128 v13, v[28:31] offset:3072
  v_mfma_f32_16x16x32_bf16 v[48:51], v[196:199], v[148:151], v[48:51]
  buffer_load_dwordx4 v[108:111], v252, s[36:39], s21 offen offset:192 sc1
  v_mfma_f32_16x16x32_bf16 v[52:55], v[156:159], v[148:151], v[52:55]
  ds_write_b128 v13, v[32:35] offset:4096
  v_mfma_f32_16x16x32_bf16 v[56:59], v[244:247], v[212:215], v[56:59]
  buffer_load_dwordx2 v[210:211], v10, s[36:39], s15 offen offset:0 sc1
  v_mfma_f32_16x16x32_bf16 v[60:63], v[128:131], v[212:215], v[60:63]
  ds_write_b128 v14, v[36:39] offset:0
  v_mfma_f32_16x16x32_bf16 v[64:67], v[236:239], v[212:215], v[64:67]
  buffer_load_dwordx4 v[176:179], v252, s[36:39], s21 offen offset:256 sc1
  v_mfma_f32_16x16x32_bf16 v[68:71], v[140:143], v[212:215], v[68:71]
  ds_write_b128 v14, v[40:43] offset:1024
  v_mfma_f32_16x16x32_bf16 v[72:75], v[160:163], v[212:215], v[72:75]
  s_waitcnt vmcnt(11)
  v_mfma_f32_16x16x32_bf16 v[56:59], v[164:167], v[152:155], v[56:59]
  ds_write_b128 v14, v[44:47] offset:2048
  v_mfma_f32_16x16x32_bf16 v[60:63], v[172:175], v[152:155], v[60:63]
  v_mfma_f32_16x16x32_bf16 v[64:67], v[248:251], v[152:155], v[64:67]
  ds_write_b128 v14, v[48:51] offset:3072
  v_mfma_f32_16x16x32_bf16 v[68:71], v[196:199], v[152:155], v[68:71]
  v_mfma_f32_16x16x32_bf16 v[72:75], v[156:159], v[152:155], v[72:75]
  ds_write_b128 v14, v[52:55] offset:4096
  v_mfma_f32_16x16x32_bf16 v[76:79], v[244:247], v[116:119], v[76:79]
  v_mfma_f32_16x16x32_bf16 v[80:83], v[128:131], v[116:119], v[80:83]
  ds_write_b128 v15, v[56:59] offset:0
  v_mfma_f32_16x16x32_bf16 v[84:87], v[236:239], v[116:119], v[84:87]
  v_mfma_f32_16x16x32_bf16 v[88:91], v[140:143], v[116:119], v[88:91]
  ds_write_b128 v15, v[60:63] offset:1024
  v_mfma_f32_16x16x32_bf16 v[92:95], v[160:163], v[116:119], v[92:95]
  s_waitcnt vmcnt(10)
  v_mfma_f32_16x16x32_bf16 v[76:79], v[164:167], v[232:235], v[76:79]
  ds_write_b128 v15, v[64:67] offset:2048
  v_mfma_f32_16x16x32_bf16 v[80:83], v[172:175], v[232:235], v[80:83]
  v_mfma_f32_16x16x32_bf16 v[84:87], v[248:251], v[232:235], v[84:87]
  ds_write_b128 v15, v[68:71] offset:3072
  v_mfma_f32_16x16x32_bf16 v[88:91], v[196:199], v[232:235], v[88:91]
  v_mfma_f32_16x16x32_bf16 v[92:95], v[156:159], v[232:235], v[92:95]
  ds_write_b128 v15, v[72:75] offset:4096
  s_waitcnt vmcnt(9)
  v_lshlrev_b32 v240, 16, v242
  v_and_b32 v241, s18, v242
  v_lshlrev_b32 v242, 16, v243
  v_and_b32 v243, s18, v243
  s_waitcnt vmcnt(7)
  v_lshlrev_b32 v204, 16, v206
  v_and_b32 v205, s18, v206
  v_lshlrev_b32 v206, 16, v207
  v_and_b32 v207, s18, v207
  s_waitcnt vmcnt(5)
  v_lshlrev_b32 v184, 16, v186
  v_and_b32 v185, s18, v186
  v_lshlrev_b32 v186, 16, v187
  v_and_b32 v187, s18, v187
  s_waitcnt vmcnt(3)
  v_lshlrev_b32 v104, 16, v106
  v_and_b32 v105, s18, v106
  v_lshlrev_b32 v106, 16, v107
  v_and_b32 v107, s18, v107
  s_waitcnt vmcnt(1)
  v_lshlrev_b32 v208, 16, v210
  v_and_b32 v209, s18, v210
  v_lshlrev_b32 v210, 16, v211
  v_and_b32 v211, s18, v211
  s_waitcnt lgkmcnt(0)
  s_barrier
  ds_read_b128 v[16:19], v9 offset:0
  ds_read_b128 v[36:39], v9 offset:5120
  ds_read_b128 v[56:59], v9 offset:10240
  ds_read_b128 v[20:23], v9 offset:1024
  ds_read_b128 v[40:43], v9 offset:6144
  ds_read_b128 v[60:63], v9 offset:11264
  ds_read_b128 v[24:27], v9 offset:2048
  ds_read_b128 v[44:47], v9 offset:7168
  ds_read_b128 v[64:67], v9 offset:12288
  ds_read_b128 v[28:31], v9 offset:3072
  ds_read_b128 v[48:51], v9 offset:8192
  ds_read_b128 v[68:71], v9 offset:13312
  ds_read_b128 v[32:35], v9 offset:4096
  ds_read_b128 v[52:55], v9 offset:9216
  ds_read_b128 v[72:75], v9 offset:14336
  s_waitcnt lgkmcnt(14)
  v_pk_add_f32 v[76:77], v[76:77], v[16:17]
  s_waitcnt lgkmcnt(12)
  v_pk_add_f32 v[36:37], v[36:37], v[56:57]
  v_pk_add_f32 v[78:79], v[78:79], v[18:19]
  v_pk_add_f32 v[38:39], v[38:39], v[58:59]
  v_pk_add_f32 v[76:77], v[76:77], v[36:37]
  v_pk_add_f32 v[78:79], v[78:79], v[38:39]
  v_pk_fma_f32 v[76:77], v[76:77], v[168:169], v[240:241]
  v_pk_fma_f32 v[78:79], v[78:79], v[170:171], v[242:243]
  v_cvt_pk_bf16_f32 v16, v76, v77
  v_cvt_pk_bf16_f32 v17, v78, v79
  ds_write_b64 v7, v[16:17] offset:0
  s_waitcnt lgkmcnt(12)
  v_pk_add_f32 v[80:81], v[80:81], v[20:21]
  s_waitcnt lgkmcnt(10)
  v_pk_add_f32 v[40:41], v[40:41], v[60:61]
  v_pk_add_f32 v[82:83], v[82:83], v[22:23]
  v_pk_add_f32 v[42:43], v[42:43], v[62:63]
  v_pk_add_f32 v[80:81], v[80:81], v[40:41]
  v_pk_add_f32 v[82:83], v[82:83], v[42:43]
  v_pk_fma_f32 v[80:81], v[80:81], v[100:101], v[204:205]
  v_pk_fma_f32 v[82:83], v[82:83], v[102:103], v[206:207]
  v_cvt_pk_bf16_f32 v20, v80, v81
  v_cvt_pk_bf16_f32 v21, v82, v83
  ds_write_b64 v7, v[20:21] offset:32
  s_waitcnt lgkmcnt(10)
  v_pk_add_f32 v[84:85], v[84:85], v[24:25]
  s_waitcnt lgkmcnt(8)
  v_pk_add_f32 v[44:45], v[44:45], v[64:65]
  v_pk_add_f32 v[86:87], v[86:87], v[26:27]
  v_pk_add_f32 v[46:47], v[46:47], v[66:67]
  v_pk_add_f32 v[84:85], v[84:85], v[44:45]
  v_pk_add_f32 v[86:87], v[86:87], v[46:47]
  v_pk_fma_f32 v[84:85], v[84:85], v[188:189], v[184:185]
  v_pk_fma_f32 v[86:87], v[86:87], v[190:191], v[186:187]
  v_cvt_pk_bf16_f32 v24, v84, v85
  v_cvt_pk_bf16_f32 v25, v86, v87
  ds_write_b64 v7, v[24:25] offset:64
  s_waitcnt lgkmcnt(8)
  v_pk_add_f32 v[88:89], v[88:89], v[28:29]
  s_waitcnt lgkmcnt(6)
  v_pk_add_f32 v[48:49], v[48:49], v[68:69]
  v_pk_add_f32 v[90:91], v[90:91], v[30:31]
  v_pk_add_f32 v[50:51], v[50:51], v[70:71]
  v_pk_add_f32 v[88:89], v[88:89], v[48:49]
  v_pk_add_f32 v[90:91], v[90:91], v[50:51]
  v_pk_fma_f32 v[88:89], v[88:89], v[108:109], v[104:105]
  v_pk_fma_f32 v[90:91], v[90:91], v[110:111], v[106:107]
  v_cvt_pk_bf16_f32 v28, v88, v89
  v_cvt_pk_bf16_f32 v29, v90, v91
  ds_write_b64 v7, v[28:29] offset:96
  s_waitcnt lgkmcnt(6)
  v_pk_add_f32 v[92:93], v[92:93], v[32:33]
  s_waitcnt lgkmcnt(4)
  v_pk_add_f32 v[52:53], v[52:53], v[72:73]
  v_pk_add_f32 v[94:95], v[94:95], v[34:35]
  v_pk_add_f32 v[54:55], v[54:55], v[74:75]
  v_pk_add_f32 v[92:93], v[92:93], v[52:53]
  v_pk_add_f32 v[94:95], v[94:95], v[54:55]
  s_waitcnt vmcnt(0)
  v_pk_fma_f32 v[92:93], v[92:93], v[176:177], v[208:209]
  v_pk_fma_f32 v[94:95], v[94:95], v[178:179], v[210:211]
  v_cvt_pk_bf16_f32 v32, v92, v93
  v_cvt_pk_bf16_f32 v33, v94, v95
  ds_write_b64 v7, v[32:33] offset:128
  v_cmp_gt_u32 vcc, 32, v0
  ds_read_b128 v[36:39], v200
  ds_read_b128 v[40:43], v202
  s_mov_b64 exec, vcc
  ds_read_b128 v[44:47], v96
  s_mov_b64 exec, -1
  s_waitcnt lgkmcnt(2)
  buffer_store_dwordx4 v[36:39], v201, s[32:35], s16 offen
  s_waitcnt lgkmcnt(1)
  buffer_store_dwordx4 v[40:43], v203, s[32:35], s16 offen
  s_mov_b64 exec, vcc
  s_waitcnt lgkmcnt(0)
  buffer_store_dwordx4 v[44:47], v97, s[32:35], s16 offen
  s_endpgm
K4_compute:
  s_setprio 3
  v_and_b32 v248, 15, v0
  v_lshrrev_b32 v249, 4, v0
  v_bfe_u32 v250, v0, 4, 1
  v_lshrrev_b32 v251, 5, v0
  v_lshlrev_b32 v5, 4, v248
  v_lshl_add_u32 v3, v250, 9, v5
  v_lshl_add_u32 v3, v251, 11, v3
  v_add_u32 v4, 49152, v3
  v_mul_u32_u24 v6, 49152, v250
  v_lshl_add_u32 v6, v251, 8, v6
  v_add_u32 v6, v6, v5
  v_lshl_add_u32 v5, v249, 9, v5
  s_lshl_b32 s8, s4, 2
  s_add_u32 s8, s8, s3
  s_mul_i32 s6, s8, 40960
  s_add_u32 s6, s6, 6070272
  s_lshl_b32 s9, s8, 8
  s_add_u32 s9, s9, 8691712
  v_and_b32 v7, 31, v0
  v_lshlrev_b32 v7, 3, v7
  s_mul_i32 s10, s8, 98304
  s_mul_i32 s11, s5, 3072
  s_add_u32 s10, s10, s11
  s_add_u32 s10, s10, 15441920
  s_lshr_b32 s12, s8, 1
  s_lshl_b32 s12, s12, 2
  s_lshr_b32 s13, s5, 2
  s_add_u32 s12, s12, s13
  s_lshl_b32 s12, s12, 7
  s_and_b32 s13, s5, 3
  s_lshl_b32 s13, s13, 1
  s_and_b32 s14, s3, 1
  s_add_u32 s13, s13, s14
  s_lshl_b32 s13, s13, 2
  s_add_u32 s12, s12, s13
  s_add_u32 s12, s12, 21733376
  s_lshr_b32 s24, s8, 1
  s_lshl_b32 s24, s24, 2
  s_lshr_b32 s25, s5, 2
  s_add_u32 s24, s24, s25
  s_lshl_b32 s24, s24, 7
  s_add_u32 s24, s24, 21749760
  v_min_u32 v252, 4, v0
  v_lshlrev_b32 v252, 2, v252
  v_mov_b32 v255, v252
  s_mov_b32 s21, 0x10000
  s_nop 1
SP_x:
  buffer_load_dword v253, v252, s[36:39], s24 offen offset:0 sc0 sc1
  s_sub_u32 s21, s21, 1
  s_waitcnt vmcnt(0)
  v_cmp_ne_u32 vcc, 1, v253
  s_cmp_eq_u32 s21, 0
  s_cbranch_scc1 SG_x
  s_nop 3
  s_cbranch_vccnz SP_x
SG_x:
  buffer_load_dwordx4 v[8:11], v5, s[36:39], s6 offen offset:0 sc1
  buffer_load_dwordx4 v[12:15], v5, s[36:39], s6 offen offset:256 sc1
  buffer_load_dwordx4 v[16:19], v5, s[36:39], s6 offen offset:2048 sc1
  buffer_load_dwordx4 v[20:23], v5, s[36:39], s6 offen offset:2304 sc1
  s_add_u32 s6, s6, 4096
  buffer_load_dwordx4 v[24:27], v5, s[36:39], s6 offen offset:0 sc1
  buffer_load_dwordx4 v[28:31], v5, s[36:39], s6 offen offset:256 sc1
  buffer_load_dwordx4 v[32:35], v5, s[36:39], s6 offen offset:2048 sc1
  buffer_load_dwordx4 v[36:39], v5, s[36:39], s6 offen offset:2304 sc1
  s_add_u32 s6, s6, 4096
  buffer_load_dwordx4 v[40:43], v5, s[36:39], s6 offen offset:0 sc1
  buffer_load_dwordx4 v[44:47], v5, s[36:39], s6 offen offset:256 sc1
  s_barrier
  ds_read_b128 v[208:211], v3 offset:0
  ds_read_b128 v[212:215], v3 offset:256
  ds_read_b128 v[216:219], v3 offset:1024
  ds_read_b128 v[220:223], v3 offset:1280
  ds_read_b128 v[224:227], v3 offset:4096
  ds_read_b128 v[228:231], v3 offset:4352
  ds_read_b128 v[232:235], v3 offset:5120
  ds_read_b128 v[236:239], v3 offset:5376
  ds_read_b128 v[240:243], v3 offset:8192
  ds_read_b128 v[244:247], v3 offset:8448
  s_waitcnt vmcnt(9) lgkmcnt(9)
  v_mfma_f32_16x16x32_bf16 v[176:179], v[208:211], v[8:11], 0
  buffer_load_dwordx4 v[48:51], v5, s[36:39], s6 offen offset:2048 sc1
  s_waitcnt vmcnt(9)
  v_mfma_f32_16x16x32_bf16 v[192:195], v[208:211], v[12:15], 0
  ds_read_b128 v[208:211], v3 offset:9216
  s_waitcnt lgkmcnt(9)
  v_mfma_f32_16x16x32_bf16 v[180:183], v[212:215], v[8:11], 0
  v_mfma_f32_16x16x32_bf16 v[196:199], v[212:215], v[12:15], 0
  ds_read_b128 v[212:215], v3 offset:9472
  s_waitcnt lgkmcnt(9)
  v_mfma_f32_16x16x32_bf16 v[184:187], v[216:219], v[8:11], 0
  buffer_load_dwordx4 v[52:55], v5, s[36:39], s6 offen offset:2304 sc1
  s_add_u32 s6, s6, 4096
  v_mfma_f32_16x16x32_bf16 v[200:203], v[216:219], v[12:15], 0
  s_barrier
  ds_read_b128 v[216:219], v3 offset:12288
  s_waitcnt lgkmcnt(9)
  v_mfma_f32_16x16x32_bf16 v[188:191], v[220:223], v[8:11], 0
  v_mfma_f32_16x16x32_bf16 v[204:207], v[220:223], v[12:15], 0
  ds_read_b128 v[220:223], v3 offset:12544
  s_waitcnt vmcnt(9) lgkmcnt(9)
  v_mfma_f32_16x16x32_bf16 v[176:179], v[224:227], v[16:19], v[176:179]
  buffer_load_dwordx4 v[56:59], v5, s[36:39], s6 offen offset:0 sc1
  s_waitcnt vmcnt(9)
  v_mfma_f32_16x16x32_bf16 v[192:195], v[224:227], v[20:23], v[192:195]
  ds_read_b128 v[224:227], v3 offset:13312
  s_waitcnt lgkmcnt(9)
  v_mfma_f32_16x16x32_bf16 v[180:183], v[228:231], v[16:19], v[180:183]
  v_mfma_f32_16x16x32_bf16 v[196:199], v[228:231], v[20:23], v[196:199]
  ds_read_b128 v[228:231], v3 offset:13568
  s_waitcnt lgkmcnt(9)
  v_mfma_f32_16x16x32_bf16 v[184:187], v[232:235], v[16:19], v[184:187]
  buffer_load_dwordx4 v[60:63], v5, s[36:39], s6 offen offset:256 sc1
  v_mfma_f32_16x16x32_bf16 v[200:203], v[232:235], v[20:23], v[200:203]
  ds_read_b128 v[232:235], v3 offset:16384
  s_waitcnt lgkmcnt(9)
  v_mfma_f32_16x16x32_bf16 v[188:191], v[236:239], v[16:19], v[188:191]
  v_mfma_f32_16x16x32_bf16 v[204:207], v[236:239], v[20:23], v[204:207]
  ds_read_b128 v[236:239], v3 offset:16640
  s_waitcnt vmcnt(9) lgkmcnt(9)
  v_mfma_f32_16x16x32_bf16 v[176:179], v[240:243], v[24:27], v[176:179]
  buffer_load_dwordx4 v[64:67], v5, s[36:39], s6 offen offset:2048 sc1
  s_waitcnt vmcnt(9)
  v_mfma_f32_16x16x32_bf16 v[192:195], v[240:243], v[28:31], v[192:195]
  ds_read_b128 v[240:243], v3 offset:17408
  s_waitcnt lgkmcnt(9)
  v_mfma_f32_16x16x32_bf16 v[180:183], v[244:247], v[24:27], v[180:183]
  v_mfma_f32_16x16x32_bf16 v[196:199], v[244:247], v[28:31], v[196:199]
  ds_read_b128 v[244:247], v3 offset:17664
  s_waitcnt lgkmcnt(9)
  v_mfma_f32_16x16x32_bf16 v[184:187], v[208:211], v[24:27], v[184:187]
  buffer_load_dwordx4 v[68:71], v5, s[36:39], s6 offen offset:2304 sc1
  s_add_u32 s6, s6, 4096
  v_mfma_f32_16x16x32_bf16 v[200:203], v[208:211], v[28:31], v[200:203]
  ds_read_b128 v[208:211], v3 offset:20480
  s_waitcnt lgkmcnt(9)
  v_mfma_f32_16x16x32_bf16 v[188:191], v[212:215], v[24:27], v[188:191]
  v_mfma_f32_16x16x32_bf16 v[204:207], v[212:215], v[28:31], v[204:207]
  ds_read_b128 v[212:215], v3 offset:20736
  s_waitcnt vmcnt(9) lgkmcnt(9)
  v_mfma_f32_16x16x32_bf16 v[176:179], v[216:219], v[32:35], v[176:179]
  buffer_load_dwordx4 v[72:75], v5, s[36:39], s6 offen offset:0 sc1
  s_waitcnt vmcnt(9)
  v_mfma_f32_16x16x32_bf16 v[192:195], v[216:219], v[36:39], v[192:195]
  ds_read_b128 v[216:219], v3 offset:21504
  s_waitcnt lgkmcnt(9)
  v_mfma_f32_16x16x32_bf16 v[180:183], v[220:223], v[32:35], v[180:183]
  v_mfma_f32_16x16x32_bf16 v[196:199], v[220:223], v[36:39], v[196:199]
  ds_read_b128 v[220:223], v3 offset:21760
  s_waitcnt lgkmcnt(9)
  v_mfma_f32_16x16x32_bf16 v[184:187], v[224:227], v[32:35], v[184:187]
  buffer_load_dwordx4 v[76:79], v5, s[36:39], s6 offen offset:256 sc1
  v_mfma_f32_16x16x32_bf16 v[200:203], v[224:227], v[36:39], v[200:203]
  s_barrier
  ds_read_b128 v[224:227], v3 offset:24576
  s_waitcnt lgkmcnt(9)
  v_mfma_f32_16x16x32_bf16 v[188:191], v[228:231], v[32:35], v[188:191]
  v_mfma_f32_16x16x32_bf16 v[204:207], v[228:231], v[36:39], v[204:207]
  ds_read_b128 v[228:231], v3 offset:24832
  s_waitcnt vmcnt(9) lgkmcnt(9)
  v_mfma_f32_16x16x32_bf16 v[176:179], v[232:235], v[40:43], v[176:179]
  buffer_load_dwordx4 v[80:83], v5, s[36:39], s6 offen offset:2048 sc1
  s_waitcnt vmcnt(9)
  v_mfma_f32_16x16x32_bf16 v[192:195], v[232:235], v[44:47], v[192:195]
  ds_read_b128 v[232:235], v3 offset:25600
  s_waitcnt lgkmcnt(9)
  v_mfma_f32_16x16x32_bf16 v[180:183], v[236:239], v[40:43], v[180:183]
  v_mfma_f32_16x16x32_bf16 v[196:199], v[236:239], v[44:47], v[196:199]
  ds_read_b128 v[236:239], v3 offset:25856
  s_waitcnt lgkmcnt(9)
  v_mfma_f32_16x16x32_bf16 v[184:187], v[240:243], v[40:43], v[184:187]
  buffer_load_dwordx4 v[84:87], v5, s[36:39], s6 offen offset:2304 sc1
  s_add_u32 s6, s6, 4096
  v_mfma_f32_16x16x32_bf16 v[200:203], v[240:243], v[44:47], v[200:203]
  ds_read_b128 v[240:243], v3 offset:28672
  s_waitcnt lgkmcnt(9)
  v_mfma_f32_16x16x32_bf16 v[188:191], v[244:247], v[40:43], v[188:191]
  v_mfma_f32_16x16x32_bf16 v[204:207], v[244:247], v[44:47], v[204:207]
  ds_read_b128 v[244:247], v3 offset:28928
  s_waitcnt vmcnt(9) lgkmcnt(9)
  v_mfma_f32_16x16x32_bf16 v[176:179], v[208:211], v[48:51], v[176:179]
  buffer_load_dwordx4 v[88:91], v5, s[36:39], s6 offen offset:0 sc1
  s_waitcnt vmcnt(9)
  v_mfma_f32_16x16x32_bf16 v[192:195], v[208:211], v[52:55], v[192:195]
  ds_read_b128 v[208:211], v3 offset:29696
  s_waitcnt lgkmcnt(9)
  v_mfma_f32_16x16x32_bf16 v[180:183], v[212:215], v[48:51], v[180:183]
  buffer_load_dwordx4 v[92:95], v5, s[36:39], s6 offen offset:256 sc1
  v_mfma_f32_16x16x32_bf16 v[196:199], v[212:215], v[52:55], v[196:199]
  ds_read_b128 v[212:215], v3 offset:29952
  s_waitcnt lgkmcnt(9)
  v_mfma_f32_16x16x32_bf16 v[184:187], v[216:219], v[48:51], v[184:187]
  buffer_load_dwordx4 v[96:99], v5, s[36:39], s6 offen offset:2048 sc1
  v_mfma_f32_16x16x32_bf16 v[200:203], v[216:219], v[52:55], v[200:203]
  ds_read_b128 v[216:219], v3 offset:32768
  s_waitcnt lgkmcnt(9)
  v_mfma_f32_16x16x32_bf16 v[188:191], v[220:223], v[48:51], v[188:191]
  v_mfma_f32_16x16x32_bf16 v[204:207], v[220:223], v[52:55], v[204:207]
  ds_read_b128 v[220:223], v3 offset:33024
  s_waitcnt vmcnt(10) lgkmcnt(9)
  v_mfma_f32_16x16x32_bf16 v[176:179], v[224:227], v[56:59], v[176:179]
  buffer_load_dwordx4 v[100:103], v5, s[36:39], s6 offen offset:2304 sc1
  s_add_u32 s6, s6, 4096
  s_waitcnt vmcnt(10)
  v_mfma_f32_16x16x32_bf16 v[192:195], v[224:227], v[60:63], v[192:195]
  ds_read_b128 v[224:227], v3 offset:33792
  s_waitcnt lgkmcnt(9)
  v_mfma_f32_16x16x32_bf16 v[180:183], v[228:231], v[56:59], v[180:183]
  buffer_load_dwordx4 v[104:107], v5, s[36:39], s6 offen offset:0 sc1
  v_mfma_f32_16x16x32_bf16 v[196:199], v[228:231], v[60:63], v[196:199]
  ds_read_b128 v[228:231], v3 offset:34048
  s_waitcnt lgkmcnt(9)
  v_mfma_f32_16x16x32_bf16 v[184:187], v[232:235], v[56:59], v[184:187]
  buffer_load_dwordx4 v[108:111], v5, s[36:39], s6 offen offset:256 sc1
  v_mfma_f32_16x16x32_bf16 v[200:203], v[232:235], v[60:63], v[200:203]
  s_barrier
  ds_read_b128 v[232:235], v3 offset:36864
  s_waitcnt lgkmcnt(9)
  v_mfma_f32_16x16x32_bf16 v[188:191], v[236:239], v[56:59], v[188:191]
  v_mfma_f32_16x16x32_bf16 v[204:207], v[236:239], v[60:63], v[204:207]
  ds_read_b128 v[236:239], v3 offset:37120
  s_waitcnt vmcnt(11) lgkmcnt(9)
  v_mfma_f32_16x16x32_bf16 v[176:179], v[240:243], v[64:67], v[176:179]
  buffer_load_dword v254, v255, s[36:39], s24 offen offset:32 sc0 sc1
  s_waitcnt vmcnt(11)
  v_mfma_f32_16x16x32_bf16 v[192:195], v[240:243], v[68:71], v[192:195]
  ds_read_b128 v[240:243], v3 offset:37888
  s_waitcnt lgkmcnt(9)
  v_mfma_f32_16x16x32_bf16 v[180:183], v[244:247], v[64:67], v[180:183]
  buffer_load_dwordx4 v[112:115], v5, s[36:39], s6 offen offset:2048 sc1
  v_mfma_f32_16x16x32_bf16 v[196:199], v[244:247], v[68:71], v[196:199]
  ds_read_b128 v[244:247], v3 offset:38144
  s_waitcnt lgkmcnt(9)
  v_mfma_f32_16x16x32_bf16 v[184:187], v[208:211], v[64:67], v[184:187]
  buffer_load_dwordx4 v[116:119], v5, s[36:39], s6 offen offset:2304 sc1
  s_add_u32 s6, s6, 4096
  v_mfma_f32_16x16x32_bf16 v[200:203], v[208:211], v[68:71], v[200:203]
  ds_read_b128 v[208:211], v3 offset:40960
  s_waitcnt lgkmcnt(9)
  v_mfma_f32_16x16x32_bf16 v[188:191], v[212:215], v[64:67], v[188:191]
  v_mfma_f32_16x16x32_bf16 v[204:207], v[212:215], v[68:71], v[204:207]
  ds_read_b128 v[212:215], v3 offset:41216
  s_waitcnt vmcnt(12) lgkmcnt(9)
  v_mfma_f32_16x16x32_bf16 v[176:179], v[216:219], v[72:75], v[176:179]
  buffer_load_dwordx4 v[120:123], v5, s[36:39], s6 offen offset:0 sc1
  s_waitcnt vmcnt(12)
  v_mfma_f32_16x16x32_bf16 v[192:195], v[216:219], v[76:79], v[192:195]
  ds_read_b128 v[216:219], v3 offset:41984
  s_waitcnt lgkmcnt(9)
  v_mfma_f32_16x16x32_bf16 v[180:183], v[220:223], v[72:75], v[180:183]
  buffer_load_dwordx4 v[124:127], v5, s[36:39], s6 offen offset:256 sc1
  v_mfma_f32_16x16x32_bf16 v[196:199], v[220:223], v[76:79], v[196:199]
  ds_read_b128 v[220:223], v3 offset:42240
  s_waitcnt lgkmcnt(9)
  v_mfma_f32_16x16x32_bf16 v[184:187], v[224:227], v[72:75], v[184:187]
  buffer_load_dwordx4 v[128:131], v5, s[36:39], s6 offen offset:2048 sc1
  v_mfma_f32_16x16x32_bf16 v[200:203], v[224:227], v[76:79], v[200:203]
  ds_read_b128 v[224:227], v3 offset:45056
  s_waitcnt lgkmcnt(9)
  v_mfma_f32_16x16x32_bf16 v[188:191], v[228:231], v[72:75], v[188:191]
  v_mfma_f32_16x16x32_bf16 v[204:207], v[228:231], v[76:79], v[204:207]
  ds_read_b128 v[228:231], v3 offset:45312
  s_waitcnt vmcnt(13) lgkmcnt(9)
  v_mfma_f32_16x16x32_bf16 v[176:179], v[232:235], v[80:83], v[176:179]
  buffer_load_dwordx4 v[132:135], v5, s[36:39], s6 offen offset:2304 sc1
  s_add_u32 s6, s6, 4096
  s_waitcnt vmcnt(13)
  v_mfma_f32_16x16x32_bf16 v[192:195], v[232:235], v[84:87], v[192:195]
  ds_read_b128 v[232:235], v3 offset:46080
  s_waitcnt lgkmcnt(9)
  v_mfma_f32_16x16x32_bf16 v[180:183], v[236:239], v[80:83], v[180:183]
  buffer_load_dwordx4 v[136:139], v5, s[36:39], s6 offen offset:0 sc1
  v_mfma_f32_16x16x32_bf16 v[196:199], v[236:239], v[84:87], v[196:199]
  ds_read_b128 v[236:239], v3 offset:46336
  s_waitcnt lgkmcnt(9)
  v_mfma_f32_16x16x32_bf16 v[184:187], v[240:243], v[80:83], v[184:187]
  buffer_load_dwordx4 v[140:143], v5, s[36:39], s6 offen offset:256 sc1
  v_mfma_f32_16x16x32_bf16 v[200:203], v[240:243], v[84:87], v[200:203]
  s_barrier
  ds_read_b128 v[240:243], v4 offset:0
  s_waitcnt lgkmcnt(9)
  v_mfma_f32_16x16x32_bf16 v[188:191], v[244:247], v[80:83], v[188:191]
  v_mfma_f32_16x16x32_bf16 v[204:207], v[244:247], v[84:87], v[204:207]
  ds_read_b128 v[244:247], v4 offset:256
  s_waitcnt vmcnt(14) lgkmcnt(9)
  v_mfma_f32_16x16x32_bf16 v[176:179], v[208:211], v[88:91], v[176:179]
  buffer_load_dwordx4 v[144:147], v5, s[36:39], s6 offen offset:2048 sc1
  s_waitcnt vmcnt(14)
  v_mfma_f32_16x16x32_bf16 v[192:195], v[208:211], v[92:95], v[192:195]
  ds_read_b128 v[208:211], v4 offset:1024
  s_waitcnt lgkmcnt(9)
  v_mfma_f32_16x16x32_bf16 v[180:183], v[212:215], v[88:91], v[180:183]
  buffer_load_dwordx4 v[148:151], v5, s[36:39], s6 offen offset:2304 sc1
  s_add_u32 s6, s6, 4096
  v_mfma_f32_16x16x32_bf16 v[196:199], v[212:215], v[92:95], v[196:199]
  ds_read_b128 v[212:215], v4 offset:1280
  s_waitcnt lgkmcnt(9)
  v_mfma_f32_16x16x32_bf16 v[184:187], v[216:219], v[88:91], v[184:187]
  s_waitcnt vmcnt(10)
  v_cmp_ne_u32 vcc, 1, v254
  s_nop 4
  s_cbranch_vccz K4_tok
  s_mov_b32 s21, 0x10000
  s_nop 1
SP_t:
  buffer_load_dword v254, v255, s[36:39], s24 offen offset:32 sc0 sc1
  s_sub_u32 s21, s21, 1
  s_waitcnt vmcnt(0)
  v_cmp_ne_u32 vcc, 1, v254
  s_cmp_eq_u32 s21, 0
  s_cbranch_scc1 SG_t
  s_nop 3
  s_cbranch_vccnz SP_t
SG_t:
K4_tok:
  buffer_load_dwordx2 v[168:169], v7, s[36:39], s9 offen sc1
  s_add_u32 s9, s9, 16384
  v_mfma_f32_16x16x32_bf16 v[200:203], v[216:219], v[92:95], v[200:203]
  ds_read_b128 v[216:219], v4 offset:4096
  s_waitcnt lgkmcnt(9)
  v_mfma_f32_16x16x32_bf16 v[188:191], v[220:223], v[88:91], v[188:191]
  v_mfma_f32_16x16x32_bf16 v[204:207], v[220:223], v[92:95], v[204:207]
  ds_read_b128 v[220:223], v4 offset:4352
  s_waitcnt lgkmcnt(9)
  v_mfma_f32_16x16x32_bf16 v[176:179], v[224:227], v[96:99], v[176:179]
  buffer_load_dwordx2 v[170:171], v7, s[36:39], s9 offen sc1
  s_add_u32 s9, s9, 16384
  v_mfma_f32_16x16x32_bf16 v[192:195], v[224:227], v[100:103], v[192:195]
  ds_read_b128 v[224:227], v4 offset:5120
  s_waitcnt lgkmcnt(9)
  v_mfma_f32_16x16x32_bf16 v[180:183], v[228:231], v[96:99], v[180:183]
  v_mfma_f32_16x16x32_bf16 v[196:199], v[228:231], v[100:103], v[196:199]
  ds_read_b128 v[228:231], v4 offset:5376
  s_waitcnt lgkmcnt(9)
  v_mfma_f32_16x16x32_bf16 v[184:187], v[232:235], v[96:99], v[184:187]
  buffer_load_dwordx2 v[172:173], v7, s[36:39], s9 offen sc1
  s_add_u32 s9, s9, 16384
  v_mfma_f32_16x16x32_bf16 v[200:203], v[232:235], v[100:103], v[200:203]
  ds_read_b128 v[232:235], v4 offset:8192
  s_waitcnt lgkmcnt(9)
  v_mfma_f32_16x16x32_bf16 v[188:191], v[236:239], v[96:99], v[188:191]
  v_mfma_f32_16x16x32_bf16 v[204:207], v[236:239], v[100:103], v[204:207]
  ds_read_b128 v[236:239], v4 offset:8448
  s_waitcnt lgkmcnt(9)
  v_mfma_f32_16x16x32_bf16 v[176:179], v[240:243], v[104:107], v[176:179]
  buffer_load_dwordx2 v[174:175], v7, s[36:39], s9 offen sc1
  s_add_u32 s9, s9, 16384
  v_mfma_f32_16x16x32_bf16 v[192:195], v[240:243], v[108:111], v[192:195]
  ds_read_b128 v[240:243], v4 offset:9216
  s_waitcnt lgkmcnt(9)
  v_mfma_f32_16x16x32_bf16 v[180:183], v[244:247], v[104:107], v[180:183]
  v_mfma_f32_16x16x32_bf16 v[196:199], v[244:247], v[108:111], v[196:199]
  ds_read_b128 v[244:247], v4 offset:9472
  s_waitcnt lgkmcnt(9)
  v_mfma_f32_16x16x32_bf16 v[184:187], v[208:211], v[104:107], v[184:187]
  buffer_load_dwordx2 v[248:249], v7, s[36:39], s9 offen sc1
  v_mfma_f32_16x16x32_bf16 v[200:203], v[208:211], v[108:111], v[200:203]
  s_barrier
  ds_read_b128 v[208:211], v4 offset:12288
  s_waitcnt lgkmcnt(9)
  v_mfma_f32_16x16x32_bf16 v[188:191], v[212:215], v[104:107], v[188:191]
  v_mfma_f32_16x16x32_bf16 v[204:207], v[212:215], v[108:111], v[204:207]
  ds_read_b128 v[212:215], v4 offset:12544
  s_waitcnt vmcnt(14) lgkmcnt(9)
  v_mfma_f32_16x16x32_bf16 v[176:179], v[216:219], v[112:115], v[176:179]
  buffer_load_dwordx4 v[152:155], v5, s[36:39], s6 offen offset:0 sc1
  s_waitcnt vmcnt(14)
  v_mfma_f32_16x16x32_bf16 v[192:195], v[216:219], v[116:119], v[192:195]
  ds_read_b128 v[216:219], v4 offset:13312
  s_waitcnt lgkmcnt(9)
  v_mfma_f32_16x16x32_bf16 v[180:183], v[220:223], v[112:115], v[180:183]
  v_mfma_f32_16x16x32_bf16 v[196:199], v[220:223], v[116:119], v[196:199]
  ds_read_b128 v[220:223], v4 offset:13568
  s_waitcnt lgkmcnt(9)
  v_mfma_f32_16x16x32_bf16 v[184:187], v[224:227], v[112:115], v[184:187]
  buffer_load_dwordx4 v[156:159], v5, s[36:39], s6 offen offset:256 sc1
  v_mfma_f32_16x16x32_bf16 v[200:203], v[224:227], v[116:119], v[200:203]
  ds_read_b128 v[224:227], v4 offset:16384
  s_waitcnt lgkmcnt(9)
  v_mfma_f32_16x16x32_bf16 v[188:191], v[228:231], v[112:115], v[188:191]
  v_mfma_f32_16x16x32_bf16 v[204:207], v[228:231], v[116:119], v[204:207]
  ds_read_b128 v[228:231], v4 offset:16640
  s_waitcnt vmcnt(14) lgkmcnt(9)
  v_mfma_f32_16x16x32_bf16 v[176:179], v[232:235], v[120:123], v[176:179]
  buffer_load_dwordx4 v[160:163], v5, s[36:39], s6 offen offset:2048 sc1
  s_waitcnt vmcnt(14)
  v_mfma_f32_16x16x32_bf16 v[192:195], v[232:235], v[124:127], v[192:195]
  ds_read_b128 v[232:235], v4 offset:17408
  s_waitcnt lgkmcnt(9)
  v_mfma_f32_16x16x32_bf16 v[180:183], v[236:239], v[120:123], v[180:183]
  v_mfma_f32_16x16x32_bf16 v[196:199], v[236:239], v[124:127], v[196:199]
  ds_read_b128 v[236:239], v4 offset:17664
  s_waitcnt lgkmcnt(9)
  v_mfma_f32_16x16x32_bf16 v[184:187], v[240:243], v[120:123], v[184:187]
  buffer_load_dwordx4 v[164:167], v5, s[36:39], s6 offen offset:2304 sc1
  s_add_u32 s6, s6, 4096
  v_mfma_f32_16x16x32_bf16 v[200:203], v[240:243], v[124:127], v[200:203]
  ds_read_b128 v[240:243], v4 offset:20480
  s_waitcnt lgkmcnt(9)
  v_mfma_f32_16x16x32_bf16 v[188:191], v[244:247], v[120:123], v[188:191]
  v_mfma_f32_16x16x32_bf16 v[204:207], v[244:247], v[124:127], v[204:207]
  ds_read_b128 v[244:247], v4 offset:20736
  s_waitcnt vmcnt(14) lgkmcnt(9)
  v_mfma_f32_16x16x32_bf16 v[176:179], v[208:211], v[128:131], v[176:179]
  s_waitcnt vmcnt(13)
  v_mfma_f32_16x16x32_bf16 v[192:195], v[208:211], v[132:135], v[192:195]
  ds_read_b128 v[208:211], v4 offset:21504
  s_waitcnt lgkmcnt(9)
  v_mfma_f32_16x16x32_bf16 v[180:183], v[212:215], v[128:131], v[180:183]
  v_mfma_f32_16x16x32_bf16 v[196:199], v[212:215], v[132:135], v[196:199]
  ds_read_b128 v[212:215], v4 offset:21760
  s_waitcnt lgkmcnt(9)
  v_mfma_f32_16x16x32_bf16 v[184:187], v[216:219], v[128:131], v[184:187]
  v_mfma_f32_16x16x32_bf16 v[200:203], v[216:219], v[132:135], v[200:203]
  s_barrier
  ds_read_b128 v[216:219], v3 offset:0
  s_waitcnt lgkmcnt(9)
  v_mfma_f32_16x16x32_bf16 v[188:191], v[220:223], v[128:131], v[188:191]
  v_mfma_f32_16x16x32_bf16 v[204:207], v[220:223], v[132:135], v[204:207]
  ds_read_b128 v[220:223], v3 offset:256
  s_waitcnt vmcnt(12) lgkmcnt(9)
  v_mfma_f32_16x16x32_bf16 v[176:179], v[224:227], v[136:139], v[176:179]
  s_waitcnt vmcnt(11)
  v_mfma_f32_16x16x32_bf16 v[192:195], v[224:227], v[140:143], v[192:195]
  ds_read_b128 v[224:227], v3 offset:1024
  s_waitcnt lgkmcnt(9)
  v_mfma_f32_16x16x32_bf16 v[180:183], v[228:231], v[136:139], v[180:183]
  v_mfma_f32_16x16x32_bf16 v[196:199], v[228:231], v[140:143], v[196:199]
  ds_read_b128 v[228:231], v3 offset:1280
  s_waitcnt lgkmcnt(9)
  v_mfma_f32_16x16x32_bf16 v[184:187], v[232:235], v[136:139], v[184:187]
  v_mfma_f32_16x16x32_bf16 v[200:203], v[232:235], v[140:143], v[200:203]
  ds_read_b128 v[232:235], v3 offset:4096
  s_waitcnt lgkmcnt(9)
  v_mfma_f32_16x16x32_bf16 v[188:191], v[236:239], v[136:139], v[188:191]
  v_mfma_f32_16x16x32_bf16 v[204:207], v[236:239], v[140:143], v[204:207]
  ds_read_b128 v[236:239], v3 offset:4352
  s_waitcnt vmcnt(10) lgkmcnt(9)
  v_mfma_f32_16x16x32_bf16 v[176:179], v[240:243], v[144:147], v[176:179]
  s_waitcnt vmcnt(7)
  v_pk_add_f32 v[168:169], v[168:169], v[170:171]
  s_waitcnt vmcnt(5)
  v_pk_add_f32 v[172:173], v[172:173], v[174:175]
  s_waitcnt vmcnt(4)
  v_pk_add_f32 v[248:249], v[248:249], v[168:169]
  v_mfma_f32_16x16x32_bf16 v[192:195], v[240:243], v[148:151], v[192:195]
  ds_read_b128 v[240:243], v3 offset:5120
  s_waitcnt lgkmcnt(9)
  v_mfma_f32_16x16x32_bf16 v[180:183], v[244:247], v[144:147], v[180:183]
  v_pk_add_f32 v[248:249], v[248:249], v[172:173]
  v_mul_f32 v248, 0xbacccccd, v248
  v_mul_f32 v249, 0x3acccccd, v249
  v_mfma_f32_16x16x32_bf16 v[196:199], v[244:247], v[148:151], v[196:199]
  ds_read_b128 v[244:247], v3 offset:5376
  s_waitcnt lgkmcnt(9)
  v_mfma_f32_16x16x32_bf16 v[184:187], v[208:211], v[144:147], v[184:187]
  v_fma_f32 v249, -v248, v248, v249
  v_max_f32 v249, 0, v249
  v_add_f32 v249, 0x3727c5ac, v249
  v_mfma_f32_16x16x32_bf16 v[200:203], v[208:211], v[148:151], v[200:203]
  ds_read_b128 v[208:211], v3 offset:8192
  s_waitcnt lgkmcnt(9)
  v_mfma_f32_16x16x32_bf16 v[188:191], v[212:215], v[144:147], v[188:191]
  v_rcp_f32 v1, v249
  v_sqrt_f32 v249, v249
  v_cvt_pk_bf16_f32 v168, v248, v248
  v_mfma_f32_16x16x32_bf16 v[204:207], v[212:215], v[148:151], v[204:207]
  ds_read_b128 v[212:215], v3 offset:8448
  s_waitcnt vmcnt(3) lgkmcnt(9)
  v_mfma_f32_16x16x32_bf16 v[176:179], v[216:219], v[152:155], v[176:179]
  v_cvt_pk_bf16_f32 v250, v249, v249
  v_and_b32 v251, 0xffff0000, v168
  v_and_b32 v250, 0xffff0000, v250
  s_waitcnt vmcnt(2)
  v_mfma_f32_16x16x32_bf16 v[192:195], v[216:219], v[156:159], v[192:195]
  ds_read_b128 v[216:219], v3 offset:9216
  s_waitcnt lgkmcnt(9)
  v_mfma_f32_16x16x32_bf16 v[180:183], v[220:223], v[152:155], v[180:183]
  v_sub_f32 v251, v248, v251
  v_sub_f32 v252, v249, v250
  v_cvt_pk_bf16_f32 v169, v251, v250
  v_mfma_f32_16x16x32_bf16 v[196:199], v[220:223], v[156:159], v[196:199]
  ds_read_b128 v[220:223], v3 offset:9472
  s_waitcnt lgkmcnt(9)
  v_mfma_f32_16x16x32_bf16 v[184:187], v[224:227], v[152:155], v[184:187]
  v_cvt_pk_bf16_f32 v170, v250, v252
  v_mov_b32 v172, v168
  v_mov_b32 v173, v169
  v_mfma_f32_16x16x32_bf16 v[200:203], v[224:227], v[156:159], v[200:203]
  s_barrier
  ds_read_b128 v[224:227], v3 offset:12288
  s_waitcnt lgkmcnt(9)
  v_mfma_f32_16x16x32_bf16 v[188:191], v[228:231], v[152:155], v[188:191]
  v_mov_b32 v174, v170
  v_mov_b32 v2, v1
  v_mov_b32 v171, 0
  v_mfma_f32_16x16x32_bf16 v[204:207], v[228:231], v[156:159], v[204:207]
  ds_read_b128 v[228:231], v3 offset:12544
  s_waitcnt vmcnt(1) lgkmcnt(9)
  v_mfma_f32_16x16x32_bf16 v[176:179], v[232:235], v[160:163], v[176:179]
  v_mov_b32 v175, 0
  v_permlane16_swap_b32 v168, v172
  v_permlane16_swap_b32 v169, v173
  s_waitcnt vmcnt(0)
  v_mfma_f32_16x16x32_bf16 v[192:195], v[232:235], v[164:167], v[192:195]
  ds_read_b128 v[232:235], v3 offset:13312
  s_waitcnt lgkmcnt(9)
  v_mfma_f32_16x16x32_bf16 v[180:183], v[236:239], v[160:163], v[180:183]
  v_permlane16_swap_b32 v170, v174
  v_permlane16_swap_b32 v1, v2
  v_mov_b32 v7, 1
  v_mfma_f32_16x16x32_bf16 v[196:199], v[236:239], v[164:167], v[196:199]
  ds_read_b128 v[236:239], v3 offset:13568
  s_waitcnt lgkmcnt(9)
  v_mfma_f32_16x16x32_bf16 v[184:187], v[240:243], v[160:163], v[184:187]
  v_mov_b32 v0, 0
  v_mfma_f32_16x16x32_bf16 v[200:203], v[240:243], v[164:167], v[200:203]
  ds_read_b128 v[240:243], v3 offset:16384
  s_waitcnt lgkmcnt(9)
  v_mfma_f32_16x16x32_bf16 v[188:191], v[244:247], v[160:163], v[188:191]
  v_mfma_f32_16x16x32_bf16 v[204:207], v[244:247], v[164:167], v[204:207]
  ds_read_b128 v[244:247], v3 offset:16640
  s_waitcnt lgkmcnt(9)
  v_mfma_f32_16x16x32_bf16 v[176:179], v[208:211], v[168:171], v[176:179]
  v_mfma_f32_16x16x32_bf16 v[192:195], v[208:211], v[172:175], v[192:195]
  ds_read_b128 v[208:211], v3 offset:17408
  s_waitcnt lgkmcnt(9)
  v_mfma_f32_16x16x32_bf16 v[180:183], v[212:215], v[168:171], v[180:183]
  v_mfma_f32_16x16x32_bf16 v[196:199], v[212:215], v[172:175], v[196:199]
  ds_read_b128 v[212:215], v3 offset:17664
  s_waitcnt lgkmcnt(9)
  v_mfma_f32_16x16x32_bf16 v[184:187], v[216:219], v[168:171], v[184:187]
  v_mfma_f32_16x16x32_bf16 v[200:203], v[216:219], v[172:175], v[200:203]
  ds_read_b128 v[216:219], v3 offset:20480
  s_waitcnt lgkmcnt(9)
  v_mfma_f32_16x16x32_bf16 v[188:191], v[220:223], v[168:171], v[188:191]
  v_mfma_f32_16x16x32_bf16 v[204:207], v[220:223], v[172:175], v[204:207]
  ds_read_b128 v[220:223], v3 offset:20736
  v_mul_f32 v180, v180, v1
  v_max_f32 v176, 0, v176
  v_mul_f32 v181, v181, v1
  v_max_f32 v177, 0, v177
  v_mul_f32 v182, v182, v1
  v_max_f32 v178, 0, v178
  v_mul_f32 v183, v183, v1
  v_max_f32 v179, 0, v179
  v_pk_mul_f32 v[176:177], v[176:177], v[180:181]
  v_pk_mul_f32 v[178:179], v[178:179], v[182:183]
  v_cvt_pk_bf16_f32 v248, v176, v177
  v_cvt_pk_bf16_f32 v249, v178, v179
  v_mul_f32 v196, v196, v2
  v_max_f32 v192, 0, v192
  v_mul_f32 v197, v197, v2
  v_max_f32 v193, 0, v193
  v_mul_f32 v198, v198, v2
  v_max_f32 v194, 0, v194
  v_mul_f32 v199, v199, v2
  v_max_f32 v195, 0, v195
  v_pk_mul_f32 v[192:193], v[192:193], v[196:197]
  v_pk_mul_f32 v[194:195], v[194:195], v[198:199]
  v_cvt_pk_bf16_f32 v250, v192, v193
  v_cvt_pk_bf16_f32 v251, v194, v195
  s_nop 0
  v_permlane16_swap_b32 v248, v250
  v_permlane16_swap_b32 v249, v251
  buffer_store_dwordx4 v[248:251], v6, s[36:39], s10 offen offset:0 sc1
  v_mul_f32 v188, v188, v1
  v_max_f32 v184, 0, v184
  v_mul_f32 v189, v189, v1
  v_max_f32 v185, 0, v185
  v_mul_f32 v190, v190, v1
  v_max_f32 v186, 0, v186
  v_mul_f32 v191, v191, v1
  v_max_f32 v187, 0, v187
  v_pk_mul_f32 v[184:185], v[184:185], v[188:189]
  v_pk_mul_f32 v[186:187], v[186:187], v[190:191]
  v_cvt_pk_bf16_f32 v252, v184, v185
  v_cvt_pk_bf16_f32 v253, v186, v187
  v_mul_f32 v204, v204, v2
  v_max_f32 v200, 0, v200
  v_mul_f32 v205, v205, v2
  v_max_f32 v201, 0, v201
  v_mul_f32 v206, v206, v2
  v_max_f32 v202, 0, v202
  v_mul_f32 v207, v207, v2
  v_max_f32 v203, 0, v203
  v_pk_mul_f32 v[200:201], v[200:201], v[204:205]
  v_pk_mul_f32 v[202:203], v[202:203], v[206:207]
  v_cvt_pk_bf16_f32 v254, v200, v201
  v_cvt_pk_bf16_f32 v255, v202, v203
  s_nop 0
  v_permlane16_swap_b32 v252, v254
  v_permlane16_swap_b32 v253, v255
  buffer_store_dwordx4 v[252:255], v6, s[36:39], s10 offen offset:512 sc1
  s_waitcnt lgkmcnt(9)
  v_mfma_f32_16x16x32_bf16 v[176:179], v[224:227], v[8:11], 0
  v_mfma_f32_16x16x32_bf16 v[192:195], v[224:227], v[12:15], 0
  ds_read_b128 v[224:227], v3 offset:21504
  s_waitcnt lgkmcnt(9)
  v_mfma_f32_16x16x32_bf16 v[180:183], v[228:231], v[8:11], 0
  v_mfma_f32_16x16x32_bf16 v[196:199], v[228:231], v[12:15], 0
  ds_read_b128 v[228:231], v3 offset:21760
  s_waitcnt lgkmcnt(9)
  v_mfma_f32_16x16x32_bf16 v[184:187], v[232:235], v[8:11], 0
  v_mfma_f32_16x16x32_bf16 v[200:203], v[232:235], v[12:15], 0
  s_barrier
  ds_read_b128 v[232:235], v3 offset:24576
  s_waitcnt lgkmcnt(9)
  v_mfma_f32_16x16x32_bf16 v[188:191], v[236:239], v[8:11], 0
  v_mfma_f32_16x16x32_bf16 v[204:207], v[236:239], v[12:15], 0
  ds_read_b128 v[236:239], v3 offset:24832
  s_waitcnt lgkmcnt(9)
  v_mfma_f32_16x16x32_bf16 v[176:179], v[240:243], v[16:19], v[176:179]
  v_mfma_f32_16x16x32_bf16 v[192:195], v[240:243], v[20:23], v[192:195]
  ds_read_b128 v[240:243], v3 offset:25600
  s_waitcnt lgkmcnt(9)
  v_mfma_f32_16x16x32_bf16 v[180:183], v[244:247], v[16:19], v[180:183]
  v_mfma_f32_16x16x32_bf16 v[196:199], v[244:247], v[20:23], v[196:199]
  ds_read_b128 v[244:247], v3 offset:25856
  s_waitcnt lgkmcnt(9)
  v_mfma_f32_16x16x32_bf16 v[184:187], v[208:211], v[16:19], v[184:187]
  v_mfma_f32_16x16x32_bf16 v[200:203], v[208:211], v[20:23], v[200:203]
  ds_read_b128 v[208:211], v3 offset:28672
  s_waitcnt lgkmcnt(9)
  v_mfma_f32_16x16x32_bf16 v[188:191], v[212:215], v[16:19], v[188:191]
  v_mfma_f32_16x16x32_bf16 v[204:207], v[212:215], v[20:23], v[204:207]
  ds_read_b128 v[212:215], v3 offset:28928
  s_waitcnt lgkmcnt(9)
  v_mfma_f32_16x16x32_bf16 v[176:179], v[216:219], v[24:27], v[176:179]
  v_mfma_f32_16x16x32_bf16 v[192:195], v[216:219], v[28:31], v[192:195]
  ds_read_b128 v[216:219], v3 offset:29696
  s_waitcnt lgkmcnt(9)
  v_mfma_f32_16x16x32_bf16 v[180:183], v[220:223], v[24:27], v[180:183]
  v_mfma_f32_16x16x32_bf16 v[196:199], v[220:223], v[28:31], v[196:199]
  ds_read_b128 v[220:223], v3 offset:29952
  s_waitcnt lgkmcnt(9)
  v_mfma_f32_16x16x32_bf16 v[184:187], v[224:227], v[24:27], v[184:187]
  v_mfma_f32_16x16x32_bf16 v[200:203], v[224:227], v[28:31], v[200:203]
  ds_read_b128 v[224:227], v3 offset:32768
  s_waitcnt lgkmcnt(9)
  v_mfma_f32_16x16x32_bf16 v[188:191], v[228:231], v[24:27], v[188:191]
  v_mfma_f32_16x16x32_bf16 v[204:207], v[228:231], v[28:31], v[204:207]
  ds_read_b128 v[228:231], v3 offset:33024
  s_waitcnt lgkmcnt(9)
  v_mfma_f32_16x16x32_bf16 v[176:179], v[232:235], v[32:35], v[176:179]
  v_mfma_f32_16x16x32_bf16 v[192:195], v[232:235], v[36:39], v[192:195]
  ds_read_b128 v[232:235], v3 offset:33792
  s_waitcnt lgkmcnt(9)
  v_mfma_f32_16x16x32_bf16 v[180:183], v[236:239], v[32:35], v[180:183]
  v_mfma_f32_16x16x32_bf16 v[196:199], v[236:239], v[36:39], v[196:199]
  ds_read_b128 v[236:239], v3 offset:34048
  s_waitcnt lgkmcnt(9)
  v_mfma_f32_16x16x32_bf16 v[184:187], v[240:243], v[32:35], v[184:187]
  v_mfma_f32_16x16x32_bf16 v[200:203], v[240:243], v[36:39], v[200:203]
  s_barrier
  ds_read_b128 v[240:243], v3 offset:36864
  s_waitcnt lgkmcnt(9)
  v_mfma_f32_16x16x32_bf16 v[188:191], v[244:247], v[32:35], v[188:191]
  v_mfma_f32_16x16x32_bf16 v[204:207], v[244:247], v[36:39], v[204:207]
  ds_read_b128 v[244:247], v3 offset:37120
  s_waitcnt lgkmcnt(9)
  v_mfma_f32_16x16x32_bf16 v[176:179], v[208:211], v[40:43], v[176:179]
  v_mfma_f32_16x16x32_bf16 v[192:195], v[208:211], v[44:47], v[192:195]
  ds_read_b128 v[208:211], v3 offset:37888
  s_waitcnt lgkmcnt(9)
  v_mfma_f32_16x16x32_bf16 v[180:183], v[212:215], v[40:43], v[180:183]
  v_mfma_f32_16x16x32_bf16 v[196:199], v[212:215], v[44:47], v[196:199]
  ds_read_b128 v[212:215], v3 offset:38144
  s_waitcnt lgkmcnt(9)
  v_mfma_f32_16x16x32_bf16 v[184:187], v[216:219], v[40:43], v[184:187]
  v_mfma_f32_16x16x32_bf16 v[200:203], v[216:219], v[44:47], v[200:203]
  ds_read_b128 v[216:219], v3 offset:40960
  s_waitcnt lgkmcnt(9)
  v_mfma_f32_16x16x32_bf16 v[188:191], v[220:223], v[40:43], v[188:191]
  v_mfma_f32_16x16x32_bf16 v[204:207], v[220:223], v[44:47], v[204:207]
  ds_read_b128 v[220:223], v3 offset:41216
  s_waitcnt lgkmcnt(9)
  v_mfma_f32_16x16x32_bf16 v[176:179], v[224:227], v[48:51], v[176:179]
  v_mfma_f32_16x16x32_bf16 v[192:195], v[224:227], v[52:55], v[192:195]
  ds_read_b128 v[224:227], v3 offset:41984
  s_waitcnt lgkmcnt(9)
  v_mfma_f32_16x16x32_bf16 v[180:183], v[228:231], v[48:51], v[180:183]
  v_mfma_f32_16x16x32_bf16 v[196:199], v[228:231], v[52:55], v[196:199]
  ds_read_b128 v[228:231], v3 offset:42240
  s_waitcnt lgkmcnt(9)
  v_mfma_f32_16x16x32_bf16 v[184:187], v[232:235], v[48:51], v[184:187]
  v_mfma_f32_16x16x32_bf16 v[200:203], v[232:235], v[52:55], v[200:203]
  ds_read_b128 v[232:235], v3 offset:45056
  s_waitcnt lgkmcnt(9)
  v_mfma_f32_16x16x32_bf16 v[188:191], v[236:239], v[48:51], v[188:191]
  v_mfma_f32_16x16x32_bf16 v[204:207], v[236:239], v[52:55], v[204:207]
  ds_read_b128 v[236:239], v3 offset:45312
  s_waitcnt lgkmcnt(9)
  v_mfma_f32_16x16x32_bf16 v[176:179], v[240:243], v[56:59], v[176:179]
  v_mfma_f32_16x16x32_bf16 v[192:195], v[240:243], v[60:63], v[192:195]
  ds_read_b128 v[240:243], v3 offset:46080
  s_waitcnt lgkmcnt(9)
  v_mfma_f32_16x16x32_bf16 v[180:183], v[244:247], v[56:59], v[180:183]
  v_mfma_f32_16x16x32_bf16 v[196:199], v[244:247], v[60:63], v[196:199]
  ds_read_b128 v[244:247], v3 offset:46336
  s_waitcnt lgkmcnt(9)
  v_mfma_f32_16x16x32_bf16 v[184:187], v[208:211], v[56:59], v[184:187]
  v_mfma_f32_16x16x32_bf16 v[200:203], v[208:211], v[60:63], v[200:203]
  s_barrier
  ds_read_b128 v[208:211], v4 offset:0
  s_waitcnt lgkmcnt(9)
  v_mfma_f32_16x16x32_bf16 v[188:191], v[212:215], v[56:59], v[188:191]
  v_mfma_f32_16x16x32_bf16 v[204:207], v[212:215], v[60:63], v[204:207]
  ds_read_b128 v[212:215], v4 offset:256
  s_waitcnt lgkmcnt(9)
  v_mfma_f32_16x16x32_bf16 v[176:179], v[216:219], v[64:67], v[176:179]
  v_mfma_f32_16x16x32_bf16 v[192:195], v[216:219], v[68:71], v[192:195]
  ds_read_b128 v[216:219], v4 offset:1024
  s_waitcnt lgkmcnt(9)
  v_mfma_f32_16x16x32_bf16 v[180:183], v[220:223], v[64:67], v[180:183]
  v_mfma_f32_16x16x32_bf16 v[196:199], v[220:223], v[68:71], v[196:199]
  ds_read_b128 v[220:223], v4 offset:1280
  s_waitcnt lgkmcnt(9)
  v_mfma_f32_16x16x32_bf16 v[184:187], v[224:227], v[64:67], v[184:187]
  v_mfma_f32_16x16x32_bf16 v[200:203], v[224:227], v[68:71], v[200:203]
  ds_read_b128 v[224:227], v4 offset:4096
  s_waitcnt lgkmcnt(9)
  v_mfma_f32_16x16x32_bf16 v[188:191], v[228:231], v[64:67], v[188:191]
  v_mfma_f32_16x16x32_bf16 v[204:207], v[228:231], v[68:71], v[204:207]
  ds_read_b128 v[228:231], v4 offset:4352
  s_waitcnt lgkmcnt(9)
  v_mfma_f32_16x16x32_bf16 v[176:179], v[232:235], v[72:75], v[176:179]
  v_mfma_f32_16x16x32_bf16 v[192:195], v[232:235], v[76:79], v[192:195]
  ds_read_b128 v[232:235], v4 offset:5120
  s_waitcnt lgkmcnt(9)
  v_mfma_f32_16x16x32_bf16 v[180:183], v[236:239], v[72:75], v[180:183]
  v_mfma_f32_16x16x32_bf16 v[196:199], v[236:239], v[76:79], v[196:199]
  ds_read_b128 v[236:239], v4 offset:5376
  s_waitcnt lgkmcnt(9)
  v_mfma_f32_16x16x32_bf16 v[184:187], v[240:243], v[72:75], v[184:187]
  v_mfma_f32_16x16x32_bf16 v[200:203], v[240:243], v[76:79], v[200:203]
  ds_read_b128 v[240:243], v4 offset:8192
  s_waitcnt lgkmcnt(9)
  v_mfma_f32_16x16x32_bf16 v[188:191], v[244:247], v[72:75], v[188:191]
  v_mfma_f32_16x16x32_bf16 v[204:207], v[244:247], v[76:79], v[204:207]
  ds_read_b128 v[244:247], v4 offset:8448
  s_waitcnt lgkmcnt(9)
  v_mfma_f32_16x16x32_bf16 v[176:179], v[208:211], v[80:83], v[176:179]
  v_mfma_f32_16x16x32_bf16 v[192:195], v[208:211], v[84:87], v[192:195]
  ds_read_b128 v[208:211], v4 offset:9216
  s_waitcnt vmcnt(0)
  s_mov_b64 exec, 1
  buffer_store_dword v7, v0, s[36:39], s12 offen offset:0 sc0 sc1
  s_mov_b64 exec, -1
  s_waitcnt lgkmcnt(9)
  v_mfma_f32_16x16x32_bf16 v[180:183], v[212:215], v[80:83], v[180:183]
  v_mfma_f32_16x16x32_bf16 v[196:199], v[212:215], v[84:87], v[196:199]
  ds_read_b128 v[212:215], v4 offset:9472
  s_waitcnt lgkmcnt(9)
  v_mfma_f32_16x16x32_bf16 v[184:187], v[216:219], v[80:83], v[184:187]
  v_mfma_f32_16x16x32_bf16 v[200:203], v[216:219], v[84:87], v[200:203]
  s_barrier
  ds_read_b128 v[216:219], v4 offset:12288
  s_waitcnt lgkmcnt(9)
  v_mfma_f32_16x16x32_bf16 v[188:191], v[220:223], v[80:83], v[188:191]
  v_mfma_f32_16x16x32_bf16 v[204:207], v[220:223], v[84:87], v[204:207]
  ds_read_b128 v[220:223], v4 offset:12544
  s_waitcnt lgkmcnt(9)
  v_mfma_f32_16x16x32_bf16 v[176:179], v[224:227], v[88:91], v[176:179]
  v_mfma_f32_16x16x32_bf16 v[192:195], v[224:227], v[92:95], v[192:195]
  ds_read_b128 v[224:227], v4 offset:13312
  s_waitcnt lgkmcnt(9)
  v_mfma_f32_16x16x32_bf16 v[180:183], v[228:231], v[88:91], v[180:183]
  v_mfma_f32_16x16x32_bf16 v[196:199], v[228:231], v[92:95], v[196:199]
  ds_read_b128 v[228:231], v4 offset:13568
  s_waitcnt lgkmcnt(9)
  v_mfma_f32_16x16x32_bf16 v[184:187], v[232:235], v[88:91], v[184:187]
  v_mfma_f32_16x16x32_bf16 v[200:203], v[232:235], v[92:95], v[200:203]
  ds_read_b128 v[232:235], v4 offset:16384
  s_waitcnt lgkmcnt(9)
  v_mfma_f32_16x16x32_bf16 v[188:191], v[236:239], v[88:91], v[188:191]
  v_mfma_f32_16x16x32_bf16 v[204:207], v[236:239], v[92:95], v[204:207]
  ds_read_b128 v[236:239], v4 offset:16640
  s_waitcnt lgkmcnt(9)
  v_mfma_f32_16x16x32_bf16 v[176:179], v[240:243], v[96:99], v[176:179]
  v_mfma_f32_16x16x32_bf16 v[192:195], v[240:243], v[100:103], v[192:195]
  ds_read_b128 v[240:243], v4 offset:17408
  s_waitcnt lgkmcnt(9)
  v_mfma_f32_16x16x32_bf16 v[180:183], v[244:247], v[96:99], v[180:183]
  v_mfma_f32_16x16x32_bf16 v[196:199], v[244:247], v[100:103], v[196:199]
  ds_read_b128 v[244:247], v4 offset:17664
  s_waitcnt lgkmcnt(9)
  v_mfma_f32_16x16x32_bf16 v[184:187], v[208:211], v[96:99], v[184:187]
  v_mfma_f32_16x16x32_bf16 v[200:203], v[208:211], v[100:103], v[200:203]
  ds_read_b128 v[208:211], v4 offset:20480
  s_waitcnt lgkmcnt(9)
  v_mfma_f32_16x16x32_bf16 v[188:191], v[212:215], v[96:99], v[188:191]
  v_mfma_f32_16x16x32_bf16 v[204:207], v[212:215], v[100:103], v[204:207]
  ds_read_b128 v[212:215], v4 offset:20736
  s_waitcnt lgkmcnt(9)
  v_mfma_f32_16x16x32_bf16 v[176:179], v[216:219], v[104:107], v[176:179]
  v_mfma_f32_16x16x32_bf16 v[192:195], v[216:219], v[108:111], v[192:195]
  ds_read_b128 v[216:219], v4 offset:21504
  s_waitcnt lgkmcnt(9)
  v_mfma_f32_16x16x32_bf16 v[180:183], v[220:223], v[104:107], v[180:183]
  v_mfma_f32_16x16x32_bf16 v[196:199], v[220:223], v[108:111], v[196:199]
  ds_read_b128 v[220:223], v4 offset:21760
  s_waitcnt lgkmcnt(9)
  v_mfma_f32_16x16x32_bf16 v[184:187], v[224:227], v[104:107], v[184:187]
  v_mfma_f32_16x16x32_bf16 v[200:203], v[224:227], v[108:111], v[200:203]
  s_barrier
  ds_read_b128 v[224:227], v3 offset:0
  s_waitcnt lgkmcnt(9)
  v_mfma_f32_16x16x32_bf16 v[188:191], v[228:231], v[104:107], v[188:191]
  v_mfma_f32_16x16x32_bf16 v[204:207], v[228:231], v[108:111], v[204:207]
  ds_read_b128 v[228:231], v3 offset:256
  s_waitcnt lgkmcnt(9)
  v_mfma_f32_16x16x32_bf16 v[176:179], v[232:235], v[112:115], v[176:179]
  v_mfma_f32_16x16x32_bf16 v[192:195], v[232:235], v[116:119], v[192:195]
  ds_read_b128 v[232:235], v3 offset:1024
  s_waitcnt lgkmcnt(9)
  v_mfma_f32_16x16x32_bf16 v[180:183], v[236:239], v[112:115], v[180:183]
  v_mfma_f32_16x16x32_bf16 v[196:199], v[236:239], v[116:119], v[196:199]
  ds_read_b128 v[236:239], v3 offset:1280
  s_waitcnt lgkmcnt(9)
  v_mfma_f32_16x16x32_bf16 v[184:187], v[240:243], v[112:115], v[184:187]
  v_mfma_f32_16x16x32_bf16 v[200:203], v[240:243], v[116:119], v[200:203]
  ds_read_b128 v[240:243], v3 offset:4096
  s_waitcnt lgkmcnt(9)
  v_mfma_f32_16x16x32_bf16 v[188:191], v[244:247], v[112:115], v[188:191]
  v_mfma_f32_16x16x32_bf16 v[204:207], v[244:247], v[116:119], v[204:207]
  ds_read_b128 v[244:247], v3 offset:4352
  s_waitcnt lgkmcnt(9)
  v_mfma_f32_16x16x32_bf16 v[176:179], v[208:211], v[120:123], v[176:179]
  v_mfma_f32_16x16x32_bf16 v[192:195], v[208:211], v[124:127], v[192:195]
  ds_read_b128 v[208:211], v3 offset:5120
  s_waitcnt lgkmcnt(9)
  v_mfma_f32_16x16x32_bf16 v[180:183], v[212:215], v[120:123], v[180:183]
  v_mfma_f32_16x16x32_bf16 v[196:199], v[212:215], v[124:127], v[196:199]
  ds_read_b128 v[212:215], v3 offset:5376
  s_waitcnt lgkmcnt(9)
  v_mfma_f32_16x16x32_bf16 v[184:187], v[216:219], v[120:123], v[184:187]
  v_mfma_f32_16x16x32_bf16 v[200:203], v[216:219], v[124:127], v[200:203]
  ds_read_b128 v[216:219], v3 offset:8192
  s_waitcnt lgkmcnt(9)
  v_mfma_f32_16x16x32_bf16 v[188:191], v[220:223], v[120:123], v[188:191]
  v_mfma_f32_16x16x32_bf16 v[204:207], v[220:223], v[124:127], v[204:207]
  ds_read_b128 v[220:223], v3 offset:8448
  s_waitcnt lgkmcnt(9)
  v_mfma_f32_16x16x32_bf16 v[176:179], v[224:227], v[128:131], v[176:179]
  v_mfma_f32_16x16x32_bf16 v[192:195], v[224:227], v[132:135], v[192:195]
  ds_read_b128 v[224:227], v3 offset:9216
  s_waitcnt lgkmcnt(9)
  v_mfma_f32_16x16x32_bf16 v[180:183], v[228:231], v[128:131], v[180:183]
  v_mfma_f32_16x16x32_bf16 v[196:199], v[228:231], v[132:135], v[196:199]
  ds_read_b128 v[228:231], v3 offset:9472
  s_waitcnt lgkmcnt(9)
  v_mfma_f32_16x16x32_bf16 v[184:187], v[232:235], v[128:131], v[184:187]
  v_mfma_f32_16x16x32_bf16 v[200:203], v[232:235], v[132:135], v[200:203]
  s_barrier
  ds_read_b128 v[232:235], v3 offset:12288
  s_waitcnt lgkmcnt(9)
  v_mfma_f32_16x16x32_bf16 v[188:191], v[236:239], v[128:131], v[188:191]
  v_mfma_f32_16x16x32_bf16 v[204:207], v[236:239], v[132:135], v[204:207]
  ds_read_b128 v[236:239], v3 offset:12544
  s_waitcnt lgkmcnt(9)
  v_mfma_f32_16x16x32_bf16 v[176:179], v[240:243], v[136:139], v[176:179]
  v_mfma_f32_16x16x32_bf16 v[192:195], v[240:243], v[140:143], v[192:195]
  ds_read_b128 v[240:243], v3 offset:13312
  s_waitcnt lgkmcnt(9)
  v_mfma_f32_16x16x32_bf16 v[180:183], v[244:247], v[136:139], v[180:183]
  v_mfma_f32_16x16x32_bf16 v[196:199], v[244:247], v[140:143], v[196:199]
  ds_read_b128 v[244:247], v3 offset:13568
  s_waitcnt lgkmcnt(9)
  v_mfma_f32_16x16x32_bf16 v[184:187], v[208:211], v[136:139], v[184:187]
  v_mfma_f32_16x16x32_bf16 v[200:203], v[208:211], v[140:143], v[200:203]
  ds_read_b128 v[208:211], v3 offset:16384
  s_waitcnt lgkmcnt(9)
  v_mfma_f32_16x16x32_bf16 v[188:191], v[212:215], v[136:139], v[188:191]
  v_mfma_f32_16x16x32_bf16 v[204:207], v[212:215], v[140:143], v[204:207]
  ds_read_b128 v[212:215], v3 offset:16640
  s_waitcnt lgkmcnt(9)
  v_mfma_f32_16x16x32_bf16 v[176:179], v[216:219], v[144:147], v[176:179]
  v_mfma_f32_16x16x32_bf16 v[192:195], v[216:219], v[148:151], v[192:195]
  ds_read_b128 v[216:219], v3 offset:17408
  s_waitcnt lgkmcnt(9)
  v_mfma_f32_16x16x32_bf16 v[180:183], v[220:223], v[144:147], v[180:183]
  v_mfma_f32_16x16x32_bf16 v[196:199], v[220:223], v[148:151], v[196:199]
  ds_read_b128 v[220:223], v3 offset:17664
  s_waitcnt lgkmcnt(9)
  v_mfma_f32_16x16x32_bf16 v[184:187], v[224:227], v[144:147], v[184:187]
  v_mfma_f32_16x16x32_bf16 v[200:203], v[224:227], v[148:151], v[200:203]
  ds_read_b128 v[224:227], v3 offset:20480
  s_waitcnt lgkmcnt(9)
  v_mfma_f32_16x16x32_bf16 v[188:191], v[228:231], v[144:147], v[188:191]
  v_mfma_f32_16x16x32_bf16 v[204:207], v[228:231], v[148:151], v[204:207]
  ds_read_b128 v[228:231], v3 offset:20736
  s_waitcnt lgkmcnt(9)
  v_mfma_f32_16x16x32_bf16 v[176:179], v[232:235], v[152:155], v[176:179]
  v_mfma_f32_16x16x32_bf16 v[192:195], v[232:235], v[156:159], v[192:195]
  ds_read_b128 v[232:235], v3 offset:21504
  s_waitcnt lgkmcnt(9)
  v_mfma_f32_16x16x32_bf16 v[180:183], v[236:239], v[152:155], v[180:183]
  v_mfma_f32_16x16x32_bf16 v[196:199], v[236:239], v[156:159], v[196:199]
  ds_read_b128 v[236:239], v3 offset:21760
  s_waitcnt lgkmcnt(9)
  v_mfma_f32_16x16x32_bf16 v[184:187], v[240:243], v[152:155], v[184:187]
  v_mfma_f32_16x16x32_bf16 v[200:203], v[240:243], v[156:159], v[200:203]
  s_barrier
  ds_read_b128 v[240:243], v3 offset:24576
  s_waitcnt lgkmcnt(9)
  v_mfma_f32_16x16x32_bf16 v[188:191], v[244:247], v[152:155], v[188:191]
  v_mfma_f32_16x16x32_bf16 v[204:207], v[244:247], v[156:159], v[204:207]
  ds_read_b128 v[244:247], v3 offset:24832
  s_waitcnt lgkmcnt(9)
  v_mfma_f32_16x16x32_bf16 v[176:179], v[208:211], v[160:163], v[176:179]
  v_mfma_f32_16x16x32_bf16 v[192:195], v[208:211], v[164:167], v[192:195]
  ds_read_b128 v[208:211], v3 offset:25600
  s_waitcnt lgkmcnt(9)
  v_mfma_f32_16x16x32_bf16 v[180:183], v[212:215], v[160:163], v[180:183]
  v_mfma_f32_16x16x32_bf16 v[196:199], v[212:215], v[164:167], v[196:199]
  ds_read_b128 v[212:215], v3 offset:25856
  s_waitcnt lgkmcnt(9)
  v_mfma_f32_16x16x32_bf16 v[184:187], v[216:219], v[160:163], v[184:187]
  v_mfma_f32_16x16x32_bf16 v[200:203], v[216:219], v[164:167], v[200:203]
  ds_read_b128 v[216:219], v3 offset:28672
  s_waitcnt lgkmcnt(9)
  v_mfma_f32_16x16x32_bf16 v[188:191], v[220:223], v[160:163], v[188:191]
  v_mfma_f32_16x16x32_bf16 v[204:207], v[220:223], v[164:167], v[204:207]
  ds_read_b128 v[220:223], v3 offset:28928
  s_waitcnt lgkmcnt(9)
  v_mfma_f32_16x16x32_bf16 v[176:179], v[224:227], v[168:171], v[176:179]
  v_mfma_f32_16x16x32_bf16 v[192:195], v[224:227], v[172:175], v[192:195]
  ds_read_b128 v[224:227], v3 offset:29696
  s_waitcnt lgkmcnt(9)
  v_mfma_f32_16x16x32_bf16 v[180:183], v[228:231], v[168:171], v[180:183]
  v_mfma_f32_16x16x32_bf16 v[196:199], v[228:231], v[172:175], v[196:199]
  ds_read_b128 v[228:231], v3 offset:29952
  s_waitcnt lgkmcnt(9)
  v_mfma_f32_16x16x32_bf16 v[184:187], v[232:235], v[168:171], v[184:187]
  v_mfma_f32_16x16x32_bf16 v[200:203], v[232:235], v[172:175], v[200:203]
  ds_read_b128 v[232:235], v3 offset:32768
  s_waitcnt lgkmcnt(9)
  v_mfma_f32_16x16x32_bf16 v[188:191], v[236:239], v[168:171], v[188:191]
  v_mfma_f32_16x16x32_bf16 v[204:207], v[236:239], v[172:175], v[204:207]
  ds_read_b128 v[236:239], v3 offset:33024
  v_mul_f32 v180, v180, v1
  v_max_f32 v176, 0, v176
  v_mul_f32 v181, v181, v1
  v_max_f32 v177, 0, v177
  v_mul_f32 v182, v182, v1
  v_max_f32 v178, 0, v178
  v_mul_f32 v183, v183, v1
  v_max_f32 v179, 0, v179
  v_pk_mul_f32 v[176:177], v[176:177], v[180:181]
  v_pk_mul_f32 v[178:179], v[178:179], v[182:183]
  v_cvt_pk_bf16_f32 v248, v176, v177
  v_cvt_pk_bf16_f32 v249, v178, v179
  v_mul_f32 v196, v196, v2
  v_max_f32 v192, 0, v192
  v_mul_f32 v197, v197, v2
  v_max_f32 v193, 0, v193
  v_mul_f32 v198, v198, v2
  v_max_f32 v194, 0, v194
  v_mul_f32 v199, v199, v2
  v_max_f32 v195, 0, v195
  v_pk_mul_f32 v[192:193], v[192:193], v[196:197]
  v_pk_mul_f32 v[194:195], v[194:195], v[198:199]
  v_cvt_pk_bf16_f32 v250, v192, v193
  v_cvt_pk_bf16_f32 v251, v194, v195
  s_nop 0
  v_permlane16_swap_b32 v248, v250
  v_permlane16_swap_b32 v249, v251
  buffer_store_dwordx4 v[248:251], v6, s[36:39], s10 offen offset:1024 sc1
  v_mul_f32 v188, v188, v1
  v_max_f32 v184, 0, v184
  v_mul_f32 v189, v189, v1
  v_max_f32 v185, 0, v185
  v_mul_f32 v190, v190, v1
  v_max_f32 v186, 0, v186
  v_mul_f32 v191, v191, v1
  v_max_f32 v187, 0, v187
  v_pk_mul_f32 v[184:185], v[184:185], v[188:189]
  v_pk_mul_f32 v[186:187], v[186:187], v[190:191]
  v_cvt_pk_bf16_f32 v252, v184, v185
  v_cvt_pk_bf16_f32 v253, v186, v187
  v_mul_f32 v204, v204, v2
  v_max_f32 v200, 0, v200
  v_mul_f32 v205, v205, v2
  v_max_f32 v201, 0, v201
  v_mul_f32 v206, v206, v2
  v_max_f32 v202, 0, v202
  v_mul_f32 v207, v207, v2
  v_max_f32 v203, 0, v203
  v_pk_mul_f32 v[200:201], v[200:201], v[204:205]
  v_pk_mul_f32 v[202:203], v[202:203], v[206:207]
  v_cvt_pk_bf16_f32 v254, v200, v201
  v_cvt_pk_bf16_f32 v255, v202, v203
  s_nop 0
  v_permlane16_swap_b32 v252, v254
  v_permlane16_swap_b32 v253, v255
  buffer_store_dwordx4 v[252:255], v6, s[36:39], s10 offen offset:1536 sc1
  s_waitcnt lgkmcnt(9)
  v_mfma_f32_16x16x32_bf16 v[176:179], v[240:243], v[8:11], 0
  v_mfma_f32_16x16x32_bf16 v[192:195], v[240:243], v[12:15], 0
  ds_read_b128 v[240:243], v3 offset:33792
  s_waitcnt lgkmcnt(9)
  v_mfma_f32_16x16x32_bf16 v[180:183], v[244:247], v[8:11], 0
  v_mfma_f32_16x16x32_bf16 v[196:199], v[244:247], v[12:15], 0
  ds_read_b128 v[244:247], v3 offset:34048
  s_waitcnt lgkmcnt(9)
  v_mfma_f32_16x16x32_bf16 v[184:187], v[208:211], v[8:11], 0
  v_mfma_f32_16x16x32_bf16 v[200:203], v[208:211], v[12:15], 0
  s_barrier
  ds_read_b128 v[208:211], v3 offset:36864
  s_waitcnt lgkmcnt(9)
  v_mfma_f32_16x16x32_bf16 v[188:191], v[212:215], v[8:11], 0
  v_mfma_f32_16x16x32_bf16 v[204:207], v[212:215], v[12:15], 0
  ds_read_b128 v[212:215], v3 offset:37120
  s_waitcnt lgkmcnt(9)
  v_mfma_f32_16x16x32_bf16 v[176:179], v[216:219], v[16:19], v[176:179]
  v_mfma_f32_16x16x32_bf16 v[192:195], v[216:219], v[20:23], v[192:195]
  ds_read_b128 v[216:219], v3 offset:37888
  s_waitcnt lgkmcnt(9)
  v_mfma_f32_16x16x32_bf16 v[180:183], v[220:223], v[16:19], v[180:183]
  v_mfma_f32_16x16x32_bf16 v[196:199], v[220:223], v[20:23], v[196:199]
  ds_read_b128 v[220:223], v3 offset:38144
  s_waitcnt lgkmcnt(9)
  v_mfma_f32_16x16x32_bf16 v[184:187], v[224:227], v[16:19], v[184:187]
  v_mfma_f32_16x16x32_bf16 v[200:203], v[224:227], v[20:23], v[200:203]
  ds_read_b128 v[224:227], v3 offset:40960
  s_waitcnt lgkmcnt(9)
  v_mfma_f32_16x16x32_bf16 v[188:191], v[228:231], v[16:19], v[188:191]
  v_mfma_f32_16x16x32_bf16 v[204:207], v[228:231], v[20:23], v[204:207]
  ds_read_b128 v[228:231], v3 offset:41216
  s_waitcnt lgkmcnt(9)
  v_mfma_f32_16x16x32_bf16 v[176:179], v[232:235], v[24:27], v[176:179]
  v_mfma_f32_16x16x32_bf16 v[192:195], v[232:235], v[28:31], v[192:195]
  ds_read_b128 v[232:235], v3 offset:41984
  s_waitcnt lgkmcnt(9)
  v_mfma_f32_16x16x32_bf16 v[180:183], v[236:239], v[24:27], v[180:183]
  v_mfma_f32_16x16x32_bf16 v[196:199], v[236:239], v[28:31], v[196:199]
  ds_read_b128 v[236:239], v3 offset:42240
  s_waitcnt lgkmcnt(9)
  v_mfma_f32_16x16x32_bf16 v[184:187], v[240:243], v[24:27], v[184:187]
  v_mfma_f32_16x16x32_bf16 v[200:203], v[240:243], v[28:31], v[200:203]
  ds_read_b128 v[240:243], v3 offset:45056
  s_waitcnt lgkmcnt(9)
  v_mfma_f32_16x16x32_bf16 v[188:191], v[244:247], v[24:27], v[188:191]
  v_mfma_f32_16x16x32_bf16 v[204:207], v[244:247], v[28:31], v[204:207]
  ds_read_b128 v[244:247], v3 offset:45312
  s_waitcnt lgkmcnt(9)
  v_mfma_f32_16x16x32_bf16 v[176:179], v[208:211], v[32:35], v[176:179]
  v_mfma_f32_16x16x32_bf16 v[192:195], v[208:211], v[36:39], v[192:195]
  ds_read_b128 v[208:211], v3 offset:46080
  s_waitcnt lgkmcnt(9)
  v_mfma_f32_16x16x32_bf16 v[180:183], v[212:215], v[32:35], v[180:183]
  v_mfma_f32_16x16x32_bf16 v[196:199], v[212:215], v[36:39], v[196:199]
  ds_read_b128 v[212:215], v3 offset:46336
  s_waitcnt lgkmcnt(9)
  v_mfma_f32_16x16x32_bf16 v[184:187], v[216:219], v[32:35], v[184:187]
  v_mfma_f32_16x16x32_bf16 v[200:203], v[216:219], v[36:39], v[200:203]
  s_barrier
  ds_read_b128 v[216:219], v4 offset:0
  s_waitcnt lgkmcnt(9)
  v_mfma_f32_16x16x32_bf16 v[188:191], v[220:223], v[32:35], v[188:191]
  v_mfma_f32_16x16x32_bf16 v[204:207], v[220:223], v[36:39], v[204:207]
  ds_read_b128 v[220:223], v4 offset:256
  s_waitcnt lgkmcnt(9)
  v_mfma_f32_16x16x32_bf16 v[176:179], v[224:227], v[40:43], v[176:179]
  v_mfma_f32_16x16x32_bf16 v[192:195], v[224:227], v[44:47], v[192:195]
  ds_read_b128 v[224:227], v4 offset:1024
  s_waitcnt lgkmcnt(9)
  v_mfma_f32_16x16x32_bf16 v[180:183], v[228:231], v[40:43], v[180:183]
  v_mfma_f32_16x16x32_bf16 v[196:199], v[228:231], v[44:47], v[196:199]
  ds_read_b128 v[228:231], v4 offset:1280
  s_waitcnt lgkmcnt(9)
  v_mfma_f32_16x16x32_bf16 v[184:187], v[232:235], v[40:43], v[184:187]
  v_mfma_f32_16x16x32_bf16 v[200:203], v[232:235], v[44:47], v[200:203]
  ds_read_b128 v[232:235], v4 offset:4096
  s_waitcnt lgkmcnt(9)
  v_mfma_f32_16x16x32_bf16 v[188:191], v[236:239], v[40:43], v[188:191]
  v_mfma_f32_16x16x32_bf16 v[204:207], v[236:239], v[44:47], v[204:207]
  ds_read_b128 v[236:239], v4 offset:4352
  s_waitcnt lgkmcnt(9)
  v_mfma_f32_16x16x32_bf16 v[176:179], v[240:243], v[48:51], v[176:179]
  v_mfma_f32_16x16x32_bf16 v[192:195], v[240:243], v[52:55], v[192:195]
  ds_read_b128 v[240:243], v4 offset:5120
  s_waitcnt lgkmcnt(9)
  v_mfma_f32_16x16x32_bf16 v[180:183], v[244:247], v[48:51], v[180:183]
  v_mfma_f32_16x16x32_bf16 v[196:199], v[244:247], v[52:55], v[196:199]
  ds_read_b128 v[244:247], v4 offset:5376
  s_waitcnt lgkmcnt(9)
  v_mfma_f32_16x16x32_bf16 v[184:187], v[208:211], v[48:51], v[184:187]
  v_mfma_f32_16x16x32_bf16 v[200:203], v[208:211], v[52:55], v[200:203]
  ds_read_b128 v[208:211], v4 offset:8192
  s_waitcnt lgkmcnt(9)
  v_mfma_f32_16x16x32_bf16 v[188:191], v[212:215], v[48:51], v[188:191]
  v_mfma_f32_16x16x32_bf16 v[204:207], v[212:215], v[52:55], v[204:207]
  ds_read_b128 v[212:215], v4 offset:8448
  s_waitcnt lgkmcnt(9)
  v_mfma_f32_16x16x32_bf16 v[176:179], v[216:219], v[56:59], v[176:179]
  v_mfma_f32_16x16x32_bf16 v[192:195], v[216:219], v[60:63], v[192:195]
  ds_read_b128 v[216:219], v4 offset:9216
  s_waitcnt lgkmcnt(9)
  v_mfma_f32_16x16x32_bf16 v[180:183], v[220:223], v[56:59], v[180:183]
  v_mfma_f32_16x16x32_bf16 v[196:199], v[220:223], v[60:63], v[196:199]
  ds_read_b128 v[220:223], v4 offset:9472
  s_waitcnt lgkmcnt(9)
  v_mfma_f32_16x16x32_bf16 v[184:187], v[224:227], v[56:59], v[184:187]
  v_mfma_f32_16x16x32_bf16 v[200:203], v[224:227], v[60:63], v[200:203]
  s_barrier
  ds_read_b128 v[224:227], v4 offset:12288
  s_waitcnt lgkmcnt(9)
  v_mfma_f32_16x16x32_bf16 v[188:191], v[228:231], v[56:59], v[188:191]
  v_mfma_f32_16x16x32_bf16 v[204:207], v[228:231], v[60:63], v[204:207]
  ds_read_b128 v[228:231], v4 offset:12544
  s_waitcnt lgkmcnt(9)
  v_mfma_f32_16x16x32_bf16 v[176:179], v[232:235], v[64:67], v[176:179]
  v_mfma_f32_16x16x32_bf16 v[192:195], v[232:235], v[68:71], v[192:195]
  ds_read_b128 v[232:235], v4 offset:13312
  s_waitcnt lgkmcnt(9)
  v_mfma_f32_16x16x32_bf16 v[180:183], v[236:239], v[64:67], v[180:183]
  v_mfma_f32_16x16x32_bf16 v[196:199], v[236:239], v[68:71], v[196:199]
  ds_read_b128 v[236:239], v4 offset:13568
  s_waitcnt lgkmcnt(9)
  v_mfma_f32_16x16x32_bf16 v[184:187], v[240:243], v[64:67], v[184:187]
  v_mfma_f32_16x16x32_bf16 v[200:203], v[240:243], v[68:71], v[200:203]
  ds_read_b128 v[240:243], v4 offset:16384
  s_waitcnt lgkmcnt(9)
  v_mfma_f32_16x16x32_bf16 v[188:191], v[244:247], v[64:67], v[188:191]
  v_mfma_f32_16x16x32_bf16 v[204:207], v[244:247], v[68:71], v[204:207]
  ds_read_b128 v[244:247], v4 offset:16640
  s_waitcnt lgkmcnt(9)
  v_mfma_f32_16x16x32_bf16 v[176:179], v[208:211], v[72:75], v[176:179]
  v_mfma_f32_16x16x32_bf16 v[192:195], v[208:211], v[76:79], v[192:195]
  ds_read_b128 v[208:211], v4 offset:17408
  s_waitcnt lgkmcnt(9)
  v_mfma_f32_16x16x32_bf16 v[180:183], v[212:215], v[72:75], v[180:183]
  v_mfma_f32_16x16x32_bf16 v[196:199], v[212:215], v[76:79], v[196:199]
  ds_read_b128 v[212:215], v4 offset:17664
  s_waitcnt lgkmcnt(9)
  v_mfma_f32_16x16x32_bf16 v[184:187], v[216:219], v[72:75], v[184:187]
  v_mfma_f32_16x16x32_bf16 v[200:203], v[216:219], v[76:79], v[200:203]
  ds_read_b128 v[216:219], v4 offset:20480
  s_waitcnt lgkmcnt(9)
  v_mfma_f32_16x16x32_bf16 v[188:191], v[220:223], v[72:75], v[188:191]
  v_mfma_f32_16x16x32_bf16 v[204:207], v[220:223], v[76:79], v[204:207]
  ds_read_b128 v[220:223], v4 offset:20736
  s_waitcnt lgkmcnt(9)
  v_mfma_f32_16x16x32_bf16 v[176:179], v[224:227], v[80:83], v[176:179]
  v_mfma_f32_16x16x32_bf16 v[192:195], v[224:227], v[84:87], v[192:195]
  ds_read_b128 v[224:227], v4 offset:21504
  s_waitcnt vmcnt(0)
  s_mov_b64 exec, 1
  buffer_store_dword v7, v0, s[36:39], s12 offen offset:32 sc0 sc1
  s_mov_b64 exec, -1
  s_waitcnt lgkmcnt(9)
  v_mfma_f32_16x16x32_bf16 v[180:183], v[228:231], v[80:83], v[180:183]
  v_mfma_f32_16x16x32_bf16 v[196:199], v[228:231], v[84:87], v[196:199]
  ds_read_b128 v[228:231], v4 offset:21760
  s_waitcnt lgkmcnt(9)
  v_mfma_f32_16x16x32_bf16 v[184:187], v[232:235], v[80:83], v[184:187]
  v_mfma_f32_16x16x32_bf16 v[200:203], v[232:235], v[84:87], v[200:203]
  s_barrier
  ds_read_b128 v[232:235], v3 offset:0
  s_waitcnt lgkmcnt(9)
  v_mfma_f32_16x16x32_bf16 v[188:191], v[236:239], v[80:83], v[188:191]
  v_mfma_f32_16x16x32_bf16 v[204:207], v[236:239], v[84:87], v[204:207]
  ds_read_b128 v[236:239], v3 offset:256
  s_waitcnt lgkmcnt(9)
  v_mfma_f32_16x16x32_bf16 v[176:179], v[240:243], v[88:91], v[176:179]
  v_mfma_f32_16x16x32_bf16 v[192:195], v[240:243], v[92:95], v[192:195]
  ds_read_b128 v[240:243], v3 offset:1024
  s_waitcnt lgkmcnt(9)
  v_mfma_f32_16x16x32_bf16 v[180:183], v[244:247], v[88:91], v[180:183]
  v_mfma_f32_16x16x32_bf16 v[196:199], v[244:247], v[92:95], v[196:199]
  ds_read_b128 v[244:247], v3 offset:1280
  s_waitcnt lgkmcnt(9)
  v_mfma_f32_16x16x32_bf16 v[184:187], v[208:211], v[88:91], v[184:187]
  v_mfma_f32_16x16x32_bf16 v[200:203], v[208:211], v[92:95], v[200:203]
  ds_read_b128 v[208:211], v3 offset:4096
  s_waitcnt lgkmcnt(9)
  v_mfma_f32_16x16x32_bf16 v[188:191], v[212:215], v[88:91], v[188:191]
  v_mfma_f32_16x16x32_bf16 v[204:207], v[212:215], v[92:95], v[204:207]
  ds_read_b128 v[212:215], v3 offset:4352
  s_waitcnt lgkmcnt(9)
  v_mfma_f32_16x16x32_bf16 v[176:179], v[216:219], v[96:99], v[176:179]
  v_mfma_f32_16x16x32_bf16 v[192:195], v[216:219], v[100:103], v[192:195]
  ds_read_b128 v[216:219], v3 offset:5120
  s_waitcnt lgkmcnt(9)
  v_mfma_f32_16x16x32_bf16 v[180:183], v[220:223], v[96:99], v[180:183]
  v_mfma_f32_16x16x32_bf16 v[196:199], v[220:223], v[100:103], v[196:199]
  ds_read_b128 v[220:223], v3 offset:5376
  s_waitcnt lgkmcnt(9)
  v_mfma_f32_16x16x32_bf16 v[184:187], v[224:227], v[96:99], v[184:187]
  v_mfma_f32_16x16x32_bf16 v[200:203], v[224:227], v[100:103], v[200:203]
  ds_read_b128 v[224:227], v3 offset:8192
  s_waitcnt lgkmcnt(9)
  v_mfma_f32_16x16x32_bf16 v[188:191], v[228:231], v[96:99], v[188:191]
  v_mfma_f32_16x16x32_bf16 v[204:207], v[228:231], v[100:103], v[204:207]
  ds_read_b128 v[228:231], v3 offset:8448
  s_waitcnt lgkmcnt(9)
  v_mfma_f32_16x16x32_bf16 v[176:179], v[232:235], v[104:107], v[176:179]
  v_mfma_f32_16x16x32_bf16 v[192:195], v[232:235], v[108:111], v[192:195]
  ds_read_b128 v[232:235], v3 offset:9216
  s_waitcnt lgkmcnt(9)
  v_mfma_f32_16x16x32_bf16 v[180:183], v[236:239], v[104:107], v[180:183]
  v_mfma_f32_16x16x32_bf16 v[196:199], v[236:239], v[108:111], v[196:199]
  ds_read_b128 v[236:239], v3 offset:9472
  s_waitcnt lgkmcnt(9)
  v_mfma_f32_16x16x32_bf16 v[184:187], v[240:243], v[104:107], v[184:187]
  v_mfma_f32_16x16x32_bf16 v[200:203], v[240:243], v[108:111], v[200:203]
  s_barrier
  ds_read_b128 v[240:243], v3 offset:12288
  s_waitcnt lgkmcnt(9)
  v_mfma_f32_16x16x32_bf16 v[188:191], v[244:247], v[104:107], v[188:191]
  v_mfma_f32_16x16x32_bf16 v[204:207], v[244:247], v[108:111], v[204:207]
  ds_read_b128 v[244:247], v3 offset:12544
  s_waitcnt lgkmcnt(9)
  v_mfma_f32_16x16x32_bf16 v[176:179], v[208:211], v[112:115], v[176:179]
  v_mfma_f32_16x16x32_bf16 v[192:195], v[208:211], v[116:119], v[192:195]
  ds_read_b128 v[208:211], v3 offset:13312
  s_waitcnt lgkmcnt(9)
  v_mfma_f32_16x16x32_bf16 v[180:183], v[212:215], v[112:115], v[180:183]
  v_mfma_f32_16x16x32_bf16 v[196:199], v[212:215], v[116:119], v[196:199]
  ds_read_b128 v[212:215], v3 offset:13568
  s_waitcnt lgkmcnt(9)
  v_mfma_f32_16x16x32_bf16 v[184:187], v[216:219], v[112:115], v[184:187]
  v_mfma_f32_16x16x32_bf16 v[200:203], v[216:219], v[116:119], v[200:203]
  ds_read_b128 v[216:219], v3 offset:16384
  s_waitcnt lgkmcnt(9)
  v_mfma_f32_16x16x32_bf16 v[188:191], v[220:223], v[112:115], v[188:191]
  v_mfma_f32_16x16x32_bf16 v[204:207], v[220:223], v[116:119], v[204:207]
  ds_read_b128 v[220:223], v3 offset:16640
  s_waitcnt lgkmcnt(9)
  v_mfma_f32_16x16x32_bf16 v[176:179], v[224:227], v[120:123], v[176:179]
  v_mfma_f32_16x16x32_bf16 v[192:195], v[224:227], v[124:127], v[192:195]
  ds_read_b128 v[224:227], v3 offset:17408
  s_waitcnt lgkmcnt(9)
  v_mfma_f32_16x16x32_bf16 v[180:183], v[228:231], v[120:123], v[180:183]
  v_mfma_f32_16x16x32_bf16 v[196:199], v[228:231], v[124:127], v[196:199]
  ds_read_b128 v[228:231], v3 offset:17664
  s_waitcnt lgkmcnt(9)
  v_mfma_f32_16x16x32_bf16 v[184:187], v[232:235], v[120:123], v[184:187]
  v_mfma_f32_16x16x32_bf16 v[200:203], v[232:235], v[124:127], v[200:203]
  ds_read_b128 v[232:235], v3 offset:20480
  s_waitcnt lgkmcnt(9)
  v_mfma_f32_16x16x32_bf16 v[188:191], v[236:239], v[120:123], v[188:191]
  v_mfma_f32_16x16x32_bf16 v[204:207], v[236:239], v[124:127], v[204:207]
  ds_read_b128 v[236:239], v3 offset:20736
  s_waitcnt lgkmcnt(9)
  v_mfma_f32_16x16x32_bf16 v[176:179], v[240:243], v[128:131], v[176:179]
  v_mfma_f32_16x16x32_bf16 v[192:195], v[240:243], v[132:135], v[192:195]
  ds_read_b128 v[240:243], v3 offset:21504
  s_waitcnt lgkmcnt(9)
  v_mfma_f32_16x16x32_bf16 v[180:183], v[244:247], v[128:131], v[180:183]
  v_mfma_f32_16x16x32_bf16 v[196:199], v[244:247], v[132:135], v[196:199]
  ds_read_b128 v[244:247], v3 offset:21760
  s_waitcnt lgkmcnt(9)
  v_mfma_f32_16x16x32_bf16 v[184:187], v[208:211], v[128:131], v[184:187]
  v_mfma_f32_16x16x32_bf16 v[200:203], v[208:211], v[132:135], v[200:203]
  s_barrier
  ds_read_b128 v[208:211], v3 offset:24576
  s_waitcnt lgkmcnt(9)
  v_mfma_f32_16x16x32_bf16 v[188:191], v[212:215], v[128:131], v[188:191]
  v_mfma_f32_16x16x32_bf16 v[204:207], v[212:215], v[132:135], v[204:207]
  ds_read_b128 v[212:215], v3 offset:24832
  s_waitcnt lgkmcnt(9)
  v_mfma_f32_16x16x32_bf16 v[176:179], v[216:219], v[136:139], v[176:179]
  v_mfma_f32_16x16x32_bf16 v[192:195], v[216:219], v[140:143], v[192:195]
  ds_read_b128 v[216:219], v3 offset:25600
  s_waitcnt lgkmcnt(9)
  v_mfma_f32_16x16x32_bf16 v[180:183], v[220:223], v[136:139], v[180:183]
  v_mfma_f32_16x16x32_bf16 v[196:199], v[220:223], v[140:143], v[196:199]
  ds_read_b128 v[220:223], v3 offset:25856
  s_waitcnt lgkmcnt(9)
  v_mfma_f32_16x16x32_bf16 v[184:187], v[224:227], v[136:139], v[184:187]
  v_mfma_f32_16x16x32_bf16 v[200:203], v[224:227], v[140:143], v[200:203]
  ds_read_b128 v[224:227], v3 offset:28672
  s_waitcnt lgkmcnt(9)
  v_mfma_f32_16x16x32_bf16 v[188:191], v[228:231], v[136:139], v[188:191]
  v_mfma_f32_16x16x32_bf16 v[204:207], v[228:231], v[140:143], v[204:207]
  ds_read_b128 v[228:231], v3 offset:28928
  s_waitcnt lgkmcnt(9)
  v_mfma_f32_16x16x32_bf16 v[176:179], v[232:235], v[144:147], v[176:179]
  v_mfma_f32_16x16x32_bf16 v[192:195], v[232:235], v[148:151], v[192:195]
  ds_read_b128 v[232:235], v3 offset:29696
  s_waitcnt lgkmcnt(9)
  v_mfma_f32_16x16x32_bf16 v[180:183], v[236:239], v[144:147], v[180:183]
  v_mfma_f32_16x16x32_bf16 v[196:199], v[236:239], v[148:151], v[196:199]
  ds_read_b128 v[236:239], v3 offset:29952
  s_waitcnt lgkmcnt(9)
  v_mfma_f32_16x16x32_bf16 v[184:187], v[240:243], v[144:147], v[184:187]
  v_mfma_f32_16x16x32_bf16 v[200:203], v[240:243], v[148:151], v[200:203]
  ds_read_b128 v[240:243], v3 offset:32768
  s_waitcnt lgkmcnt(9)
  v_mfma_f32_16x16x32_bf16 v[188:191], v[244:247], v[144:147], v[188:191]
  v_mfma_f32_16x16x32_bf16 v[204:207], v[244:247], v[148:151], v[204:207]
  ds_read_b128 v[244:247], v3 offset:33024
  s_waitcnt lgkmcnt(9)
  v_mfma_f32_16x16x32_bf16 v[176:179], v[208:211], v[152:155], v[176:179]
  v_mfma_f32_16x16x32_bf16 v[192:195], v[208:211], v[156:159], v[192:195]
  ds_read_b128 v[208:211], v3 offset:33792
  s_waitcnt lgkmcnt(9)
  v_mfma_f32_16x16x32_bf16 v[180:183], v[212:215], v[152:155], v[180:183]
  v_mfma_f32_16x16x32_bf16 v[196:199], v[212:215], v[156:159], v[196:199]
  ds_read_b128 v[212:215], v3 offset:34048
  s_waitcnt lgkmcnt(9)
  v_mfma_f32_16x16x32_bf16 v[184:187], v[216:219], v[152:155], v[184:187]
  v_mfma_f32_16x16x32_bf16 v[200:203], v[216:219], v[156:159], v[200:203]
  s_waitcnt lgkmcnt(8)
  v_mfma_f32_16x16x32_bf16 v[188:191], v[220:223], v[152:155], v[188:191]
  v_mfma_f32_16x16x32_bf16 v[204:207], v[220:223], v[156:159], v[204:207]
  s_waitcnt lgkmcnt(7)
  v_mfma_f32_16x16x32_bf16 v[176:179], v[224:227], v[160:163], v[176:179]
  v_mfma_f32_16x16x32_bf16 v[192:195], v[224:227], v[164:167], v[192:195]
  s_waitcnt lgkmcnt(6)
  v_mfma_f32_16x16x32_bf16 v[180:183], v[228:231], v[160:163], v[180:183]
  v_mfma_f32_16x16x32_bf16 v[196:199], v[228:231], v[164:167], v[196:199]
  s_waitcnt lgkmcnt(5)
  v_mfma_f32_16x16x32_bf16 v[184:187], v[232:235], v[160:163], v[184:187]
  v_mfma_f32_16x16x32_bf16 v[200:203], v[232:235], v[164:167], v[200:203]
  s_waitcnt lgkmcnt(4)
  v_mfma_f32_16x16x32_bf16 v[188:191], v[236:239], v[160:163], v[188:191]
  v_mfma_f32_16x16x32_bf16 v[204:207], v[236:239], v[164:167], v[204:207]
  s_waitcnt lgkmcnt(3)
  v_mfma_f32_16x16x32_bf16 v[176:179], v[240:243], v[168:171], v[176:179]
  v_mfma_f32_16x16x32_bf16 v[192:195], v[240:243], v[172:175], v[192:195]
  s_waitcnt lgkmcnt(2)
  v_mfma_f32_16x16x32_bf16 v[180:183], v[244:247], v[168:171], v[180:183]
  v_mfma_f32_16x16x32_bf16 v[196:199], v[244:247], v[172:175], v[196:199]
  s_waitcnt lgkmcnt(1)
  v_mfma_f32_16x16x32_bf16 v[184:187], v[208:211], v[168:171], v[184:187]
  v_mfma_f32_16x16x32_bf16 v[200:203], v[208:211], v[172:175], v[200:203]
  s_waitcnt lgkmcnt(0)
  v_mfma_f32_16x16x32_bf16 v[188:191], v[212:215], v[168:171], v[188:191]
  v_mfma_f32_16x16x32_bf16 v[204:207], v[212:215], v[172:175], v[204:207]
  s_nop 0
  v_mul_f32 v180, v180, v1
  v_max_f32 v176, 0, v176
  v_mul_f32 v181, v181, v1
  v_max_f32 v177, 0, v177
  v_mul_f32 v182, v182, v1
  v_max_f32 v178, 0, v178
  v_mul_f32 v183, v183, v1
  v_max_f32 v179, 0, v179
  v_pk_mul_f32 v[176:177], v[176:177], v[180:181]
  v_pk_mul_f32 v[178:179], v[178:179], v[182:183]
  v_cvt_pk_bf16_f32 v248, v176, v177
  v_cvt_pk_bf16_f32 v249, v178, v179
  v_mul_f32 v196, v196, v2
  v_max_f32 v192, 0, v192
  v_mul_f32 v197, v197, v2
  v_max_f32 v193, 0, v193
  v_mul_f32 v198, v198, v2
  v_max_f32 v194, 0, v194
  v_mul_f32 v199, v199, v2
  v_max_f32 v195, 0, v195
  v_pk_mul_f32 v[192:193], v[192:193], v[196:197]
  v_pk_mul_f32 v[194:195], v[194:195], v[198:199]
  v_cvt_pk_bf16_f32 v250, v192, v193
  v_cvt_pk_bf16_f32 v251, v194, v195
  s_nop 0
  v_permlane16_swap_b32 v248, v250
  v_permlane16_swap_b32 v249, v251
  buffer_store_dwordx4 v[248:251], v6, s[36:39], s10 offen offset:2048 sc1
  v_mul_f32 v188, v188, v1
  v_max_f32 v184, 0, v184
  v_mul_f32 v189, v189, v1
  v_max_f32 v185, 0, v185
  v_mul_f32 v190, v190, v1
  v_max_f32 v186, 0, v186
  v_mul_f32 v191, v191, v1
  v_max_f32 v187, 0, v187
  v_pk_mul_f32 v[184:185], v[184:185], v[188:189]
  v_pk_mul_f32 v[186:187], v[186:187], v[190:191]
  v_cvt_pk_bf16_f32 v252, v184, v185
  v_cvt_pk_bf16_f32 v253, v186, v187
  v_mul_f32 v204, v204, v2
  v_max_f32 v200, 0, v200
  v_mul_f32 v205, v205, v2
  v_max_f32 v201, 0, v201
  v_mul_f32 v206, v206, v2
  v_max_f32 v202, 0, v202
  v_mul_f32 v207, v207, v2
  v_max_f32 v203, 0, v203
  v_pk_mul_f32 v[200:201], v[200:201], v[204:205]
  v_pk_mul_f32 v[202:203], v[202:203], v[206:207]
  v_cvt_pk_bf16_f32 v254, v200, v201
  v_cvt_pk_bf16_f32 v255, v202, v203
  s_nop 0
  v_permlane16_swap_b32 v252, v254
  v_permlane16_swap_b32 v253, v255
  buffer_store_dwordx4 v[252:255], v6, s[36:39], s10 offen offset:2560 sc1
  s_barrier
  s_mov_b64 exec, 1
  s_waitcnt vmcnt(0)
  buffer_store_dword v7, v0, s[36:39], s12 offen offset:64 sc0 sc1
K4_end:
  s_endpgm
CODE_END:
  s_endpgm
.section .rodata,"a"
.p2align 6
.amdhsa_kernel adaLN_cond__spectral_gfnet__glu_gated_reglu__prompt_kernel
  .amdhsa_next_free_vgpr 256
  .amdhsa_next_free_sgpr 102
  .amdhsa_accum_offset 256
  .amdhsa_group_segment_fixed_size 0
  .amdhsa_kernarg_size 96
  .amdhsa_user_sgpr_count 2
  .amdhsa_user_sgpr_kernarg_segment_ptr 1
  .amdhsa_system_sgpr_workgroup_id_x 1
.end_amdhsa_kernel
```
